```python
import torch

def _softmax(x, axis=-1):
    return torch.softmax(x, dim=axis)
def _gelu(x):
    return torch.nn.functional.gelu(x, approximate="tanh")
def _silu(x):
    return torch.nn.functional.silu(x)
def _sigmoid(x):
    return torch.sigmoid(x)
def _layernorm(x, axis=-1, eps=1e-5):
    m = x.mean(dim=axis, keepdim=True)
    v = x.var(dim=axis, keepdim=True, unbiased=False)
    return (x - m) / torch.sqrt(v + eps)
def _scatter_add(tgt, idx, src, axis=0):
    return tgt.clone().index_add_(axis, idx, src)
def _segment_sum(src, seg, n):
    out = torch.zeros((n,) + src.shape[1:], dtype=src.dtype)
    return out.index_add_(0, seg, src)
def _pad(x, pw):
    flat = tuple(v for pair in reversed(pw) for v in pair)
    return torch.nn.functional.pad(x, flat)

kernel_name = 'concat_heads__gqa_block_cached__mha_block_cached__near_ridge'

def setup_inputs():

    _w = (lambda a: (lambda t: t.to(torch.bfloat16) if t.is_floating_point() else t)(torch.as_tensor(a)))
    def _A_setup():
        B, Sq, D = 8, 32, 1024
        Hq, Hkv, Sk, Dh = 32, 4, 1024, 128
        assert Hq % Hkv == 0, (Hq, Hkv)
        return {
            "x": _w((lambda *s: torch.randn(*s, dtype=torch.bfloat16) * 0.8)(B, Sq, D)),
            "k_cache": _w((lambda *s: torch.randn(*s, dtype=torch.bfloat16) * 0.8)(B, Hkv, Sk, Dh)),
            "v_cache": _w((lambda *s: torch.randn(*s, dtype=torch.bfloat16) * 0.05)(B, Hkv, Sk, Dh)),
            "wq": _w((lambda *s: torch.randn(*s, dtype=torch.bfloat16) * 0.8)(D, Hq * Dh) * (D ** -0.5)),
            "wo": _w((lambda *s: torch.randn(*s, dtype=torch.bfloat16) * 0.05)(Hq * Dh, D) * ((Hq * Dh) ** -0.5)),
        }
    _A_in = _A_setup()

    def _B_setup():
        B, Sq, D = 8, 32, 1024
        H, Sk, Dh = 32, 1024, 128
        return {
            "x": _w((lambda *s: torch.randn(*s, dtype=torch.bfloat16) * 0.8)(B, Sq, D)),
            "k_cache": _w((lambda *s: torch.randn(*s, dtype=torch.bfloat16) * 0.8)(B, H, Sk, Dh)),
            "v_cache": _w((lambda *s: torch.randn(*s, dtype=torch.bfloat16) * 0.05)(B, H, Sk, Dh)),
            "wq": _w((lambda *s: torch.randn(*s, dtype=torch.bfloat16) * 0.8)(D, H * Dh) * (D ** -0.5)),
            "wo": _w((lambda *s: torch.randn(*s, dtype=torch.bfloat16) * 0.05)(H * Dh, D) * ((H * Dh) ** -0.5)),
        }
    _B_in = _B_setup()

    return {
        "A_x": _A_in["x"],
        "A_k_cache": _A_in["k_cache"],
        "A_v_cache": _A_in["v_cache"],
        "A_wq": _A_in["wq"],
        "A_wo": _A_in["wo"],
        "B_x": _B_in["x"],
        "B_k_cache": _B_in["k_cache"],
        "B_v_cache": _B_in["v_cache"],
        "B_wq": _B_in["wq"],
        "B_wo": _B_in["wo"],
    }

def reference(A_x, A_k_cache, A_v_cache, A_wq, A_wo, B_x, B_k_cache, B_v_cache, B_wq, B_wo):
    def _A_ref(x, k_cache, v_cache, wq, wo):
        B, Sq, D = x.shape
        Hq, Dh = 32, 128
        Hkv = k_cache.shape[1]
        rep = Hq // Hkv
        q = (lambda x, *d: x.permute(*d))((x @ wq).reshape(B, Sq, Hq, Dh), 0, 2, 1, 3)
        k = (lambda x, n, axis: torch.repeat_interleave(x, n, dim=axis))(k_cache, rep, axis=1)
        v = (lambda x, n, axis: torch.repeat_interleave(x, n, dim=axis))(v_cache, rep, axis=1)
        scores = torch.einsum("bhqd,bhkd->bhqk", q, k) * (Dh ** -0.5)
        p = _softmax(scores, axis=-1)
        o = torch.einsum("bhqk,bhkd->bhqd", p, v)
        return (lambda x, *d: x.permute(*d))(o, 0, 2, 1, 3).reshape(B, Sq, Hq * Dh) @ wo

    def _B_ref(x, k_cache, v_cache, wq, wo):
        B, Sq, D = x.shape
        H, Dh = 32, 128
        q = (lambda x, *d: x.permute(*d))((x @ wq).reshape(B, Sq, H, Dh), 0, 2, 1, 3)
        scores = torch.einsum("bhqd,bhkd->bhqk", q, k_cache) * (Dh ** -0.5)
        p = _softmax(scores, axis=-1)
        o = torch.einsum("bhqk,bhkd->bhqd", p, v_cache)
        return (lambda x, *d: x.permute(*d))(o, 0, 2, 1, 3).reshape(B, Sq, H * Dh) @ wo

    a = _A_ref(A_x, A_k_cache, A_v_cache, A_wq, A_wo)
    b = _B_ref(B_x, B_k_cache, B_v_cache, B_wq, B_wo)
    return torch.concatenate([a, b], axis=-1)
```

```asm
; @launch grid=(256,1,1) block=(256,1,1) lds=163840
.amdgcn_target "amdgcn-amd-amdhsa--gfx950"
.text
.globl concat_heads__gqa_block_cached__mha_block_cached__near_ridge_kernel
.p2align 8
.type concat_heads__gqa_block_cached__mha_block_cached__near_ridge_kernel,@function
concat_heads__gqa_block_cached__mha_block_cached__near_ridge_kernel:
    s_cmp_ge_u32 s2, 256
    s_cbranch_scc1 L_end
    s_load_dwordx16 s[16:31], s[0:1], 0
    s_load_dwordx8 s[32:39], s[0:1], 64
    s_load_dwordx2 s[40:41], s[0:1], 96
    v_lshrrev_b32 v31, 6, v0
    v_and_b32 v1, 63, v0
    v_readfirstlane_b32 s3, v31
    v_lshlrev_b32 v30, 4, v1
    s_lshl_b32 s4, s3, 15
    s_and_b32 s50, s2, 7
    s_lshr_b32 s51, s2, 3
    s_and_b32 s52, s51, 15
    s_and_b32 s53, s51, 3
    s_lshl_b32 s7, s50, 2
    s_add_u32 s53, s53, s7
    s_lshr_b32 s54, s51, 2
    s_lshl_b32 s55, s54, 5
    s_add_u32 s55, s55, s53
    s_cmp_lt_u32 s51, 16
    s_cbranch_scc1 L_g1
    v_lshrrev_b32 v31, 4, v1
    v_and_b32 v2, 15, v1
    v_xor_b32 v2, v2, v31
    v_lshlrev_b32 v2, 4, v2
    v_lshlrev_b32 v31, 8, v31
    v_xor_b32 v3, 64, v2
    v_add_u32 v3, v3, v31
    v_add_u32 v3, 3072, v3
    v_xor_b32 v4, 128, v2
    v_add_u32 v4, v4, v31
    v_add_u32 v4, 6144, v4
    v_xor_b32 v5, 192, v2
    v_add_u32 v5, v5, v31
    v_add_u32 v5, 9216, v5
    v_add_u32 v2, v2, v31
    s_lshl_b32 s59, s55, 18
    s_lshl_b32 s7, s3, 10
    s_add_u32 s59, s59, s7
    s_mov_b32 s56, s59
    s_waitcnt lgkmcnt(0)
    s_mov_b32 s8, s28
    s_mov_b32 s9, s29
    s_mov_b32 s10, 67108864
    s_mov_b32 s11, 0x20000
    s_add_u32 m0, s4, 0
    s_nop 0
    buffer_load_dwordx4 v2, s[8:11], s56 offen nt lds
    buffer_load_dwordx4 v3, s[8:11], s56 offen offset:1024 nt lds
    buffer_load_dwordx4 v4, s[8:11], s56 offen offset:2048 nt lds
    buffer_load_dwordx4 v5, s[8:11], s56 offen offset:3072 nt lds
    s_add_u32 s57, s56, 16384
    s_add_u32 m0, s4, 4096
    s_nop 0
    buffer_load_dwordx4 v2, s[8:11], s57 offen nt lds
    buffer_load_dwordx4 v3, s[8:11], s57 offen offset:1024 nt lds
    buffer_load_dwordx4 v4, s[8:11], s57 offen offset:2048 nt lds
    buffer_load_dwordx4 v5, s[8:11], s57 offen offset:3072 nt lds
    s_add_u32 s56, s56, 32768
    s_add_u32 m0, s4, 8192
    s_nop 0
    buffer_load_dwordx4 v2, s[8:11], s56 offen nt lds
    buffer_load_dwordx4 v3, s[8:11], s56 offen offset:1024 nt lds
    buffer_load_dwordx4 v4, s[8:11], s56 offen offset:2048 nt lds
    buffer_load_dwordx4 v5, s[8:11], s56 offen offset:3072 nt lds
    s_add_u32 s57, s56, 16384
    s_add_u32 m0, s4, 12288
    s_nop 0
    buffer_load_dwordx4 v2, s[8:11], s57 offen nt lds
    buffer_load_dwordx4 v3, s[8:11], s57 offen offset:1024 nt lds
    buffer_load_dwordx4 v4, s[8:11], s57 offen offset:2048 nt lds
    buffer_load_dwordx4 v5, s[8:11], s57 offen offset:3072 nt lds
    s_add_u32 s56, s56, 32768
    s_branch L_g2
L_g1:
    v_lshrrev_b32 v31, 4, v1
    v_and_b32 v2, 15, v1
    v_xor_b32 v2, v2, v31
    v_lshlrev_b32 v2, 4, v2
    v_lshlrev_b32 v31, 11, v31
    v_xor_b32 v3, 64, v2
    v_add_u32 v3, v3, v31
    v_add_u32 v3, 7168, v3
    v_xor_b32 v4, 128, v2
    v_add_u32 v4, v4, v31
    v_add_u32 v4, 14336, v4
    v_xor_b32 v5, 192, v2
    v_add_u32 v5, v5, v31
    v_add_u32 v5, 21504, v5
    v_add_u32 v2, v2, v31
    s_and_b32 s97, s50, 1
    s_bfe_u32 s98, s52, 0x20001
    s_lshr_b32 s99, s52, 3
    s_lshl_b32 s100, s99, 2
    s_add_u32 s100, s100, s3
    s_lshl_b32 s59, s100, 16
    s_lshr_b32 s7, s50, 1
    s_lshl_b32 s7, s7, 3
    s_and_b32 s101, s52, 7
    s_add_u32 s101, s101, s7
    s_xor_b32 s99, s99, s52
    s_and_b32 s99, s99, 1
    s_add_u32 s7, s98, 0
    s_and_b32 s7, s7, 3
    s_lshl_b32 s7, s7, 1
    s_add_u32 s7, s7, s99
    s_lshl_b32 s7, s7, 8
    s_add_u32 s56, s59, s7
    s_waitcnt lgkmcnt(0)
    s_cmp_eq_u32 s97, 0
    s_cselect_b32 s8, s16, s26
    s_cselect_b32 s9, s17, s27
    s_mov_b32 s10, 524288
    s_mov_b32 s11, 0x20000
    s_lshl_b32 s69, s3, 13
    s_add_u32 s69, s69, 131072
    s_add_u32 m0, s69, 0
    s_nop 0
    buffer_load_dwordx4 v2, s[8:11], s56 offen lds
    buffer_load_dwordx4 v3, s[8:11], s56 offen offset:1024 lds
    buffer_load_dwordx4 v4, s[8:11], s56 offen offset:2048 lds
    buffer_load_dwordx4 v5, s[8:11], s56 offen offset:3072 lds
    s_add_u32 s57, s56, 32768
    s_add_u32 m0, s69, 4096
    s_nop 0
    buffer_load_dwordx4 v2, s[8:11], s57 offen lds
    buffer_load_dwordx4 v3, s[8:11], s57 offen offset:1024 lds
    buffer_load_dwordx4 v4, s[8:11], s57 offen offset:2048 lds
    buffer_load_dwordx4 v5, s[8:11], s57 offen offset:3072 lds
    s_add_u32 s7, s98, 0
    s_and_b32 s7, s7, 3
    s_lshl_b32 s7, s7, 1
    s_add_u32 s7, s7, s99
    s_xor_b32 s7, s7, 1
    s_lshl_b32 s7, s7, 8
    s_add_u32 s56, s59, s7
    s_mov_b32 s44, s40
    s_mov_b32 s45, s41
    s_mov_b32 s46, 268435456
    s_mov_b32 s47, 0x20000
    s_lshl_b32 s64, s55, 13
    s_add_u32 s64, s64, 2097152
    s_add_u32 s65, s64, 4194304
    s_lshl_b32 s66, s55, 6
    s_add_u32 s66, s66, 16793600
    s_lshl_b32 s67, s54, 3
    s_add_u32 s67, s67, s50
    s_lshl_b32 s67, s67, 8
    s_and_b32 s7, s51, 3
    s_lshl_b32 s7, s7, 2
    s_add_u32 s67, s67, s7
    s_add_u32 s67, s67, 18890752
    s_mov_b32 s6, 0x3e0293ee
    s_lshl_b32 s95, s97, 3
    s_add_u32 s95, s95, s100
    s_lshl_b32 s95, s95, 5
    s_add_u32 s95, s95, s101
    s_lshl_b32 s96, s95, 6
    s_add_u32 s96, s96, 16777216
    s_lshl_b32 s95, s95, 13
    s_xor_b32 s92, s51, 16
    s_lshl_b32 s93, s92, 2
    s_add_u32 s93, s93, s3
    s_lshl_b32 s93, s93, 8
    s_lshl_b32 s7, s50, 2
    s_add_u32 s93, s93, s7
    s_add_u32 s93, s93, 20971520
    s_cmp_lg_u32 s3, 0
    s_cbranch_scc1 L_g1clear
    v_mov_b32 v31, 0
    v_lshlrev_b32 v103, 11, v1
    s_mov_b64 exec, 15
    buffer_store_dword v31, v103, s[44:47], s96 offen sc1
    s_mov_b64 exec, -1
    v_lshlrev_b32 v103, 2, v1
    s_mov_b64 exec, 1
    buffer_store_dword v31, v103, s[44:47], s67 offen sc1
    s_mov_b64 exec, -1
    v_lshlrev_b32 v103, 8, v1
    s_mov_b64 exec, 15
    buffer_store_dword v31, v103, s[44:47], s93 offen sc1
    s_mov_b64 exec, -1
L_g1clear:
    v_and_b32 v31, 31, v1
    v_lshrrev_b32 v32, 5, v1
    v_and_b32 v33, 15, v1
    v_xor_b32 v32, v32, v33
    v_lshlrev_b32 v32, 4, v32
    v_lshlrev_b32 v31, 8, v31
    v_add_u32 v31, s69, v31
    v_xor_b32 v10, 0, v32
    v_add_u32 v10, v10, v31
    v_xor_b32 v11, 32, v32
    v_add_u32 v11, v11, v31
    v_xor_b32 v12, 64, v32
    v_add_u32 v12, v12, v31
    v_xor_b32 v13, 96, v32
    v_add_u32 v13, v13, v31
    v_xor_b32 v14, 128, v32
    v_add_u32 v14, v14, v31
    v_xor_b32 v15, 160, v32
    v_add_u32 v15, v15, v31
    v_xor_b32 v16, 192, v32
    v_add_u32 v16, v16, v31
    v_xor_b32 v17, 224, v32
    v_add_u32 v17, v17, v31
    v_bfe_u32 v31, v1, 2, 2
    v_bfe_u32 v32, v1, 4, 1
    v_lshlrev_b32 v32, 5, v32
    v_and_b32 v33, 1, v1
    v_lshl_add_u32 v32, v33, 4, v32
    v_bfe_u32 v33, v1, 1, 1
    v_lshl_add_u32 v32, v33, 3, v32
    v_lshl_add_u32 v32, v31, 8, v32
    v_lshrrev_b32 v33, 5, v1
    v_lshlrev_b32 v31, 6, v31
    v_xor_b32 v34, 0, v31
    v_add_u32 v34, v34, v32
    v_lshl_add_u32 v22, v33, 11, v34
    v_add_u32 v26, 0x10000, v22
    v_xor_b32 v34, 64, v31
    v_add_u32 v34, v34, v32
    v_lshl_add_u32 v23, v33, 11, v34
    v_add_u32 v27, 0x10000, v23
    v_xor_b32 v34, 128, v31
    v_add_u32 v34, v34, v32
    v_lshl_add_u32 v24, v33, 11, v34
    v_add_u32 v28, 0x10000, v24
    v_xor_b32 v34, 192, v31
    v_add_u32 v34, v34, v32
    v_lshl_add_u32 v25, v33, 11, v34
    v_add_u32 v29, 0x10000, v25
    s_add_u32 s5, s3, 0
    s_and_b32 s5, s5, 3
    s_lshl_b32 s5, s5, 6
    v_xor_b32 v34, s5, v31
    v_add3_u32 v34, v34, v32, s4
    v_lshl_add_u32 v18, v33, 10, v34
    s_add_u32 s5, s3, 1
    s_and_b32 s5, s5, 3
    s_lshl_b32 s5, s5, 6
    v_xor_b32 v34, s5, v31
    v_add3_u32 v34, v34, v32, s4
    v_lshl_add_u32 v19, v33, 10, v34
    s_add_u32 s5, s3, 2
    s_and_b32 s5, s5, 3
    s_lshl_b32 s5, s5, 6
    v_xor_b32 v34, s5, v31
    v_add3_u32 v34, v34, v32, s4
    v_lshl_add_u32 v20, v33, 10, v34
    s_add_u32 s5, s3, 3
    s_and_b32 s5, s5, 3
    s_lshl_b32 s5, s5, 6
    v_xor_b32 v34, s5, v31
    v_add3_u32 v34, v34, v32, s4
    v_lshl_add_u32 v21, v33, 10, v34
    s_getpc_b64 s[48:49]
L_g1pf:
    s_add_u32 s48, s48, L_g1pf_x-L_g1pf
    s_addc_u32 s49, s49, 0
    s_lshl_b32 s7, s52, 2
    s_add_u32 s7, s7, s3
    s_mul_i32 s7, s7, 512
    v_lshl_add_u32 v101, v1, 7, s7
    v_min_u32 v101, L_g2-L_g1pf_x-4, v101
    s_mov_b64 exec, 15
    global_load_dword v31, v101, s[48:49]
    s_mov_b64 exec, -1
L_g1pf_x:
    s_add_u32 s94, s95, 4096
    v_lshrrev_b32 v7, 4, v1
    v_and_b32 v8, 15, v1
    v_lshlrev_b32 v9, 2, v7
    v_xor_b32 v8, v8, v9
    v_lshlrev_b32 v8, 4, v8
    v_lshl_add_u32 v6, v7, 13, v8
    v_add_u32 v7, 31744, v6
    v_add_u32 v8, 63488, v6
    v_add_u32 v9, 95232, v6
    s_cmp_eq_u32 s97, 0
    s_cselect_b32 s12, s22, s32
    s_cselect_b32 s13, s23, s33
    s_mov_b32 s14, 8388608
    s_mov_b32 s15, 0x20000
    s_lshl_b32 s63, s101, 8
    s_lshl_b32 s7, s3, 18
    s_add_u32 s63, s63, s7
    s_add_u32 s7, s98, 0
    s_and_b32 s7, s7, 3
    s_lshl_b32 s7, s7, 1
    s_add_u32 s7, s7, s99
    s_lshl_b32 s7, s7, 20
    s_add_u32 s60, s63, s7
    s_add_u32 m0, s4, 0
    s_nop 0
    buffer_load_dwordx4 v6, s[12:15], s60 offen lds
    buffer_load_dwordx4 v7, s[12:15], s60 offen offset:1024 lds
    buffer_load_dwordx4 v8, s[12:15], s60 offen offset:2048 lds
    buffer_load_dwordx4 v9, s[12:15], s60 offen offset:3072 lds
    s_add_u32 s61, s60, 131072
    s_add_u32 m0, s4, 4096
    s_nop 0
    buffer_load_dwordx4 v6, s[12:15], s61 offen lds
    buffer_load_dwordx4 v7, s[12:15], s61 offen offset:1024 lds
    buffer_load_dwordx4 v8, s[12:15], s61 offen offset:2048 lds
    buffer_load_dwordx4 v9, s[12:15], s61 offen offset:3072 lds
    s_add_u32 s7, s98, 0
    s_and_b32 s7, s7, 3
    s_lshl_b32 s7, s7, 1
    s_add_u32 s7, s7, s99
    s_xor_b32 s7, s7, 1
    s_lshl_b32 s7, s7, 20
    s_add_u32 s60, s63, s7
    s_waitcnt vmcnt(15)
    s_add_u32 m0, s4, 8192
    s_nop 0
    buffer_load_dwordx4 v6, s[12:15], s60 offen lds
    s_waitcnt vmcnt(15)
    buffer_load_dwordx4 v7, s[12:15], s60 offen offset:1024 lds
    s_waitcnt vmcnt(15)
    buffer_load_dwordx4 v8, s[12:15], s60 offen offset:2048 lds
    s_waitcnt vmcnt(15)
    buffer_load_dwordx4 v9, s[12:15], s60 offen offset:3072 lds
    s_waitcnt vmcnt(15)
    s_add_u32 s61, s60, 131072
    s_add_u32 m0, s4, 12288
    s_nop 0
    buffer_load_dwordx4 v6, s[12:15], s61 offen lds
    s_waitcnt vmcnt(15)
    buffer_load_dwordx4 v7, s[12:15], s61 offen offset:1024 lds
    s_waitcnt vmcnt(15)
    buffer_load_dwordx4 v8, s[12:15], s61 offen offset:2048 lds
    s_waitcnt vmcnt(15)
    buffer_load_dwordx4 v9, s[12:15], s61 offen offset:3072 lds
    s_add_u32 s7, s98, 1
    s_and_b32 s7, s7, 3
    s_lshl_b32 s7, s7, 1
    s_add_u32 s7, s7, s99
    s_lshl_b32 s7, s7, 20
    s_add_u32 s60, s63, s7
    ds_read_b128 a[0:3], v10
    ds_read_b128 a[4:7], v11
    ds_read_b128 a[8:11], v12
    ds_read_b128 a[12:15], v13
    ds_read_b128 a[16:19], v14
    ds_read_b128 a[20:23], v15
    ds_read_b128 a[24:27], v16
    ds_read_b128 a[28:31], v17
    s_waitcnt vmcnt(8)
    s_cmp_lg_u32 s3, 0
    s_cbranch_scc1 L_g1count
    s_lshl_b32 s7, s50, 5
    v_mov_b32 v31, 1
    v_mov_b32 v103, s7
    s_mov_b64 exec, 1
    global_atomic_add v103, v31, s[38:39] sc1
    s_mov_b64 exec, -1
L_g1count:
    s_barrier
    ds_read_b64_tr_b16 v[72:73], v22 offset:0
    ds_read_b64_tr_b16 v[74:75], v22 offset:1024
    ds_read_b64_tr_b16 v[76:77], v23 offset:0
    ds_read_b64_tr_b16 v[78:79], v23 offset:1024
    ds_read_b64_tr_b16 v[80:81], v24 offset:0
    ds_read_b64_tr_b16 v[82:83], v24 offset:1024
    ds_read_b64_tr_b16 v[84:85], v25 offset:0
    ds_read_b64_tr_b16 v[86:87], v25 offset:1024
    s_waitcnt lgkmcnt(6)
    v_mfma_f32_32x32x16_bf16 v[128:143], v[72:75], a[0:3], 0
    s_add_u32 m0, s69, 0
    s_nop 0
    buffer_load_dwordx4 v2, s[8:11], s56 offen lds
    buffer_load_dwordx4 v3, s[8:11], s56 offen offset:1024 lds
    ds_read_b64_tr_b16 v[88:89], v22 offset:4096
    ds_read_b64_tr_b16 v[90:91], v22 offset:5120
    s_waitcnt lgkmcnt(6)
    v_mfma_f32_32x32x16_bf16 v[144:159], v[76:79], a[0:3], 0
    ds_read_b64_tr_b16 v[92:93], v23 offset:4096
    ds_read_b64_tr_b16 v[94:95], v23 offset:5120
    s_waitcnt lgkmcnt(6)
    v_mfma_f32_32x32x16_bf16 v[160:175], v[80:83], a[0:3], 0
    ds_read_b64_tr_b16 v[96:97], v24 offset:4096
    ds_read_b64_tr_b16 v[98:99], v24 offset:5120
    s_waitcnt lgkmcnt(6)
    v_mfma_f32_32x32x16_bf16 v[176:191], v[84:87], a[0:3], 0
    ds_read_b64_tr_b16 v[100:101], v25 offset:4096
    ds_read_b64_tr_b16 v[102:103], v25 offset:5120
    s_waitcnt lgkmcnt(6)
    v_mfma_f32_32x32x16_bf16 v[128:143], v[88:91], a[4:7], v[128:143]
    buffer_load_dwordx4 v4, s[8:11], s56 offen offset:2048 lds
    buffer_load_dwordx4 v5, s[8:11], s56 offen offset:3072 lds
    ds_read_b64_tr_b16 v[72:73], v22 offset:32768
    ds_read_b64_tr_b16 v[74:75], v22 offset:33792
    s_waitcnt lgkmcnt(6)
    v_mfma_f32_32x32x16_bf16 v[144:159], v[92:95], a[4:7], v[144:159]
    ds_read_b64_tr_b16 v[76:77], v23 offset:32768
    ds_read_b64_tr_b16 v[78:79], v23 offset:33792
    s_waitcnt lgkmcnt(6)
    v_mfma_f32_32x32x16_bf16 v[160:175], v[96:99], a[4:7], v[160:175]
    ds_read_b64_tr_b16 v[80:81], v24 offset:32768
    ds_read_b64_tr_b16 v[82:83], v24 offset:33792
    s_waitcnt lgkmcnt(6)
    v_mfma_f32_32x32x16_bf16 v[176:191], v[100:103], a[4:7], v[176:191]
    ds_read_b64_tr_b16 v[84:85], v25 offset:32768
    ds_read_b64_tr_b16 v[86:87], v25 offset:33792
    s_waitcnt lgkmcnt(6)
    v_mfma_f32_32x32x16_bf16 v[128:143], v[72:75], a[8:11], v[128:143]
    s_add_u32 s57, s56, 32768
    s_add_u32 m0, s69, 4096
    s_nop 0
    buffer_load_dwordx4 v2, s[8:11], s57 offen lds
    buffer_load_dwordx4 v3, s[8:11], s57 offen offset:1024 lds
    ds_read_b64_tr_b16 v[88:89], v22 offset:36864
    ds_read_b64_tr_b16 v[90:91], v22 offset:37888
    s_waitcnt lgkmcnt(6)
    v_mfma_f32_32x32x16_bf16 v[144:159], v[76:79], a[8:11], v[144:159]
    ds_read_b64_tr_b16 v[92:93], v23 offset:36864
    ds_read_b64_tr_b16 v[94:95], v23 offset:37888
    s_waitcnt lgkmcnt(6)
    v_mfma_f32_32x32x16_bf16 v[160:175], v[80:83], a[8:11], v[160:175]
    ds_read_b64_tr_b16 v[96:97], v24 offset:36864
    ds_read_b64_tr_b16 v[98:99], v24 offset:37888
    s_waitcnt lgkmcnt(6)
    v_mfma_f32_32x32x16_bf16 v[176:191], v[84:87], a[8:11], v[176:191]
    ds_read_b64_tr_b16 v[100:101], v25 offset:36864
    ds_read_b64_tr_b16 v[102:103], v25 offset:37888
    s_waitcnt lgkmcnt(6)
    v_mfma_f32_32x32x16_bf16 v[128:143], v[88:91], a[12:15], v[128:143]
    buffer_load_dwordx4 v4, s[8:11], s57 offen offset:2048 lds
    buffer_load_dwordx4 v5, s[8:11], s57 offen offset:3072 lds
    s_add_u32 s7, s98, 1
    s_and_b32 s7, s7, 3
    s_lshl_b32 s7, s7, 1
    s_add_u32 s7, s7, s99
    s_lshl_b32 s7, s7, 8
    s_add_u32 s56, s59, s7
    ds_read_b64_tr_b16 v[72:73], v26 offset:0
    ds_read_b64_tr_b16 v[74:75], v26 offset:1024
    s_waitcnt lgkmcnt(6)
    v_mfma_f32_32x32x16_bf16 v[144:159], v[92:95], a[12:15], v[144:159]
    ds_read_b64_tr_b16 v[76:77], v27 offset:0
    ds_read_b64_tr_b16 v[78:79], v27 offset:1024
    s_waitcnt lgkmcnt(6)
    v_mfma_f32_32x32x16_bf16 v[160:175], v[96:99], a[12:15], v[160:175]
    ds_read_b64_tr_b16 v[80:81], v28 offset:0
    ds_read_b64_tr_b16 v[82:83], v28 offset:1024
    s_waitcnt lgkmcnt(6)
    v_mfma_f32_32x32x16_bf16 v[176:191], v[100:103], a[12:15], v[176:191]
    ds_read_b64_tr_b16 v[84:85], v29 offset:0
    ds_read_b64_tr_b16 v[86:87], v29 offset:1024
    s_waitcnt lgkmcnt(6)
    v_mfma_f32_32x32x16_bf16 v[128:143], v[72:75], a[16:19], v[128:143]
    s_waitcnt vmcnt(15)
    s_add_u32 m0, s4, 16384
    s_nop 0
    buffer_load_dwordx4 v6, s[12:15], s60 offen lds
    s_waitcnt vmcnt(15)
    buffer_load_dwordx4 v7, s[12:15], s60 offen offset:1024 lds
    ds_read_b64_tr_b16 v[88:89], v26 offset:4096
    ds_read_b64_tr_b16 v[90:91], v26 offset:5120
    s_waitcnt lgkmcnt(6)
    v_mfma_f32_32x32x16_bf16 v[144:159], v[76:79], a[16:19], v[144:159]
    ds_read_b64_tr_b16 v[92:93], v27 offset:4096
    ds_read_b64_tr_b16 v[94:95], v27 offset:5120
    s_waitcnt lgkmcnt(6)
    v_mfma_f32_32x32x16_bf16 v[160:175], v[80:83], a[16:19], v[160:175]
    ds_read_b64_tr_b16 v[96:97], v28 offset:4096
    ds_read_b64_tr_b16 v[98:99], v28 offset:5120
    s_waitcnt lgkmcnt(6)
    v_mfma_f32_32x32x16_bf16 v[176:191], v[84:87], a[16:19], v[176:191]
    ds_read_b64_tr_b16 v[100:101], v29 offset:4096
    ds_read_b64_tr_b16 v[102:103], v29 offset:5120
    s_waitcnt lgkmcnt(6)
    v_mfma_f32_32x32x16_bf16 v[128:143], v[88:91], a[20:23], v[128:143]
    s_waitcnt vmcnt(15)
    buffer_load_dwordx4 v8, s[12:15], s60 offen offset:2048 lds
    s_waitcnt vmcnt(15)
    buffer_load_dwordx4 v9, s[12:15], s60 offen offset:3072 lds
    ds_read_b64_tr_b16 v[72:73], v26 offset:32768
    ds_read_b64_tr_b16 v[74:75], v26 offset:33792
    s_waitcnt lgkmcnt(6)
    v_mfma_f32_32x32x16_bf16 v[144:159], v[92:95], a[20:23], v[144:159]
    ds_read_b64_tr_b16 v[76:77], v27 offset:32768
    ds_read_b64_tr_b16 v[78:79], v27 offset:33792
    s_waitcnt lgkmcnt(6)
    v_mfma_f32_32x32x16_bf16 v[160:175], v[96:99], a[20:23], v[160:175]
    ds_read_b64_tr_b16 v[80:81], v28 offset:32768
    ds_read_b64_tr_b16 v[82:83], v28 offset:33792
    s_waitcnt lgkmcnt(6)
    v_mfma_f32_32x32x16_bf16 v[176:191], v[100:103], a[20:23], v[176:191]
    ds_read_b64_tr_b16 v[84:85], v29 offset:32768
    ds_read_b64_tr_b16 v[86:87], v29 offset:33792
    s_waitcnt lgkmcnt(6)
    v_mfma_f32_32x32x16_bf16 v[128:143], v[72:75], a[24:27], v[128:143]
    s_waitcnt vmcnt(15)
    s_add_u32 s61, s60, 131072
    s_add_u32 m0, s4, 20480
    s_nop 0
    buffer_load_dwordx4 v6, s[12:15], s61 offen lds
    s_waitcnt vmcnt(15)
    buffer_load_dwordx4 v7, s[12:15], s61 offen offset:1024 lds
    ds_read_b64_tr_b16 v[88:89], v26 offset:36864
    ds_read_b64_tr_b16 v[90:91], v26 offset:37888
    s_waitcnt lgkmcnt(6)
    v_mfma_f32_32x32x16_bf16 v[144:159], v[76:79], a[24:27], v[144:159]
    ds_read_b64_tr_b16 v[92:93], v27 offset:36864
    ds_read_b64_tr_b16 v[94:95], v27 offset:37888
    s_waitcnt lgkmcnt(6)
    v_mfma_f32_32x32x16_bf16 v[160:175], v[80:83], a[24:27], v[160:175]
    ds_read_b64_tr_b16 v[96:97], v28 offset:36864
    ds_read_b64_tr_b16 v[98:99], v28 offset:37888
    s_waitcnt lgkmcnt(6)
    v_mfma_f32_32x32x16_bf16 v[176:191], v[84:87], a[24:27], v[176:191]
    ds_read_b64_tr_b16 v[100:101], v29 offset:36864
    ds_read_b64_tr_b16 v[102:103], v29 offset:37888
    s_waitcnt lgkmcnt(0)
    s_waitcnt vmcnt(15)
    buffer_load_dwordx4 v8, s[12:15], s61 offen offset:2048 lds
    s_waitcnt vmcnt(15)
    buffer_load_dwordx4 v9, s[12:15], s61 offen offset:3072 lds
    s_add_u32 s7, s98, 1
    s_and_b32 s7, s7, 3
    s_lshl_b32 s7, s7, 1
    s_add_u32 s7, s7, s99
    s_xor_b32 s7, s7, 1
    s_lshl_b32 s7, s7, 20
    s_add_u32 s60, s63, s7
    s_waitcnt vmcnt(8)
    ds_read_b128 a[32:35], v10
    ds_read_b128 a[36:39], v11
    ds_read_b128 a[40:43], v12
    ds_read_b128 a[44:47], v13
    ds_read_b128 a[48:51], v14
    ds_read_b128 a[52:55], v15
    ds_read_b128 a[56:59], v16
    ds_read_b128 a[60:63], v17
    s_barrier
    v_mfma_f32_32x32x16_bf16 v[128:143], v[88:91], a[28:31], v[128:143]
    ds_read_b64_tr_b16 v[72:73], v22 offset:8192
    ds_read_b64_tr_b16 v[74:75], v22 offset:9216
    v_mfma_f32_32x32x16_bf16 v[144:159], v[92:95], a[28:31], v[144:159]
    ds_read_b64_tr_b16 v[76:77], v23 offset:8192
    ds_read_b64_tr_b16 v[78:79], v23 offset:9216
    v_mfma_f32_32x32x16_bf16 v[160:175], v[96:99], a[28:31], v[160:175]
    ds_read_b64_tr_b16 v[80:81], v24 offset:8192
    ds_read_b64_tr_b16 v[82:83], v24 offset:9216
    v_mfma_f32_32x32x16_bf16 v[176:191], v[100:103], a[28:31], v[176:191]
    ds_read_b64_tr_b16 v[84:85], v25 offset:8192
    ds_read_b64_tr_b16 v[86:87], v25 offset:9216
    s_waitcnt lgkmcnt(6)
    v_mfma_f32_32x32x16_bf16 v[128:143], v[72:75], a[32:35], v[128:143]
    s_add_u32 m0, s69, 0
    s_nop 0
    buffer_load_dwordx4 v2, s[8:11], s56 offen lds
    buffer_load_dwordx4 v3, s[8:11], s56 offen offset:1024 lds
    ds_read_b64_tr_b16 v[88:89], v22 offset:12288
    ds_read_b64_tr_b16 v[90:91], v22 offset:13312
    s_waitcnt lgkmcnt(6)
    v_mfma_f32_32x32x16_bf16 v[144:159], v[76:79], a[32:35], v[144:159]
    ds_read_b64_tr_b16 v[92:93], v23 offset:12288
    ds_read_b64_tr_b16 v[94:95], v23 offset:13312
    s_waitcnt lgkmcnt(6)
    v_mfma_f32_32x32x16_bf16 v[160:175], v[80:83], a[32:35], v[160:175]
    ds_read_b64_tr_b16 v[96:97], v24 offset:12288
    ds_read_b64_tr_b16 v[98:99], v24 offset:13312
    s_waitcnt lgkmcnt(6)
    v_mfma_f32_32x32x16_bf16 v[176:191], v[84:87], a[32:35], v[176:191]
    ds_read_b64_tr_b16 v[100:101], v25 offset:12288
    ds_read_b64_tr_b16 v[102:103], v25 offset:13312
    s_waitcnt lgkmcnt(6)
    v_mfma_f32_32x32x16_bf16 v[128:143], v[88:91], a[36:39], v[128:143]
    buffer_load_dwordx4 v4, s[8:11], s56 offen offset:2048 lds
    buffer_load_dwordx4 v5, s[8:11], s56 offen offset:3072 lds
    ds_read_b64_tr_b16 v[72:73], v22 offset:40960
    ds_read_b64_tr_b16 v[74:75], v22 offset:41984
    s_waitcnt lgkmcnt(6)
    v_mfma_f32_32x32x16_bf16 v[144:159], v[92:95], a[36:39], v[144:159]
    ds_read_b64_tr_b16 v[76:77], v23 offset:40960
    ds_read_b64_tr_b16 v[78:79], v23 offset:41984
    s_waitcnt lgkmcnt(6)
    v_mfma_f32_32x32x16_bf16 v[160:175], v[96:99], a[36:39], v[160:175]
    ds_read_b64_tr_b16 v[80:81], v24 offset:40960
    ds_read_b64_tr_b16 v[82:83], v24 offset:41984
    s_waitcnt lgkmcnt(6)
    v_mfma_f32_32x32x16_bf16 v[176:191], v[100:103], a[36:39], v[176:191]
    ds_read_b64_tr_b16 v[84:85], v25 offset:40960
    ds_read_b64_tr_b16 v[86:87], v25 offset:41984
    s_waitcnt lgkmcnt(6)
    v_mfma_f32_32x32x16_bf16 v[128:143], v[72:75], a[40:43], v[128:143]
    s_add_u32 s57, s56, 32768
    s_add_u32 m0, s69, 4096
    s_nop 0
    buffer_load_dwordx4 v2, s[8:11], s57 offen lds
    buffer_load_dwordx4 v3, s[8:11], s57 offen offset:1024 lds
    ds_read_b64_tr_b16 v[88:89], v22 offset:45056
    ds_read_b64_tr_b16 v[90:91], v22 offset:46080
    s_waitcnt lgkmcnt(6)
    v_mfma_f32_32x32x16_bf16 v[144:159], v[76:79], a[40:43], v[144:159]
    ds_read_b64_tr_b16 v[92:93], v23 offset:45056
    ds_read_b64_tr_b16 v[94:95], v23 offset:46080
    s_waitcnt lgkmcnt(6)
    v_mfma_f32_32x32x16_bf16 v[160:175], v[80:83], a[40:43], v[160:175]
    ds_read_b64_tr_b16 v[96:97], v24 offset:45056
    ds_read_b64_tr_b16 v[98:99], v24 offset:46080
    s_waitcnt lgkmcnt(6)
    v_mfma_f32_32x32x16_bf16 v[176:191], v[84:87], a[40:43], v[176:191]
    ds_read_b64_tr_b16 v[100:101], v25 offset:45056
    ds_read_b64_tr_b16 v[102:103], v25 offset:46080
    s_waitcnt lgkmcnt(6)
    v_mfma_f32_32x32x16_bf16 v[128:143], v[88:91], a[44:47], v[128:143]
    buffer_load_dwordx4 v4, s[8:11], s57 offen offset:2048 lds
    buffer_load_dwordx4 v5, s[8:11], s57 offen offset:3072 lds
    s_add_u32 s7, s98, 1
    s_and_b32 s7, s7, 3
    s_lshl_b32 s7, s7, 1
    s_add_u32 s7, s7, s99
    s_xor_b32 s7, s7, 1
    s_lshl_b32 s7, s7, 8
    s_add_u32 s56, s59, s7
    ds_read_b64_tr_b16 v[72:73], v26 offset:8192
    ds_read_b64_tr_b16 v[74:75], v26 offset:9216
    s_waitcnt lgkmcnt(6)
    v_mfma_f32_32x32x16_bf16 v[144:159], v[92:95], a[44:47], v[144:159]
    ds_read_b64_tr_b16 v[76:77], v27 offset:8192
    ds_read_b64_tr_b16 v[78:79], v27 offset:9216
    s_waitcnt lgkmcnt(6)
    v_mfma_f32_32x32x16_bf16 v[160:175], v[96:99], a[44:47], v[160:175]
    ds_read_b64_tr_b16 v[80:81], v28 offset:8192
    ds_read_b64_tr_b16 v[82:83], v28 offset:9216
    s_waitcnt lgkmcnt(6)
    v_mfma_f32_32x32x16_bf16 v[176:191], v[100:103], a[44:47], v[176:191]
    ds_read_b64_tr_b16 v[84:85], v29 offset:8192
    ds_read_b64_tr_b16 v[86:87], v29 offset:9216
    s_waitcnt lgkmcnt(6)
    v_mfma_f32_32x32x16_bf16 v[128:143], v[72:75], a[48:51], v[128:143]
    s_waitcnt vmcnt(15)
    s_add_u32 m0, s4, 24576
    s_nop 0
    buffer_load_dwordx4 v6, s[12:15], s60 offen lds
    s_waitcnt vmcnt(15)
    buffer_load_dwordx4 v7, s[12:15], s60 offen offset:1024 lds
    ds_read_b64_tr_b16 v[88:89], v26 offset:12288
    ds_read_b64_tr_b16 v[90:91], v26 offset:13312
    s_waitcnt lgkmcnt(6)
    v_mfma_f32_32x32x16_bf16 v[144:159], v[76:79], a[48:51], v[144:159]
    ds_read_b64_tr_b16 v[92:93], v27 offset:12288
    ds_read_b64_tr_b16 v[94:95], v27 offset:13312
    s_waitcnt lgkmcnt(6)
    v_mfma_f32_32x32x16_bf16 v[160:175], v[80:83], a[48:51], v[160:175]
    ds_read_b64_tr_b16 v[96:97], v28 offset:12288
    ds_read_b64_tr_b16 v[98:99], v28 offset:13312
    s_waitcnt lgkmcnt(6)
    v_mfma_f32_32x32x16_bf16 v[176:191], v[84:87], a[48:51], v[176:191]
    ds_read_b64_tr_b16 v[100:101], v29 offset:12288
    ds_read_b64_tr_b16 v[102:103], v29 offset:13312
    s_waitcnt lgkmcnt(6)
    v_mfma_f32_32x32x16_bf16 v[128:143], v[88:91], a[52:55], v[128:143]
    s_waitcnt vmcnt(15)
    buffer_load_dwordx4 v8, s[12:15], s60 offen offset:2048 lds
    s_waitcnt vmcnt(15)
    buffer_load_dwordx4 v9, s[12:15], s60 offen offset:3072 lds
    ds_read_b64_tr_b16 v[72:73], v26 offset:40960
    ds_read_b64_tr_b16 v[74:75], v26 offset:41984
    s_waitcnt lgkmcnt(6)
    v_mfma_f32_32x32x16_bf16 v[144:159], v[92:95], a[52:55], v[144:159]
    ds_read_b64_tr_b16 v[76:77], v27 offset:40960
    ds_read_b64_tr_b16 v[78:79], v27 offset:41984
    s_waitcnt lgkmcnt(6)
    v_mfma_f32_32x32x16_bf16 v[160:175], v[96:99], a[52:55], v[160:175]
    ds_read_b64_tr_b16 v[80:81], v28 offset:40960
    ds_read_b64_tr_b16 v[82:83], v28 offset:41984
    s_waitcnt lgkmcnt(6)
    v_mfma_f32_32x32x16_bf16 v[176:191], v[100:103], a[52:55], v[176:191]
    ds_read_b64_tr_b16 v[84:85], v29 offset:40960
    ds_read_b64_tr_b16 v[86:87], v29 offset:41984
    s_waitcnt lgkmcnt(6)
    v_mfma_f32_32x32x16_bf16 v[128:143], v[72:75], a[56:59], v[128:143]
    s_waitcnt vmcnt(15)
    s_add_u32 s61, s60, 131072
    s_add_u32 m0, s4, 28672
    s_nop 0
    buffer_load_dwordx4 v6, s[12:15], s61 offen lds
    s_waitcnt vmcnt(15)
    buffer_load_dwordx4 v7, s[12:15], s61 offen offset:1024 lds
    ds_read_b64_tr_b16 v[88:89], v26 offset:45056
    ds_read_b64_tr_b16 v[90:91], v26 offset:46080
    s_waitcnt lgkmcnt(6)
    v_mfma_f32_32x32x16_bf16 v[144:159], v[76:79], a[56:59], v[144:159]
    ds_read_b64_tr_b16 v[92:93], v27 offset:45056
    ds_read_b64_tr_b16 v[94:95], v27 offset:46080
    s_waitcnt lgkmcnt(6)
    v_mfma_f32_32x32x16_bf16 v[160:175], v[80:83], a[56:59], v[160:175]
    ds_read_b64_tr_b16 v[96:97], v28 offset:45056
    ds_read_b64_tr_b16 v[98:99], v28 offset:46080
    s_waitcnt lgkmcnt(6)
    v_mfma_f32_32x32x16_bf16 v[176:191], v[84:87], a[56:59], v[176:191]
    ds_read_b64_tr_b16 v[100:101], v29 offset:45056
    ds_read_b64_tr_b16 v[102:103], v29 offset:46080
    s_waitcnt lgkmcnt(0)
    s_waitcnt vmcnt(15)
    buffer_load_dwordx4 v8, s[12:15], s61 offen offset:2048 lds
    s_waitcnt vmcnt(15)
    buffer_load_dwordx4 v9, s[12:15], s61 offen offset:3072 lds
    s_add_u32 s7, s98, 2
    s_and_b32 s7, s7, 3
    s_lshl_b32 s7, s7, 1
    s_add_u32 s7, s7, s99
    s_lshl_b32 s7, s7, 20
    s_add_u32 s60, s63, s7
    s_waitcnt vmcnt(8)
    ds_read_b128 a[64:67], v10
    ds_read_b128 a[68:71], v11
    ds_read_b128 a[72:75], v12
    ds_read_b128 a[76:79], v13
    ds_read_b128 a[80:83], v14
    ds_read_b128 a[84:87], v15
    ds_read_b128 a[88:91], v16
    ds_read_b128 a[92:95], v17
    s_barrier
    v_mfma_f32_32x32x16_bf16 v[128:143], v[88:91], a[60:63], v[128:143]
    ds_read_b64_tr_b16 v[72:73], v22 offset:16384
    ds_read_b64_tr_b16 v[74:75], v22 offset:17408
    v_mfma_f32_32x32x16_bf16 v[144:159], v[92:95], a[60:63], v[144:159]
    ds_read_b64_tr_b16 v[76:77], v23 offset:16384
    ds_read_b64_tr_b16 v[78:79], v23 offset:17408
    v_mfma_f32_32x32x16_bf16 v[160:175], v[96:99], a[60:63], v[160:175]
    ds_read_b64_tr_b16 v[80:81], v24 offset:16384
    ds_read_b64_tr_b16 v[82:83], v24 offset:17408
    v_mfma_f32_32x32x16_bf16 v[176:191], v[100:103], a[60:63], v[176:191]
    ds_read_b64_tr_b16 v[84:85], v25 offset:16384
    ds_read_b64_tr_b16 v[86:87], v25 offset:17408
    s_waitcnt lgkmcnt(6)
    v_mfma_f32_32x32x16_bf16 v[128:143], v[72:75], a[64:67], v[128:143]
    s_add_u32 m0, s69, 0
    s_nop 0
    buffer_load_dwordx4 v2, s[8:11], s56 offen lds
    buffer_load_dwordx4 v3, s[8:11], s56 offen offset:1024 lds
    ds_read_b64_tr_b16 v[88:89], v22 offset:20480
    ds_read_b64_tr_b16 v[90:91], v22 offset:21504
    s_waitcnt lgkmcnt(6)
    v_mfma_f32_32x32x16_bf16 v[144:159], v[76:79], a[64:67], v[144:159]
    ds_read_b64_tr_b16 v[92:93], v23 offset:20480
    ds_read_b64_tr_b16 v[94:95], v23 offset:21504
    s_waitcnt lgkmcnt(6)
    v_mfma_f32_32x32x16_bf16 v[160:175], v[80:83], a[64:67], v[160:175]
    ds_read_b64_tr_b16 v[96:97], v24 offset:20480
    ds_read_b64_tr_b16 v[98:99], v24 offset:21504
    s_waitcnt lgkmcnt(6)
    v_mfma_f32_32x32x16_bf16 v[176:191], v[84:87], a[64:67], v[176:191]
    ds_read_b64_tr_b16 v[100:101], v25 offset:20480
    ds_read_b64_tr_b16 v[102:103], v25 offset:21504
    s_waitcnt lgkmcnt(6)
    v_mfma_f32_32x32x16_bf16 v[128:143], v[88:91], a[68:71], v[128:143]
    buffer_load_dwordx4 v4, s[8:11], s56 offen offset:2048 lds
    buffer_load_dwordx4 v5, s[8:11], s56 offen offset:3072 lds
    ds_read_b64_tr_b16 v[72:73], v22 offset:49152
    ds_read_b64_tr_b16 v[74:75], v22 offset:50176
    s_waitcnt lgkmcnt(6)
    v_mfma_f32_32x32x16_bf16 v[144:159], v[92:95], a[68:71], v[144:159]
    ds_read_b64_tr_b16 v[76:77], v23 offset:49152
    ds_read_b64_tr_b16 v[78:79], v23 offset:50176
    s_waitcnt lgkmcnt(6)
    v_mfma_f32_32x32x16_bf16 v[160:175], v[96:99], a[68:71], v[160:175]
    ds_read_b64_tr_b16 v[80:81], v24 offset:49152
    ds_read_b64_tr_b16 v[82:83], v24 offset:50176
    s_waitcnt lgkmcnt(6)
    v_mfma_f32_32x32x16_bf16 v[176:191], v[100:103], a[68:71], v[176:191]
    ds_read_b64_tr_b16 v[84:85], v25 offset:49152
    ds_read_b64_tr_b16 v[86:87], v25 offset:50176
    s_waitcnt lgkmcnt(6)
    v_mfma_f32_32x32x16_bf16 v[128:143], v[72:75], a[72:75], v[128:143]
    s_add_u32 s57, s56, 32768
    s_add_u32 m0, s69, 4096
    s_nop 0
    buffer_load_dwordx4 v2, s[8:11], s57 offen lds
    buffer_load_dwordx4 v3, s[8:11], s57 offen offset:1024 lds
    ds_read_b64_tr_b16 v[88:89], v22 offset:53248
    ds_read_b64_tr_b16 v[90:91], v22 offset:54272
    s_waitcnt lgkmcnt(6)
    v_mfma_f32_32x32x16_bf16 v[144:159], v[76:79], a[72:75], v[144:159]
    ds_read_b64_tr_b16 v[92:93], v23 offset:53248
    ds_read_b64_tr_b16 v[94:95], v23 offset:54272
    s_waitcnt lgkmcnt(6)
    v_mfma_f32_32x32x16_bf16 v[160:175], v[80:83], a[72:75], v[160:175]
    ds_read_b64_tr_b16 v[96:97], v24 offset:53248
    ds_read_b64_tr_b16 v[98:99], v24 offset:54272
    s_waitcnt lgkmcnt(6)
    v_mfma_f32_32x32x16_bf16 v[176:191], v[84:87], a[72:75], v[176:191]
    ds_read_b64_tr_b16 v[100:101], v25 offset:53248
    ds_read_b64_tr_b16 v[102:103], v25 offset:54272
    s_waitcnt lgkmcnt(6)
    v_mfma_f32_32x32x16_bf16 v[128:143], v[88:91], a[76:79], v[128:143]
    buffer_load_dwordx4 v4, s[8:11], s57 offen offset:2048 lds
    buffer_load_dwordx4 v5, s[8:11], s57 offen offset:3072 lds
    s_add_u32 s7, s98, 2
    s_and_b32 s7, s7, 3
    s_lshl_b32 s7, s7, 1
    s_add_u32 s7, s7, s99
    s_lshl_b32 s7, s7, 8
    s_add_u32 s56, s59, s7
    ds_read_b64_tr_b16 v[72:73], v26 offset:16384
    ds_read_b64_tr_b16 v[74:75], v26 offset:17408
    s_waitcnt lgkmcnt(6)
    v_mfma_f32_32x32x16_bf16 v[144:159], v[92:95], a[76:79], v[144:159]
    ds_read_b64_tr_b16 v[76:77], v27 offset:16384
    ds_read_b64_tr_b16 v[78:79], v27 offset:17408
    s_waitcnt lgkmcnt(6)
    v_mfma_f32_32x32x16_bf16 v[160:175], v[96:99], a[76:79], v[160:175]
    ds_read_b64_tr_b16 v[80:81], v28 offset:16384
    ds_read_b64_tr_b16 v[82:83], v28 offset:17408
    s_waitcnt lgkmcnt(6)
    v_mfma_f32_32x32x16_bf16 v[176:191], v[100:103], a[76:79], v[176:191]
    ds_read_b64_tr_b16 v[84:85], v29 offset:16384
    ds_read_b64_tr_b16 v[86:87], v29 offset:17408
    s_waitcnt lgkmcnt(6)
    v_mfma_f32_32x32x16_bf16 v[128:143], v[72:75], a[80:83], v[128:143]
    s_waitcnt vmcnt(15)
    s_add_u32 m0, s4, 0
    s_nop 0
    buffer_load_dwordx4 v6, s[12:15], s60 offen lds
    s_waitcnt vmcnt(15)
    buffer_load_dwordx4 v7, s[12:15], s60 offen offset:1024 lds
    ds_read_b64_tr_b16 v[88:89], v26 offset:20480
    ds_read_b64_tr_b16 v[90:91], v26 offset:21504
    s_waitcnt lgkmcnt(6)
    v_mfma_f32_32x32x16_bf16 v[144:159], v[76:79], a[80:83], v[144:159]
    ds_read_b64_tr_b16 v[92:93], v27 offset:20480
    ds_read_b64_tr_b16 v[94:95], v27 offset:21504
    s_waitcnt lgkmcnt(6)
    v_mfma_f32_32x32x16_bf16 v[160:175], v[80:83], a[80:83], v[160:175]
    ds_read_b64_tr_b16 v[96:97], v28 offset:20480
    ds_read_b64_tr_b16 v[98:99], v28 offset:21504
    s_waitcnt lgkmcnt(6)
    v_mfma_f32_32x32x16_bf16 v[176:191], v[84:87], a[80:83], v[176:191]
    ds_read_b64_tr_b16 v[100:101], v29 offset:20480
    ds_read_b64_tr_b16 v[102:103], v29 offset:21504
    s_waitcnt lgkmcnt(6)
    v_mfma_f32_32x32x16_bf16 v[128:143], v[88:91], a[84:87], v[128:143]
    s_waitcnt vmcnt(15)
    buffer_load_dwordx4 v8, s[12:15], s60 offen offset:2048 lds
    s_waitcnt vmcnt(15)
    buffer_load_dwordx4 v9, s[12:15], s60 offen offset:3072 lds
    ds_read_b64_tr_b16 v[72:73], v26 offset:49152
    ds_read_b64_tr_b16 v[74:75], v26 offset:50176
    s_waitcnt lgkmcnt(6)
    v_mfma_f32_32x32x16_bf16 v[144:159], v[92:95], a[84:87], v[144:159]
    ds_read_b64_tr_b16 v[76:77], v27 offset:49152
    ds_read_b64_tr_b16 v[78:79], v27 offset:50176
    s_waitcnt lgkmcnt(6)
    v_mfma_f32_32x32x16_bf16 v[160:175], v[96:99], a[84:87], v[160:175]
    ds_read_b64_tr_b16 v[80:81], v28 offset:49152
    ds_read_b64_tr_b16 v[82:83], v28 offset:50176
    s_waitcnt lgkmcnt(6)
    v_mfma_f32_32x32x16_bf16 v[176:191], v[100:103], a[84:87], v[176:191]
    ds_read_b64_tr_b16 v[84:85], v29 offset:49152
    ds_read_b64_tr_b16 v[86:87], v29 offset:50176
    s_waitcnt lgkmcnt(6)
    v_mfma_f32_32x32x16_bf16 v[128:143], v[72:75], a[88:91], v[128:143]
    s_waitcnt vmcnt(15)
    s_add_u32 s61, s60, 131072
    s_add_u32 m0, s4, 4096
    s_nop 0
    buffer_load_dwordx4 v6, s[12:15], s61 offen lds
    s_waitcnt vmcnt(15)
    buffer_load_dwordx4 v7, s[12:15], s61 offen offset:1024 lds
    ds_read_b64_tr_b16 v[88:89], v26 offset:53248
    ds_read_b64_tr_b16 v[90:91], v26 offset:54272
    s_waitcnt lgkmcnt(6)
    v_mfma_f32_32x32x16_bf16 v[144:159], v[76:79], a[88:91], v[144:159]
    ds_read_b64_tr_b16 v[92:93], v27 offset:53248
    ds_read_b64_tr_b16 v[94:95], v27 offset:54272
    s_waitcnt lgkmcnt(6)
    v_mfma_f32_32x32x16_bf16 v[160:175], v[80:83], a[88:91], v[160:175]
    ds_read_b64_tr_b16 v[96:97], v28 offset:53248
    ds_read_b64_tr_b16 v[98:99], v28 offset:54272
    s_waitcnt lgkmcnt(6)
    v_mfma_f32_32x32x16_bf16 v[176:191], v[84:87], a[88:91], v[176:191]
    ds_read_b64_tr_b16 v[100:101], v29 offset:53248
    ds_read_b64_tr_b16 v[102:103], v29 offset:54272
    s_waitcnt lgkmcnt(0)
    s_waitcnt vmcnt(15)
    buffer_load_dwordx4 v8, s[12:15], s61 offen offset:2048 lds
    s_waitcnt vmcnt(15)
    buffer_load_dwordx4 v9, s[12:15], s61 offen offset:3072 lds
    s_add_u32 s7, s98, 2
    s_and_b32 s7, s7, 3
    s_lshl_b32 s7, s7, 1
    s_add_u32 s7, s7, s99
    s_xor_b32 s7, s7, 1
    s_lshl_b32 s7, s7, 20
    s_add_u32 s60, s63, s7
    s_waitcnt vmcnt(8)
    ds_read_b128 a[96:99], v10
    ds_read_b128 a[100:103], v11
    ds_read_b128 a[104:107], v12
    ds_read_b128 a[108:111], v13
    ds_read_b128 a[112:115], v14
    ds_read_b128 a[116:119], v15
    ds_read_b128 a[120:123], v16
    ds_read_b128 a[124:127], v17
    s_barrier
    v_mfma_f32_32x32x16_bf16 v[128:143], v[88:91], a[92:95], v[128:143]
    ds_read_b64_tr_b16 v[72:73], v22 offset:24576
    ds_read_b64_tr_b16 v[74:75], v22 offset:25600
    v_mfma_f32_32x32x16_bf16 v[144:159], v[92:95], a[92:95], v[144:159]
    ds_read_b64_tr_b16 v[76:77], v23 offset:24576
    ds_read_b64_tr_b16 v[78:79], v23 offset:25600
    v_mfma_f32_32x32x16_bf16 v[160:175], v[96:99], a[92:95], v[160:175]
    ds_read_b64_tr_b16 v[80:81], v24 offset:24576
    ds_read_b64_tr_b16 v[82:83], v24 offset:25600
    v_mfma_f32_32x32x16_bf16 v[176:191], v[100:103], a[92:95], v[176:191]
    ds_read_b64_tr_b16 v[84:85], v25 offset:24576
    ds_read_b64_tr_b16 v[86:87], v25 offset:25600
    s_waitcnt lgkmcnt(6)
    v_mfma_f32_32x32x16_bf16 v[128:143], v[72:75], a[96:99], v[128:143]
    s_add_u32 m0, s69, 0
    s_nop 0
    buffer_load_dwordx4 v2, s[8:11], s56 offen lds
    buffer_load_dwordx4 v3, s[8:11], s56 offen offset:1024 lds
    ds_read_b64_tr_b16 v[88:89], v22 offset:28672
    ds_read_b64_tr_b16 v[90:91], v22 offset:29696
    s_waitcnt lgkmcnt(6)
    v_mfma_f32_32x32x16_bf16 v[144:159], v[76:79], a[96:99], v[144:159]
    ds_read_b64_tr_b16 v[92:93], v23 offset:28672
    ds_read_b64_tr_b16 v[94:95], v23 offset:29696
    s_waitcnt lgkmcnt(6)
    v_mfma_f32_32x32x16_bf16 v[160:175], v[80:83], a[96:99], v[160:175]
    ds_read_b64_tr_b16 v[96:97], v24 offset:28672
    ds_read_b64_tr_b16 v[98:99], v24 offset:29696
    s_waitcnt lgkmcnt(6)
    v_mfma_f32_32x32x16_bf16 v[176:191], v[84:87], a[96:99], v[176:191]
    ds_read_b64_tr_b16 v[100:101], v25 offset:28672
    ds_read_b64_tr_b16 v[102:103], v25 offset:29696
    s_waitcnt lgkmcnt(6)
    v_mfma_f32_32x32x16_bf16 v[128:143], v[88:91], a[100:103], v[128:143]
    buffer_load_dwordx4 v4, s[8:11], s56 offen offset:2048 lds
    buffer_load_dwordx4 v5, s[8:11], s56 offen offset:3072 lds
    ds_read_b64_tr_b16 v[72:73], v22 offset:57344
    ds_read_b64_tr_b16 v[74:75], v22 offset:58368
    s_waitcnt lgkmcnt(6)
    v_mfma_f32_32x32x16_bf16 v[144:159], v[92:95], a[100:103], v[144:159]
    ds_read_b64_tr_b16 v[76:77], v23 offset:57344
    ds_read_b64_tr_b16 v[78:79], v23 offset:58368
    s_waitcnt lgkmcnt(6)
    v_mfma_f32_32x32x16_bf16 v[160:175], v[96:99], a[100:103], v[160:175]
    ds_read_b64_tr_b16 v[80:81], v24 offset:57344
    ds_read_b64_tr_b16 v[82:83], v24 offset:58368
    s_waitcnt lgkmcnt(6)
    v_mfma_f32_32x32x16_bf16 v[176:191], v[100:103], a[100:103], v[176:191]
    ds_read_b64_tr_b16 v[84:85], v25 offset:57344
    ds_read_b64_tr_b16 v[86:87], v25 offset:58368
    s_waitcnt lgkmcnt(6)
    v_mfma_f32_32x32x16_bf16 v[128:143], v[72:75], a[104:107], v[128:143]
    s_add_u32 s57, s56, 32768
    s_add_u32 m0, s69, 4096
    s_nop 0
    buffer_load_dwordx4 v2, s[8:11], s57 offen lds
    buffer_load_dwordx4 v3, s[8:11], s57 offen offset:1024 lds
    ds_read_b64_tr_b16 v[88:89], v22 offset:61440
    ds_read_b64_tr_b16 v[90:91], v22 offset:62464
    s_waitcnt lgkmcnt(6)
    v_mfma_f32_32x32x16_bf16 v[144:159], v[76:79], a[104:107], v[144:159]
    ds_read_b64_tr_b16 v[92:93], v23 offset:61440
    ds_read_b64_tr_b16 v[94:95], v23 offset:62464
    s_waitcnt lgkmcnt(6)
    v_mfma_f32_32x32x16_bf16 v[160:175], v[80:83], a[104:107], v[160:175]
    ds_read_b64_tr_b16 v[96:97], v24 offset:61440
    ds_read_b64_tr_b16 v[98:99], v24 offset:62464
    s_waitcnt lgkmcnt(6)
    v_mfma_f32_32x32x16_bf16 v[176:191], v[84:87], a[104:107], v[176:191]
    ds_read_b64_tr_b16 v[100:101], v25 offset:61440
    ds_read_b64_tr_b16 v[102:103], v25 offset:62464
    s_waitcnt lgkmcnt(6)
    v_mfma_f32_32x32x16_bf16 v[128:143], v[88:91], a[108:111], v[128:143]
    buffer_load_dwordx4 v4, s[8:11], s57 offen offset:2048 lds
    buffer_load_dwordx4 v5, s[8:11], s57 offen offset:3072 lds
    s_add_u32 s7, s98, 2
    s_and_b32 s7, s7, 3
    s_lshl_b32 s7, s7, 1
    s_add_u32 s7, s7, s99
    s_xor_b32 s7, s7, 1
    s_lshl_b32 s7, s7, 8
    s_add_u32 s56, s59, s7
    ds_read_b64_tr_b16 v[72:73], v26 offset:24576
    ds_read_b64_tr_b16 v[74:75], v26 offset:25600
    s_waitcnt lgkmcnt(6)
    v_mfma_f32_32x32x16_bf16 v[144:159], v[92:95], a[108:111], v[144:159]
    ds_read_b64_tr_b16 v[76:77], v27 offset:24576
    ds_read_b64_tr_b16 v[78:79], v27 offset:25600
    s_waitcnt lgkmcnt(6)
    v_mfma_f32_32x32x16_bf16 v[160:175], v[96:99], a[108:111], v[160:175]
    ds_read_b64_tr_b16 v[80:81], v28 offset:24576
    ds_read_b64_tr_b16 v[82:83], v28 offset:25600
    s_waitcnt lgkmcnt(6)
    v_mfma_f32_32x32x16_bf16 v[176:191], v[100:103], a[108:111], v[176:191]
    ds_read_b64_tr_b16 v[84:85], v29 offset:24576
    ds_read_b64_tr_b16 v[86:87], v29 offset:25600
    s_waitcnt lgkmcnt(6)
    v_mfma_f32_32x32x16_bf16 v[128:143], v[72:75], a[112:115], v[128:143]
    s_waitcnt vmcnt(15)
    s_add_u32 m0, s4, 8192
    s_nop 0
    buffer_load_dwordx4 v6, s[12:15], s60 offen lds
    s_waitcnt vmcnt(15)
    buffer_load_dwordx4 v7, s[12:15], s60 offen offset:1024 lds
    ds_read_b64_tr_b16 v[88:89], v26 offset:28672
    ds_read_b64_tr_b16 v[90:91], v26 offset:29696
    s_waitcnt lgkmcnt(6)
    v_mfma_f32_32x32x16_bf16 v[144:159], v[76:79], a[112:115], v[144:159]
    ds_read_b64_tr_b16 v[92:93], v27 offset:28672
    ds_read_b64_tr_b16 v[94:95], v27 offset:29696
    s_waitcnt lgkmcnt(6)
    v_mfma_f32_32x32x16_bf16 v[160:175], v[80:83], a[112:115], v[160:175]
    ds_read_b64_tr_b16 v[96:97], v28 offset:28672
    ds_read_b64_tr_b16 v[98:99], v28 offset:29696
    s_waitcnt lgkmcnt(6)
    v_mfma_f32_32x32x16_bf16 v[176:191], v[84:87], a[112:115], v[176:191]
    ds_read_b64_tr_b16 v[100:101], v29 offset:28672
    ds_read_b64_tr_b16 v[102:103], v29 offset:29696
    s_waitcnt lgkmcnt(6)
    v_mfma_f32_32x32x16_bf16 v[128:143], v[88:91], a[116:119], v[128:143]
    s_waitcnt vmcnt(15)
    buffer_load_dwordx4 v8, s[12:15], s60 offen offset:2048 lds
    s_waitcnt vmcnt(15)
    buffer_load_dwordx4 v9, s[12:15], s60 offen offset:3072 lds
    ds_read_b64_tr_b16 v[72:73], v26 offset:57344
    ds_read_b64_tr_b16 v[74:75], v26 offset:58368
    s_waitcnt lgkmcnt(6)
    v_mfma_f32_32x32x16_bf16 v[144:159], v[92:95], a[116:119], v[144:159]
    ds_read_b64_tr_b16 v[76:77], v27 offset:57344
    ds_read_b64_tr_b16 v[78:79], v27 offset:58368
    s_waitcnt lgkmcnt(6)
    v_mfma_f32_32x32x16_bf16 v[160:175], v[96:99], a[116:119], v[160:175]
    ds_read_b64_tr_b16 v[80:81], v28 offset:57344
    ds_read_b64_tr_b16 v[82:83], v28 offset:58368
    s_waitcnt lgkmcnt(6)
    v_mfma_f32_32x32x16_bf16 v[176:191], v[100:103], a[116:119], v[176:191]
    ds_read_b64_tr_b16 v[84:85], v29 offset:57344
    ds_read_b64_tr_b16 v[86:87], v29 offset:58368
    s_waitcnt lgkmcnt(6)
    v_mfma_f32_32x32x16_bf16 v[128:143], v[72:75], a[120:123], v[128:143]
    s_waitcnt vmcnt(15)
    s_add_u32 s61, s60, 131072
    s_add_u32 m0, s4, 12288
    s_nop 0
    buffer_load_dwordx4 v6, s[12:15], s61 offen lds
    s_waitcnt vmcnt(15)
    buffer_load_dwordx4 v7, s[12:15], s61 offen offset:1024 lds
    ds_read_b64_tr_b16 v[88:89], v26 offset:61440
    ds_read_b64_tr_b16 v[90:91], v26 offset:62464
    s_waitcnt lgkmcnt(6)
    v_mfma_f32_32x32x16_bf16 v[144:159], v[76:79], a[120:123], v[144:159]
    ds_read_b64_tr_b16 v[92:93], v27 offset:61440
    ds_read_b64_tr_b16 v[94:95], v27 offset:62464
    s_waitcnt lgkmcnt(6)
    v_mfma_f32_32x32x16_bf16 v[160:175], v[80:83], a[120:123], v[160:175]
    ds_read_b64_tr_b16 v[96:97], v28 offset:61440
    ds_read_b64_tr_b16 v[98:99], v28 offset:62464
    s_waitcnt lgkmcnt(6)
    v_mfma_f32_32x32x16_bf16 v[176:191], v[84:87], a[120:123], v[176:191]
    ds_read_b64_tr_b16 v[100:101], v29 offset:61440
    ds_read_b64_tr_b16 v[102:103], v29 offset:62464
    s_waitcnt lgkmcnt(0)
    s_waitcnt vmcnt(15)
    buffer_load_dwordx4 v8, s[12:15], s61 offen offset:2048 lds
    s_waitcnt vmcnt(15)
    buffer_load_dwordx4 v9, s[12:15], s61 offen offset:3072 lds
    s_add_u32 s7, s98, 3
    s_and_b32 s7, s7, 3
    s_lshl_b32 s7, s7, 1
    s_add_u32 s7, s7, s99
    s_lshl_b32 s7, s7, 20
    s_add_u32 s60, s63, s7
    s_waitcnt vmcnt(8)
    ds_read_b128 a[128:131], v10
    ds_read_b128 a[132:135], v11
    ds_read_b128 a[136:139], v12
    ds_read_b128 a[140:143], v13
    ds_read_b128 a[144:147], v14
    ds_read_b128 a[148:151], v15
    ds_read_b128 a[152:155], v16
    ds_read_b128 a[156:159], v17
    s_barrier
    v_mfma_f32_32x32x16_bf16 v[128:143], v[88:91], a[124:127], v[128:143]
    ds_read_b64_tr_b16 v[72:73], v22 offset:0
    ds_read_b64_tr_b16 v[74:75], v22 offset:1024
    v_mfma_f32_32x32x16_bf16 v[144:159], v[92:95], a[124:127], v[144:159]
    ds_read_b64_tr_b16 v[76:77], v23 offset:0
    ds_read_b64_tr_b16 v[78:79], v23 offset:1024
    v_mfma_f32_32x32x16_bf16 v[160:175], v[96:99], a[124:127], v[160:175]
    ds_read_b64_tr_b16 v[80:81], v24 offset:0
    ds_read_b64_tr_b16 v[82:83], v24 offset:1024
    v_mfma_f32_32x32x16_bf16 v[176:191], v[100:103], a[124:127], v[176:191]
    ds_read_b64_tr_b16 v[84:85], v25 offset:0
    ds_read_b64_tr_b16 v[86:87], v25 offset:1024
    s_waitcnt lgkmcnt(6)
    v_mfma_f32_32x32x16_bf16 v[128:143], v[72:75], a[128:131], v[128:143]
    s_add_u32 m0, s69, 0
    s_nop 0
    buffer_load_dwordx4 v2, s[8:11], s56 offen lds
    buffer_load_dwordx4 v3, s[8:11], s56 offen offset:1024 lds
    ds_read_b64_tr_b16 v[88:89], v22 offset:4096
    ds_read_b64_tr_b16 v[90:91], v22 offset:5120
    s_waitcnt lgkmcnt(6)
    v_mfma_f32_32x32x16_bf16 v[144:159], v[76:79], a[128:131], v[144:159]
    ds_read_b64_tr_b16 v[92:93], v23 offset:4096
    ds_read_b64_tr_b16 v[94:95], v23 offset:5120
    s_waitcnt lgkmcnt(6)
    v_mfma_f32_32x32x16_bf16 v[160:175], v[80:83], a[128:131], v[160:175]
    ds_read_b64_tr_b16 v[96:97], v24 offset:4096
    ds_read_b64_tr_b16 v[98:99], v24 offset:5120
    s_waitcnt lgkmcnt(6)
    v_mfma_f32_32x32x16_bf16 v[176:191], v[84:87], a[128:131], v[176:191]
    ds_read_b64_tr_b16 v[100:101], v25 offset:4096
    ds_read_b64_tr_b16 v[102:103], v25 offset:5120
    s_waitcnt lgkmcnt(6)
    v_mfma_f32_32x32x16_bf16 v[128:143], v[88:91], a[132:135], v[128:143]
    buffer_load_dwordx4 v4, s[8:11], s56 offen offset:2048 lds
    buffer_load_dwordx4 v5, s[8:11], s56 offen offset:3072 lds
    ds_read_b64_tr_b16 v[72:73], v22 offset:32768
    ds_read_b64_tr_b16 v[74:75], v22 offset:33792
    s_waitcnt lgkmcnt(6)
    v_mfma_f32_32x32x16_bf16 v[144:159], v[92:95], a[132:135], v[144:159]
    ds_read_b64_tr_b16 v[76:77], v23 offset:32768
    ds_read_b64_tr_b16 v[78:79], v23 offset:33792
    s_waitcnt lgkmcnt(6)
    v_mfma_f32_32x32x16_bf16 v[160:175], v[96:99], a[132:135], v[160:175]
    ds_read_b64_tr_b16 v[80:81], v24 offset:32768
    ds_read_b64_tr_b16 v[82:83], v24 offset:33792
    s_waitcnt lgkmcnt(6)
    v_mfma_f32_32x32x16_bf16 v[176:191], v[100:103], a[132:135], v[176:191]
    ds_read_b64_tr_b16 v[84:85], v25 offset:32768
    ds_read_b64_tr_b16 v[86:87], v25 offset:33792
    s_waitcnt lgkmcnt(6)
    v_mfma_f32_32x32x16_bf16 v[128:143], v[72:75], a[136:139], v[128:143]
    s_add_u32 s57, s56, 32768
    s_add_u32 m0, s69, 4096
    s_nop 0
    buffer_load_dwordx4 v2, s[8:11], s57 offen lds
    buffer_load_dwordx4 v3, s[8:11], s57 offen offset:1024 lds
    ds_read_b64_tr_b16 v[88:89], v22 offset:36864
    ds_read_b64_tr_b16 v[90:91], v22 offset:37888
    s_waitcnt lgkmcnt(6)
    v_mfma_f32_32x32x16_bf16 v[144:159], v[76:79], a[136:139], v[144:159]
    ds_read_b64_tr_b16 v[92:93], v23 offset:36864
    ds_read_b64_tr_b16 v[94:95], v23 offset:37888
    s_waitcnt lgkmcnt(6)
    v_mfma_f32_32x32x16_bf16 v[160:175], v[80:83], a[136:139], v[160:175]
    ds_read_b64_tr_b16 v[96:97], v24 offset:36864
    ds_read_b64_tr_b16 v[98:99], v24 offset:37888
    s_waitcnt lgkmcnt(6)
    v_mfma_f32_32x32x16_bf16 v[176:191], v[84:87], a[136:139], v[176:191]
    ds_read_b64_tr_b16 v[100:101], v25 offset:36864
    ds_read_b64_tr_b16 v[102:103], v25 offset:37888
    s_waitcnt lgkmcnt(6)
    v_mfma_f32_32x32x16_bf16 v[128:143], v[88:91], a[140:143], v[128:143]
    buffer_load_dwordx4 v4, s[8:11], s57 offen offset:2048 lds
    buffer_load_dwordx4 v5, s[8:11], s57 offen offset:3072 lds
    s_add_u32 s7, s98, 3
    s_and_b32 s7, s7, 3
    s_lshl_b32 s7, s7, 1
    s_add_u32 s7, s7, s99
    s_lshl_b32 s7, s7, 8
    s_add_u32 s56, s59, s7
    ds_read_b64_tr_b16 v[72:73], v26 offset:0
    ds_read_b64_tr_b16 v[74:75], v26 offset:1024
    s_waitcnt lgkmcnt(6)
    v_mfma_f32_32x32x16_bf16 v[144:159], v[92:95], a[140:143], v[144:159]
    ds_read_b64_tr_b16 v[76:77], v27 offset:0
    ds_read_b64_tr_b16 v[78:79], v27 offset:1024
    s_waitcnt lgkmcnt(6)
    v_mfma_f32_32x32x16_bf16 v[160:175], v[96:99], a[140:143], v[160:175]
    ds_read_b64_tr_b16 v[80:81], v28 offset:0
    ds_read_b64_tr_b16 v[82:83], v28 offset:1024
    s_waitcnt lgkmcnt(6)
    v_mfma_f32_32x32x16_bf16 v[176:191], v[100:103], a[140:143], v[176:191]
    ds_read_b64_tr_b16 v[84:85], v29 offset:0
    ds_read_b64_tr_b16 v[86:87], v29 offset:1024
    s_waitcnt lgkmcnt(6)
    v_mfma_f32_32x32x16_bf16 v[128:143], v[72:75], a[144:147], v[128:143]
    s_waitcnt vmcnt(15)
    s_add_u32 m0, s4, 16384
    s_nop 0
    buffer_load_dwordx4 v6, s[12:15], s60 offen lds
    s_waitcnt vmcnt(15)
    buffer_load_dwordx4 v7, s[12:15], s60 offen offset:1024 lds
    ds_read_b64_tr_b16 v[88:89], v26 offset:4096
    ds_read_b64_tr_b16 v[90:91], v26 offset:5120
    s_waitcnt lgkmcnt(6)
    v_mfma_f32_32x32x16_bf16 v[144:159], v[76:79], a[144:147], v[144:159]
    ds_read_b64_tr_b16 v[92:93], v27 offset:4096
    ds_read_b64_tr_b16 v[94:95], v27 offset:5120
    s_waitcnt lgkmcnt(6)
    v_mfma_f32_32x32x16_bf16 v[160:175], v[80:83], a[144:147], v[160:175]
    ds_read_b64_tr_b16 v[96:97], v28 offset:4096
    ds_read_b64_tr_b16 v[98:99], v28 offset:5120
    s_waitcnt lgkmcnt(6)
    v_mfma_f32_32x32x16_bf16 v[176:191], v[84:87], a[144:147], v[176:191]
    ds_read_b64_tr_b16 v[100:101], v29 offset:4096
    ds_read_b64_tr_b16 v[102:103], v29 offset:5120
    s_waitcnt lgkmcnt(6)
    v_mfma_f32_32x32x16_bf16 v[128:143], v[88:91], a[148:151], v[128:143]
    s_waitcnt vmcnt(15)
    buffer_load_dwordx4 v8, s[12:15], s60 offen offset:2048 lds
    s_waitcnt vmcnt(15)
    buffer_load_dwordx4 v9, s[12:15], s60 offen offset:3072 lds
    ds_read_b64_tr_b16 v[72:73], v26 offset:32768
    ds_read_b64_tr_b16 v[74:75], v26 offset:33792
    s_waitcnt lgkmcnt(6)
    v_mfma_f32_32x32x16_bf16 v[144:159], v[92:95], a[148:151], v[144:159]
    ds_read_b64_tr_b16 v[76:77], v27 offset:32768
    ds_read_b64_tr_b16 v[78:79], v27 offset:33792
    s_waitcnt lgkmcnt(6)
    v_mfma_f32_32x32x16_bf16 v[160:175], v[96:99], a[148:151], v[160:175]
    ds_read_b64_tr_b16 v[80:81], v28 offset:32768
    ds_read_b64_tr_b16 v[82:83], v28 offset:33792
    s_waitcnt lgkmcnt(6)
    v_mfma_f32_32x32x16_bf16 v[176:191], v[100:103], a[148:151], v[176:191]
    ds_read_b64_tr_b16 v[84:85], v29 offset:32768
    ds_read_b64_tr_b16 v[86:87], v29 offset:33792
    s_waitcnt lgkmcnt(6)
    v_mfma_f32_32x32x16_bf16 v[128:143], v[72:75], a[152:155], v[128:143]
    s_waitcnt vmcnt(15)
    s_add_u32 s61, s60, 131072
    s_add_u32 m0, s4, 20480
    s_nop 0
    buffer_load_dwordx4 v6, s[12:15], s61 offen lds
    s_waitcnt vmcnt(15)
    buffer_load_dwordx4 v7, s[12:15], s61 offen offset:1024 lds
    ds_read_b64_tr_b16 v[88:89], v26 offset:36864
    ds_read_b64_tr_b16 v[90:91], v26 offset:37888
    s_waitcnt lgkmcnt(6)
    v_mfma_f32_32x32x16_bf16 v[144:159], v[76:79], a[152:155], v[144:159]
    ds_read_b64_tr_b16 v[92:93], v27 offset:36864
    ds_read_b64_tr_b16 v[94:95], v27 offset:37888
    s_waitcnt lgkmcnt(6)
    v_mfma_f32_32x32x16_bf16 v[160:175], v[80:83], a[152:155], v[160:175]
    ds_read_b64_tr_b16 v[96:97], v28 offset:36864
    ds_read_b64_tr_b16 v[98:99], v28 offset:37888
    s_waitcnt lgkmcnt(6)
    v_mfma_f32_32x32x16_bf16 v[176:191], v[84:87], a[152:155], v[176:191]
    ds_read_b64_tr_b16 v[100:101], v29 offset:36864
    ds_read_b64_tr_b16 v[102:103], v29 offset:37888
    s_waitcnt lgkmcnt(0)
    s_waitcnt vmcnt(15)
    buffer_load_dwordx4 v8, s[12:15], s61 offen offset:2048 lds
    s_waitcnt vmcnt(15)
    buffer_load_dwordx4 v9, s[12:15], s61 offen offset:3072 lds
    s_add_u32 s7, s98, 3
    s_and_b32 s7, s7, 3
    s_lshl_b32 s7, s7, 1
    s_add_u32 s7, s7, s99
    s_xor_b32 s7, s7, 1
    s_lshl_b32 s7, s7, 20
    s_add_u32 s60, s63, s7
    s_waitcnt vmcnt(8)
    ds_read_b128 a[160:163], v10
    ds_read_b128 a[164:167], v11
    ds_read_b128 a[168:171], v12
    ds_read_b128 a[172:175], v13
    ds_read_b128 a[176:179], v14
    ds_read_b128 a[180:183], v15
    ds_read_b128 a[184:187], v16
    ds_read_b128 a[188:191], v17
    s_barrier
    v_mfma_f32_32x32x16_bf16 v[128:143], v[88:91], a[156:159], v[128:143]
    ds_read_b64_tr_b16 v[72:73], v22 offset:8192
    ds_read_b64_tr_b16 v[74:75], v22 offset:9216
    v_mfma_f32_32x32x16_bf16 v[144:159], v[92:95], a[156:159], v[144:159]
    ds_read_b64_tr_b16 v[76:77], v23 offset:8192
    ds_read_b64_tr_b16 v[78:79], v23 offset:9216
    v_mfma_f32_32x32x16_bf16 v[160:175], v[96:99], a[156:159], v[160:175]
    ds_read_b64_tr_b16 v[80:81], v24 offset:8192
    ds_read_b64_tr_b16 v[82:83], v24 offset:9216
    v_mfma_f32_32x32x16_bf16 v[176:191], v[100:103], a[156:159], v[176:191]
    ds_read_b64_tr_b16 v[84:85], v25 offset:8192
    ds_read_b64_tr_b16 v[86:87], v25 offset:9216
    s_waitcnt lgkmcnt(6)
    v_mfma_f32_32x32x16_bf16 v[128:143], v[72:75], a[160:163], v[128:143]
    s_add_u32 m0, s69, 0
    s_nop 0
    buffer_load_dwordx4 v2, s[8:11], s56 offen lds
    buffer_load_dwordx4 v3, s[8:11], s56 offen offset:1024 lds
    ds_read_b64_tr_b16 v[88:89], v22 offset:12288
    ds_read_b64_tr_b16 v[90:91], v22 offset:13312
    s_waitcnt lgkmcnt(6)
    v_mfma_f32_32x32x16_bf16 v[144:159], v[76:79], a[160:163], v[144:159]
    ds_read_b64_tr_b16 v[92:93], v23 offset:12288
    ds_read_b64_tr_b16 v[94:95], v23 offset:13312
    s_waitcnt lgkmcnt(6)
    v_mfma_f32_32x32x16_bf16 v[160:175], v[80:83], a[160:163], v[160:175]
    ds_read_b64_tr_b16 v[96:97], v24 offset:12288
    ds_read_b64_tr_b16 v[98:99], v24 offset:13312
    s_waitcnt lgkmcnt(6)
    v_mfma_f32_32x32x16_bf16 v[176:191], v[84:87], a[160:163], v[176:191]
    ds_read_b64_tr_b16 v[100:101], v25 offset:12288
    ds_read_b64_tr_b16 v[102:103], v25 offset:13312
    s_waitcnt lgkmcnt(6)
    v_mfma_f32_32x32x16_bf16 v[128:143], v[88:91], a[164:167], v[128:143]
    buffer_load_dwordx4 v4, s[8:11], s56 offen offset:2048 lds
    buffer_load_dwordx4 v5, s[8:11], s56 offen offset:3072 lds
    ds_read_b64_tr_b16 v[72:73], v22 offset:40960
    ds_read_b64_tr_b16 v[74:75], v22 offset:41984
    s_waitcnt lgkmcnt(6)
    v_mfma_f32_32x32x16_bf16 v[144:159], v[92:95], a[164:167], v[144:159]
    ds_read_b64_tr_b16 v[76:77], v23 offset:40960
    ds_read_b64_tr_b16 v[78:79], v23 offset:41984
    s_waitcnt lgkmcnt(6)
    v_mfma_f32_32x32x16_bf16 v[160:175], v[96:99], a[164:167], v[160:175]
    ds_read_b64_tr_b16 v[80:81], v24 offset:40960
    ds_read_b64_tr_b16 v[82:83], v24 offset:41984
    s_waitcnt lgkmcnt(6)
    v_mfma_f32_32x32x16_bf16 v[176:191], v[100:103], a[164:167], v[176:191]
    ds_read_b64_tr_b16 v[84:85], v25 offset:40960
    ds_read_b64_tr_b16 v[86:87], v25 offset:41984
    s_waitcnt lgkmcnt(6)
    v_mfma_f32_32x32x16_bf16 v[128:143], v[72:75], a[168:171], v[128:143]
    s_add_u32 s57, s56, 32768
    s_add_u32 m0, s69, 4096
    s_nop 0
    buffer_load_dwordx4 v2, s[8:11], s57 offen lds
    buffer_load_dwordx4 v3, s[8:11], s57 offen offset:1024 lds
    ds_read_b64_tr_b16 v[88:89], v22 offset:45056
    ds_read_b64_tr_b16 v[90:91], v22 offset:46080
    s_waitcnt lgkmcnt(6)
    v_mfma_f32_32x32x16_bf16 v[144:159], v[76:79], a[168:171], v[144:159]
    ds_read_b64_tr_b16 v[92:93], v23 offset:45056
    ds_read_b64_tr_b16 v[94:95], v23 offset:46080
    s_waitcnt lgkmcnt(6)
    v_mfma_f32_32x32x16_bf16 v[160:175], v[80:83], a[168:171], v[160:175]
    ds_read_b64_tr_b16 v[96:97], v24 offset:45056
    ds_read_b64_tr_b16 v[98:99], v24 offset:46080
    s_waitcnt lgkmcnt(6)
    v_mfma_f32_32x32x16_bf16 v[176:191], v[84:87], a[168:171], v[176:191]
    ds_read_b64_tr_b16 v[100:101], v25 offset:45056
    ds_read_b64_tr_b16 v[102:103], v25 offset:46080
    s_waitcnt lgkmcnt(6)
    v_mfma_f32_32x32x16_bf16 v[128:143], v[88:91], a[172:175], v[128:143]
    buffer_load_dwordx4 v4, s[8:11], s57 offen offset:2048 lds
    buffer_load_dwordx4 v5, s[8:11], s57 offen offset:3072 lds
    s_add_u32 s7, s98, 3
    s_and_b32 s7, s7, 3
    s_lshl_b32 s7, s7, 1
    s_add_u32 s7, s7, s99
    s_xor_b32 s7, s7, 1
    s_lshl_b32 s7, s7, 8
    s_add_u32 s56, s59, s7
    ds_read_b64_tr_b16 v[72:73], v26 offset:8192
    ds_read_b64_tr_b16 v[74:75], v26 offset:9216
    s_waitcnt lgkmcnt(6)
    v_mfma_f32_32x32x16_bf16 v[144:159], v[92:95], a[172:175], v[144:159]
    ds_read_b64_tr_b16 v[76:77], v27 offset:8192
    ds_read_b64_tr_b16 v[78:79], v27 offset:9216
    s_waitcnt lgkmcnt(6)
    v_mfma_f32_32x32x16_bf16 v[160:175], v[96:99], a[172:175], v[160:175]
    ds_read_b64_tr_b16 v[80:81], v28 offset:8192
    ds_read_b64_tr_b16 v[82:83], v28 offset:9216
    s_waitcnt lgkmcnt(6)
    v_mfma_f32_32x32x16_bf16 v[176:191], v[100:103], a[172:175], v[176:191]
    ds_read_b64_tr_b16 v[84:85], v29 offset:8192
    ds_read_b64_tr_b16 v[86:87], v29 offset:9216
    s_waitcnt lgkmcnt(6)
    v_mfma_f32_32x32x16_bf16 v[128:143], v[72:75], a[176:179], v[128:143]
    s_waitcnt vmcnt(15)
    s_add_u32 m0, s4, 24576
    s_nop 0
    buffer_load_dwordx4 v6, s[12:15], s60 offen lds
    s_waitcnt vmcnt(15)
    buffer_load_dwordx4 v7, s[12:15], s60 offen offset:1024 lds
    ds_read_b64_tr_b16 v[88:89], v26 offset:12288
    ds_read_b64_tr_b16 v[90:91], v26 offset:13312
    s_waitcnt lgkmcnt(6)
    v_mfma_f32_32x32x16_bf16 v[144:159], v[76:79], a[176:179], v[144:159]
    ds_read_b64_tr_b16 v[92:93], v27 offset:12288
    ds_read_b64_tr_b16 v[94:95], v27 offset:13312
    s_waitcnt lgkmcnt(6)
    v_mfma_f32_32x32x16_bf16 v[160:175], v[80:83], a[176:179], v[160:175]
    ds_read_b64_tr_b16 v[96:97], v28 offset:12288
    ds_read_b64_tr_b16 v[98:99], v28 offset:13312
    s_waitcnt lgkmcnt(6)
    v_mfma_f32_32x32x16_bf16 v[176:191], v[84:87], a[176:179], v[176:191]
    ds_read_b64_tr_b16 v[100:101], v29 offset:12288
    ds_read_b64_tr_b16 v[102:103], v29 offset:13312
    s_waitcnt lgkmcnt(6)
    v_mfma_f32_32x32x16_bf16 v[128:143], v[88:91], a[180:183], v[128:143]
    s_waitcnt vmcnt(15)
    buffer_load_dwordx4 v8, s[12:15], s60 offen offset:2048 lds
    s_waitcnt vmcnt(15)
    buffer_load_dwordx4 v9, s[12:15], s60 offen offset:3072 lds
    ds_read_b64_tr_b16 v[72:73], v26 offset:40960
    ds_read_b64_tr_b16 v[74:75], v26 offset:41984
    s_waitcnt lgkmcnt(6)
    v_mfma_f32_32x32x16_bf16 v[144:159], v[92:95], a[180:183], v[144:159]
    ds_read_b64_tr_b16 v[76:77], v27 offset:40960
    ds_read_b64_tr_b16 v[78:79], v27 offset:41984
    s_waitcnt lgkmcnt(6)
    v_mfma_f32_32x32x16_bf16 v[160:175], v[96:99], a[180:183], v[160:175]
    ds_read_b64_tr_b16 v[80:81], v28 offset:40960
    ds_read_b64_tr_b16 v[82:83], v28 offset:41984
    s_waitcnt lgkmcnt(6)
    v_mfma_f32_32x32x16_bf16 v[176:191], v[100:103], a[180:183], v[176:191]
    ds_read_b64_tr_b16 v[84:85], v29 offset:40960
    ds_read_b64_tr_b16 v[86:87], v29 offset:41984
    s_waitcnt lgkmcnt(6)
    v_mfma_f32_32x32x16_bf16 v[128:143], v[72:75], a[184:187], v[128:143]
    s_waitcnt vmcnt(15)
    s_add_u32 s61, s60, 131072
    s_add_u32 m0, s4, 28672
    s_nop 0
    buffer_load_dwordx4 v6, s[12:15], s61 offen lds
    s_waitcnt vmcnt(15)
    buffer_load_dwordx4 v7, s[12:15], s61 offen offset:1024 lds
    ds_read_b64_tr_b16 v[88:89], v26 offset:45056
    ds_read_b64_tr_b16 v[90:91], v26 offset:46080
    s_waitcnt lgkmcnt(6)
    v_mfma_f32_32x32x16_bf16 v[144:159], v[76:79], a[184:187], v[144:159]
    ds_read_b64_tr_b16 v[92:93], v27 offset:45056
    ds_read_b64_tr_b16 v[94:95], v27 offset:46080
    s_waitcnt lgkmcnt(6)
    v_mfma_f32_32x32x16_bf16 v[160:175], v[80:83], a[184:187], v[160:175]
    ds_read_b64_tr_b16 v[96:97], v28 offset:45056
    ds_read_b64_tr_b16 v[98:99], v28 offset:46080
    s_waitcnt lgkmcnt(6)
    v_mfma_f32_32x32x16_bf16 v[176:191], v[84:87], a[184:187], v[176:191]
    ds_read_b64_tr_b16 v[100:101], v29 offset:45056
    ds_read_b64_tr_b16 v[102:103], v29 offset:46080
    s_waitcnt lgkmcnt(0)
    s_waitcnt vmcnt(6)
    ds_read_b128 a[192:195], v10
    ds_read_b128 a[196:199], v11
    ds_read_b128 a[200:203], v12
    ds_read_b128 a[204:207], v13
    ds_read_b128 a[208:211], v14
    ds_read_b128 a[212:215], v15
    ds_read_b128 a[216:219], v16
    ds_read_b128 a[220:223], v17
    s_barrier
    v_mfma_f32_32x32x16_bf16 v[128:143], v[88:91], a[188:191], v[128:143]
    buffer_load_dwordx4 v8, s[12:15], s61 offen offset:2048 lds
    buffer_load_dwordx4 v9, s[12:15], s61 offen offset:3072 lds
    ds_read_b64_tr_b16 v[72:73], v22 offset:16384
    ds_read_b64_tr_b16 v[74:75], v22 offset:17408
    v_mfma_f32_32x32x16_bf16 v[144:159], v[92:95], a[188:191], v[144:159]
    ds_read_b64_tr_b16 v[76:77], v23 offset:16384
    ds_read_b64_tr_b16 v[78:79], v23 offset:17408
    v_mfma_f32_32x32x16_bf16 v[160:175], v[96:99], a[188:191], v[160:175]
    ds_read_b64_tr_b16 v[80:81], v24 offset:16384
    ds_read_b64_tr_b16 v[82:83], v24 offset:17408
    v_mfma_f32_32x32x16_bf16 v[176:191], v[100:103], a[188:191], v[176:191]
    ds_read_b64_tr_b16 v[84:85], v25 offset:16384
    ds_read_b64_tr_b16 v[86:87], v25 offset:17408
    s_waitcnt lgkmcnt(6)
    v_mfma_f32_32x32x16_bf16 v[128:143], v[72:75], a[192:195], v[128:143]
    s_add_u32 m0, s69, 0
    s_nop 0
    buffer_load_dwordx4 v2, s[8:11], s56 offen lds
    buffer_load_dwordx4 v3, s[8:11], s56 offen offset:1024 lds
    ds_read_b64_tr_b16 v[88:89], v22 offset:20480
    ds_read_b64_tr_b16 v[90:91], v22 offset:21504
    s_waitcnt lgkmcnt(6)
    v_mfma_f32_32x32x16_bf16 v[144:159], v[76:79], a[192:195], v[144:159]
    ds_read_b64_tr_b16 v[92:93], v23 offset:20480
    ds_read_b64_tr_b16 v[94:95], v23 offset:21504
    s_waitcnt lgkmcnt(6)
    v_mfma_f32_32x32x16_bf16 v[160:175], v[80:83], a[192:195], v[160:175]
    ds_read_b64_tr_b16 v[96:97], v24 offset:20480
    ds_read_b64_tr_b16 v[98:99], v24 offset:21504
    s_waitcnt lgkmcnt(6)
    v_mfma_f32_32x32x16_bf16 v[176:191], v[84:87], a[192:195], v[176:191]
    ds_read_b64_tr_b16 v[100:101], v25 offset:20480
    ds_read_b64_tr_b16 v[102:103], v25 offset:21504
    s_waitcnt lgkmcnt(6)
    v_mfma_f32_32x32x16_bf16 v[128:143], v[88:91], a[196:199], v[128:143]
    buffer_load_dwordx4 v4, s[8:11], s56 offen offset:2048 lds
    buffer_load_dwordx4 v5, s[8:11], s56 offen offset:3072 lds
    ds_read_b64_tr_b16 v[72:73], v22 offset:49152
    ds_read_b64_tr_b16 v[74:75], v22 offset:50176
    s_waitcnt lgkmcnt(6)
    v_mfma_f32_32x32x16_bf16 v[144:159], v[92:95], a[196:199], v[144:159]
    ds_read_b64_tr_b16 v[76:77], v23 offset:49152
    ds_read_b64_tr_b16 v[78:79], v23 offset:50176
    s_waitcnt lgkmcnt(6)
    v_mfma_f32_32x32x16_bf16 v[160:175], v[96:99], a[196:199], v[160:175]
    ds_read_b64_tr_b16 v[80:81], v24 offset:49152
    ds_read_b64_tr_b16 v[82:83], v24 offset:50176
    s_waitcnt lgkmcnt(6)
    v_mfma_f32_32x32x16_bf16 v[176:191], v[100:103], a[196:199], v[176:191]
    ds_read_b64_tr_b16 v[84:85], v25 offset:49152
    ds_read_b64_tr_b16 v[86:87], v25 offset:50176
    s_waitcnt lgkmcnt(6)
    v_mfma_f32_32x32x16_bf16 v[128:143], v[72:75], a[200:203], v[128:143]
    s_add_u32 s57, s56, 32768
    s_add_u32 m0, s69, 4096
    s_nop 0
    buffer_load_dwordx4 v2, s[8:11], s57 offen lds
    buffer_load_dwordx4 v3, s[8:11], s57 offen offset:1024 lds
    ds_read_b64_tr_b16 v[88:89], v22 offset:53248
    ds_read_b64_tr_b16 v[90:91], v22 offset:54272
    s_waitcnt lgkmcnt(6)
    v_mfma_f32_32x32x16_bf16 v[144:159], v[76:79], a[200:203], v[144:159]
    ds_read_b64_tr_b16 v[92:93], v23 offset:53248
    ds_read_b64_tr_b16 v[94:95], v23 offset:54272
    s_waitcnt lgkmcnt(6)
    v_mfma_f32_32x32x16_bf16 v[160:175], v[80:83], a[200:203], v[160:175]
    ds_read_b64_tr_b16 v[96:97], v24 offset:53248
    ds_read_b64_tr_b16 v[98:99], v24 offset:54272
    s_waitcnt lgkmcnt(6)
    v_mfma_f32_32x32x16_bf16 v[176:191], v[84:87], a[200:203], v[176:191]
    ds_read_b64_tr_b16 v[100:101], v25 offset:53248
    ds_read_b64_tr_b16 v[102:103], v25 offset:54272
    s_waitcnt lgkmcnt(6)
    v_mfma_f32_32x32x16_bf16 v[128:143], v[88:91], a[204:207], v[128:143]
    buffer_load_dwordx4 v4, s[8:11], s57 offen offset:2048 lds
    buffer_load_dwordx4 v5, s[8:11], s57 offen offset:3072 lds
    ds_read_b64_tr_b16 v[72:73], v26 offset:16384
    ds_read_b64_tr_b16 v[74:75], v26 offset:17408
    s_waitcnt lgkmcnt(6)
    v_mfma_f32_32x32x16_bf16 v[144:159], v[92:95], a[204:207], v[144:159]
    ds_read_b64_tr_b16 v[76:77], v27 offset:16384
    ds_read_b64_tr_b16 v[78:79], v27 offset:17408
    s_waitcnt lgkmcnt(6)
    v_mfma_f32_32x32x16_bf16 v[160:175], v[96:99], a[204:207], v[160:175]
    ds_read_b64_tr_b16 v[80:81], v28 offset:16384
    ds_read_b64_tr_b16 v[82:83], v28 offset:17408
    s_waitcnt lgkmcnt(6)
    v_mfma_f32_32x32x16_bf16 v[176:191], v[100:103], a[204:207], v[176:191]
    ds_read_b64_tr_b16 v[84:85], v29 offset:16384
    ds_read_b64_tr_b16 v[86:87], v29 offset:17408
    s_waitcnt lgkmcnt(6)
    v_mfma_f32_32x32x16_bf16 v[128:143], v[72:75], a[208:211], v[128:143]
    s_waitcnt vmcnt(15)
    v_lshrrev_b32 v31, 4, v1
    v_and_b32 v2, 15, v1
    v_xor_b32 v2, v2, v31
    v_lshlrev_b32 v2, 4, v2
    v_lshlrev_b32 v31, 8, v31
    v_xor_b32 v3, 64, v2
    v_add_u32 v3, v3, v31
    v_add_u32 v3, 3072, v3
    v_xor_b32 v4, 128, v2
    v_add_u32 v4, v4, v31
    v_add_u32 v4, 6144, v4
    v_xor_b32 v5, 192, v2
    v_add_u32 v5, v5, v31
    v_add_u32 v5, 9216, v5
    v_add_u32 v2, v2, v31
    s_lshl_b32 s59, s55, 18
    s_lshl_b32 s7, s3, 10
    s_add_u32 s59, s59, s7
    s_mov_b32 s56, s59
    s_mov_b32 s8, s28
    s_mov_b32 s9, s29
    s_mov_b32 s10, 67108864
    s_mov_b32 s11, 0x20000
    s_add_u32 m0, s4, 0
    s_nop 0
    buffer_load_dwordx4 v2, s[8:11], s56 offen nt lds
    s_waitcnt vmcnt(15)
    buffer_load_dwordx4 v3, s[8:11], s56 offen offset:1024 nt lds
    ds_read_b64_tr_b16 v[88:89], v26 offset:20480
    ds_read_b64_tr_b16 v[90:91], v26 offset:21504
    s_waitcnt lgkmcnt(6)
    v_mfma_f32_32x32x16_bf16 v[144:159], v[76:79], a[208:211], v[144:159]
    ds_read_b64_tr_b16 v[92:93], v27 offset:20480
    ds_read_b64_tr_b16 v[94:95], v27 offset:21504
    s_waitcnt lgkmcnt(6)
    v_mfma_f32_32x32x16_bf16 v[160:175], v[80:83], a[208:211], v[160:175]
    ds_read_b64_tr_b16 v[96:97], v28 offset:20480
    ds_read_b64_tr_b16 v[98:99], v28 offset:21504
    s_waitcnt lgkmcnt(6)
    v_mfma_f32_32x32x16_bf16 v[176:191], v[84:87], a[208:211], v[176:191]
    ds_read_b64_tr_b16 v[100:101], v29 offset:20480
    ds_read_b64_tr_b16 v[102:103], v29 offset:21504
    s_waitcnt lgkmcnt(6)
    v_mfma_f32_32x32x16_bf16 v[128:143], v[88:91], a[212:215], v[128:143]
    s_waitcnt vmcnt(15)
    buffer_load_dwordx4 v4, s[8:11], s56 offen offset:2048 nt lds
    s_waitcnt vmcnt(15)
    buffer_load_dwordx4 v5, s[8:11], s56 offen offset:3072 nt lds
    ds_read_b64_tr_b16 v[72:73], v26 offset:49152
    ds_read_b64_tr_b16 v[74:75], v26 offset:50176
    s_waitcnt lgkmcnt(6)
    v_mfma_f32_32x32x16_bf16 v[144:159], v[92:95], a[212:215], v[144:159]
    ds_read_b64_tr_b16 v[76:77], v27 offset:49152
    ds_read_b64_tr_b16 v[78:79], v27 offset:50176
    s_waitcnt lgkmcnt(6)
    v_mfma_f32_32x32x16_bf16 v[160:175], v[96:99], a[212:215], v[160:175]
    ds_read_b64_tr_b16 v[80:81], v28 offset:49152
    ds_read_b64_tr_b16 v[82:83], v28 offset:50176
    s_waitcnt lgkmcnt(6)
    v_mfma_f32_32x32x16_bf16 v[176:191], v[100:103], a[212:215], v[176:191]
    ds_read_b64_tr_b16 v[84:85], v29 offset:49152
    ds_read_b64_tr_b16 v[86:87], v29 offset:50176
    s_waitcnt lgkmcnt(6)
    v_mfma_f32_32x32x16_bf16 v[128:143], v[72:75], a[216:219], v[128:143]
    s_waitcnt vmcnt(15)
    s_add_u32 s57, s56, 16384
    s_add_u32 m0, s4, 4096
    s_nop 0
    buffer_load_dwordx4 v2, s[8:11], s57 offen nt lds
    s_waitcnt vmcnt(15)
    buffer_load_dwordx4 v3, s[8:11], s57 offen offset:1024 nt lds
    ds_read_b64_tr_b16 v[88:89], v26 offset:53248
    ds_read_b64_tr_b16 v[90:91], v26 offset:54272
    s_waitcnt lgkmcnt(6)
    v_mfma_f32_32x32x16_bf16 v[144:159], v[76:79], a[216:219], v[144:159]
    ds_read_b64_tr_b16 v[92:93], v27 offset:53248
    ds_read_b64_tr_b16 v[94:95], v27 offset:54272
    s_waitcnt lgkmcnt(6)
    v_mfma_f32_32x32x16_bf16 v[160:175], v[80:83], a[216:219], v[160:175]
    ds_read_b64_tr_b16 v[96:97], v28 offset:53248
    ds_read_b64_tr_b16 v[98:99], v28 offset:54272
    s_waitcnt lgkmcnt(6)
    v_mfma_f32_32x32x16_bf16 v[176:191], v[84:87], a[216:219], v[176:191]
    ds_read_b64_tr_b16 v[100:101], v29 offset:53248
    ds_read_b64_tr_b16 v[102:103], v29 offset:54272
    s_waitcnt lgkmcnt(0)
    s_waitcnt vmcnt(6)
    ds_read_b128 a[224:227], v10
    ds_read_b128 a[228:231], v11
    ds_read_b128 a[232:235], v12
    ds_read_b128 a[236:239], v13
    ds_read_b128 a[240:243], v14
    ds_read_b128 a[244:247], v15
    ds_read_b128 a[248:251], v16
    ds_read_b128 a[252:255], v17
    s_barrier
    v_mfma_f32_32x32x16_bf16 v[128:143], v[88:91], a[220:223], v[128:143]
    buffer_load_dwordx4 v4, s[8:11], s57 offen offset:2048 nt lds
    buffer_load_dwordx4 v5, s[8:11], s57 offen offset:3072 nt lds
    s_add_u32 s56, s56, 32768
    ds_read_b64_tr_b16 v[72:73], v22 offset:24576
    ds_read_b64_tr_b16 v[74:75], v22 offset:25600
    v_mfma_f32_32x32x16_bf16 v[144:159], v[92:95], a[220:223], v[144:159]
    ds_read_b64_tr_b16 v[76:77], v23 offset:24576
    ds_read_b64_tr_b16 v[78:79], v23 offset:25600
    v_mfma_f32_32x32x16_bf16 v[160:175], v[96:99], a[220:223], v[160:175]
    ds_read_b64_tr_b16 v[80:81], v24 offset:24576
    ds_read_b64_tr_b16 v[82:83], v24 offset:25600
    v_mfma_f32_32x32x16_bf16 v[176:191], v[100:103], a[220:223], v[176:191]
    ds_read_b64_tr_b16 v[84:85], v25 offset:24576
    ds_read_b64_tr_b16 v[86:87], v25 offset:25600
    s_waitcnt lgkmcnt(6)
    v_and_b32 v31, 31, v1
    v_lshrrev_b32 v32, 5, v1
    v_and_b32 v33, 15, v1
    v_xor_b32 v32, v32, v33
    v_lshlrev_b32 v32, 4, v32
    v_lshlrev_b32 v31, 8, v31
    v_add_u32 v31, s4, v31
    v_xor_b32 v10, 0, v32
    v_add_u32 v10, v10, v31
    v_xor_b32 v11, 32, v32
    v_add_u32 v11, v11, v31
    v_xor_b32 v12, 64, v32
    v_add_u32 v12, v12, v31
    v_xor_b32 v13, 96, v32
    v_add_u32 v13, v13, v31
    v_xor_b32 v14, 128, v32
    v_add_u32 v14, v14, v31
    v_xor_b32 v15, 160, v32
    v_add_u32 v15, v15, v31
    v_xor_b32 v16, 192, v32
    v_add_u32 v16, v16, v31
    v_xor_b32 v17, 224, v32
    v_add_u32 v17, v17, v31
    v_mfma_f32_32x32x16_bf16 v[128:143], v[72:75], a[224:227], v[128:143]
    ds_read_b64_tr_b16 v[88:89], v22 offset:28672
    ds_read_b64_tr_b16 v[90:91], v22 offset:29696
    s_waitcnt lgkmcnt(6)
    v_mfma_f32_32x32x16_bf16 v[144:159], v[76:79], a[224:227], v[144:159]
    ds_read_b64_tr_b16 v[92:93], v23 offset:28672
    ds_read_b64_tr_b16 v[94:95], v23 offset:29696
    s_waitcnt lgkmcnt(6)
    v_mfma_f32_32x32x16_bf16 v[160:175], v[80:83], a[224:227], v[160:175]
    ds_read_b64_tr_b16 v[96:97], v24 offset:28672
    ds_read_b64_tr_b16 v[98:99], v24 offset:29696
    s_waitcnt lgkmcnt(6)
    v_mfma_f32_32x32x16_bf16 v[176:191], v[84:87], a[224:227], v[176:191]
    ds_read_b64_tr_b16 v[100:101], v25 offset:28672
    ds_read_b64_tr_b16 v[102:103], v25 offset:29696
    s_waitcnt lgkmcnt(6)
    v_mfma_f32_32x32x16_bf16 v[128:143], v[88:91], a[228:231], v[128:143]
    ds_read_b64_tr_b16 v[72:73], v22 offset:57344
    ds_read_b64_tr_b16 v[74:75], v22 offset:58368
    s_waitcnt lgkmcnt(6)
    v_mfma_f32_32x32x16_bf16 v[144:159], v[92:95], a[228:231], v[144:159]
    ds_read_b64_tr_b16 v[76:77], v23 offset:57344
    ds_read_b64_tr_b16 v[78:79], v23 offset:58368
    s_waitcnt lgkmcnt(6)
    v_mfma_f32_32x32x16_bf16 v[160:175], v[96:99], a[228:231], v[160:175]
    ds_read_b64_tr_b16 v[80:81], v24 offset:57344
    ds_read_b64_tr_b16 v[82:83], v24 offset:58368
    s_waitcnt lgkmcnt(6)
    v_mfma_f32_32x32x16_bf16 v[176:191], v[100:103], a[228:231], v[176:191]
    ds_read_b64_tr_b16 v[84:85], v25 offset:57344
    ds_read_b64_tr_b16 v[86:87], v25 offset:58368
    s_waitcnt lgkmcnt(6)
    v_mfma_f32_32x32x16_bf16 v[128:143], v[72:75], a[232:235], v[128:143]
    ds_read_b64_tr_b16 v[88:89], v22 offset:61440
    ds_read_b64_tr_b16 v[90:91], v22 offset:62464
    s_waitcnt lgkmcnt(6)
    v_mfma_f32_32x32x16_bf16 v[144:159], v[76:79], a[232:235], v[144:159]
    ds_read_b64_tr_b16 v[92:93], v23 offset:61440
    ds_read_b64_tr_b16 v[94:95], v23 offset:62464
    s_waitcnt lgkmcnt(6)
    v_mfma_f32_32x32x16_bf16 v[160:175], v[80:83], a[232:235], v[160:175]
    ds_read_b64_tr_b16 v[96:97], v24 offset:61440
    ds_read_b64_tr_b16 v[98:99], v24 offset:62464
    s_waitcnt lgkmcnt(6)
    v_mfma_f32_32x32x16_bf16 v[176:191], v[84:87], a[232:235], v[176:191]
    ds_read_b64_tr_b16 v[100:101], v25 offset:61440
    ds_read_b64_tr_b16 v[102:103], v25 offset:62464
    s_waitcnt lgkmcnt(6)
    v_mfma_f32_32x32x16_bf16 v[128:143], v[88:91], a[236:239], v[128:143]
    ds_read_b64_tr_b16 v[72:73], v26 offset:24576
    ds_read_b64_tr_b16 v[74:75], v26 offset:25600
    s_waitcnt lgkmcnt(6)
    v_mfma_f32_32x32x16_bf16 v[144:159], v[92:95], a[236:239], v[144:159]
    ds_read_b64_tr_b16 v[76:77], v27 offset:24576
    ds_read_b64_tr_b16 v[78:79], v27 offset:25600
    s_waitcnt lgkmcnt(6)
    v_mfma_f32_32x32x16_bf16 v[160:175], v[96:99], a[236:239], v[160:175]
    ds_read_b64_tr_b16 v[80:81], v28 offset:24576
    ds_read_b64_tr_b16 v[82:83], v28 offset:25600
    s_waitcnt lgkmcnt(6)
    v_mfma_f32_32x32x16_bf16 v[176:191], v[100:103], a[236:239], v[176:191]
    ds_read_b64_tr_b16 v[84:85], v29 offset:24576
    ds_read_b64_tr_b16 v[86:87], v29 offset:25600
    s_waitcnt lgkmcnt(6)
    v_mfma_f32_32x32x16_bf16 v[128:143], v[72:75], a[240:243], v[128:143]
    ds_read_b64_tr_b16 v[88:89], v26 offset:28672
    ds_read_b64_tr_b16 v[90:91], v26 offset:29696
    s_waitcnt lgkmcnt(6)
    v_mfma_f32_32x32x16_bf16 v[144:159], v[76:79], a[240:243], v[144:159]
    ds_read_b64_tr_b16 v[92:93], v27 offset:28672
    ds_read_b64_tr_b16 v[94:95], v27 offset:29696
    s_waitcnt lgkmcnt(6)
    v_mfma_f32_32x32x16_bf16 v[160:175], v[80:83], a[240:243], v[160:175]
    ds_read_b64_tr_b16 v[96:97], v28 offset:28672
    ds_read_b64_tr_b16 v[98:99], v28 offset:29696
    s_waitcnt lgkmcnt(6)
    v_mfma_f32_32x32x16_bf16 v[176:191], v[84:87], a[240:243], v[176:191]
    ds_read_b64_tr_b16 v[100:101], v29 offset:28672
    ds_read_b64_tr_b16 v[102:103], v29 offset:29696
    s_waitcnt lgkmcnt(6)
    v_mfma_f32_32x32x16_bf16 v[128:143], v[88:91], a[244:247], v[128:143]
    ds_read_b64_tr_b16 v[72:73], v26 offset:57344
    ds_read_b64_tr_b16 v[74:75], v26 offset:58368
    s_waitcnt lgkmcnt(6)
    v_mfma_f32_32x32x16_bf16 v[144:159], v[92:95], a[244:247], v[144:159]
    ds_read_b64_tr_b16 v[76:77], v27 offset:57344
    ds_read_b64_tr_b16 v[78:79], v27 offset:58368
    s_waitcnt lgkmcnt(6)
    v_mfma_f32_32x32x16_bf16 v[160:175], v[96:99], a[244:247], v[160:175]
    ds_read_b64_tr_b16 v[80:81], v28 offset:57344
    ds_read_b64_tr_b16 v[82:83], v28 offset:58368
    s_waitcnt lgkmcnt(6)
    v_mfma_f32_32x32x16_bf16 v[176:191], v[100:103], a[244:247], v[176:191]
    ds_read_b64_tr_b16 v[84:85], v29 offset:57344
    ds_read_b64_tr_b16 v[86:87], v29 offset:58368
    s_waitcnt lgkmcnt(6)
    v_mfma_f32_32x32x16_bf16 v[128:143], v[72:75], a[248:251], v[128:143]
    ds_read_b64_tr_b16 v[88:89], v26 offset:61440
    ds_read_b64_tr_b16 v[90:91], v26 offset:62464
    s_waitcnt lgkmcnt(6)
    v_mfma_f32_32x32x16_bf16 v[144:159], v[76:79], a[248:251], v[144:159]
    ds_read_b64_tr_b16 v[92:93], v27 offset:61440
    ds_read_b64_tr_b16 v[94:95], v27 offset:62464
    s_waitcnt lgkmcnt(6)
    v_mfma_f32_32x32x16_bf16 v[160:175], v[80:83], a[248:251], v[160:175]
    ds_read_b64_tr_b16 v[96:97], v28 offset:61440
    ds_read_b64_tr_b16 v[98:99], v28 offset:62464
    s_waitcnt lgkmcnt(6)
    v_mfma_f32_32x32x16_bf16 v[176:191], v[84:87], a[248:251], v[176:191]
    ds_read_b64_tr_b16 v[100:101], v29 offset:61440
    ds_read_b64_tr_b16 v[102:103], v29 offset:62464
    s_waitcnt lgkmcnt(6)
    v_mfma_f32_32x32x16_bf16 v[128:143], v[88:91], a[252:255], v[128:143]
    s_waitcnt lgkmcnt(4)
    v_mfma_f32_32x32x16_bf16 v[144:159], v[92:95], a[252:255], v[144:159]
    s_waitcnt lgkmcnt(2)
    v_mfma_f32_32x32x16_bf16 v[160:175], v[96:99], a[252:255], v[160:175]
    s_waitcnt lgkmcnt(0)
    v_mfma_f32_32x32x16_bf16 v[176:191], v[100:103], a[252:255], v[176:191]
    s_nop 5
    v_pk_mul_f32 v[128:129], v[128:129], s[6:7] op_sel_hi:[1,0]
    v_pk_mul_f32 v[130:131], v[130:131], s[6:7] op_sel_hi:[1,0]
    v_pk_mul_f32 v[132:133], v[132:133], s[6:7] op_sel_hi:[1,0]
    v_pk_mul_f32 v[134:135], v[134:135], s[6:7] op_sel_hi:[1,0]
    v_pk_mul_f32 v[136:137], v[136:137], s[6:7] op_sel_hi:[1,0]
    v_pk_mul_f32 v[138:139], v[138:139], s[6:7] op_sel_hi:[1,0]
    v_pk_mul_f32 v[140:141], v[140:141], s[6:7] op_sel_hi:[1,0]
    v_pk_mul_f32 v[142:143], v[142:143], s[6:7] op_sel_hi:[1,0]
    v_cvt_pk_bf16_f32 v192, v128, v129
    v_cvt_pk_bf16_f32 v193, v130, v131
    v_cvt_pk_bf16_f32 v194, v132, v133
    v_cvt_pk_bf16_f32 v195, v134, v135
    v_cvt_pk_bf16_f32 v196, v136, v137
    v_cvt_pk_bf16_f32 v197, v138, v139
    v_cvt_pk_bf16_f32 v198, v140, v141
    v_cvt_pk_bf16_f32 v199, v142, v143
    buffer_store_dwordx4 v[192:195], v30, s[44:47], s95 offen offset:0 sc1
    buffer_store_dwordx4 v[196:199], v30, s[44:47], s95 offen offset:1024 sc1
    v_pk_mul_f32 v[144:145], v[144:145], s[6:7] op_sel_hi:[1,0]
    v_pk_mul_f32 v[146:147], v[146:147], s[6:7] op_sel_hi:[1,0]
    v_pk_mul_f32 v[148:149], v[148:149], s[6:7] op_sel_hi:[1,0]
    v_pk_mul_f32 v[150:151], v[150:151], s[6:7] op_sel_hi:[1,0]
    v_pk_mul_f32 v[152:153], v[152:153], s[6:7] op_sel_hi:[1,0]
    v_pk_mul_f32 v[154:155], v[154:155], s[6:7] op_sel_hi:[1,0]
    v_pk_mul_f32 v[156:157], v[156:157], s[6:7] op_sel_hi:[1,0]
    v_pk_mul_f32 v[158:159], v[158:159], s[6:7] op_sel_hi:[1,0]
    v_cvt_pk_bf16_f32 v200, v144, v145
    v_cvt_pk_bf16_f32 v201, v146, v147
    v_cvt_pk_bf16_f32 v202, v148, v149
    v_cvt_pk_bf16_f32 v203, v150, v151
    v_cvt_pk_bf16_f32 v204, v152, v153
    v_cvt_pk_bf16_f32 v205, v154, v155
    v_cvt_pk_bf16_f32 v206, v156, v157
    v_cvt_pk_bf16_f32 v207, v158, v159
    buffer_store_dwordx4 v[200:203], v30, s[44:47], s95 offen offset:2048 sc1
    buffer_store_dwordx4 v[204:207], v30, s[44:47], s95 offen offset:3072 sc1
    v_pk_mul_f32 v[160:161], v[160:161], s[6:7] op_sel_hi:[1,0]
    v_pk_mul_f32 v[162:163], v[162:163], s[6:7] op_sel_hi:[1,0]
    v_pk_mul_f32 v[164:165], v[164:165], s[6:7] op_sel_hi:[1,0]
    v_pk_mul_f32 v[166:167], v[166:167], s[6:7] op_sel_hi:[1,0]
    v_pk_mul_f32 v[168:169], v[168:169], s[6:7] op_sel_hi:[1,0]
    v_pk_mul_f32 v[170:171], v[170:171], s[6:7] op_sel_hi:[1,0]
    v_pk_mul_f32 v[172:173], v[172:173], s[6:7] op_sel_hi:[1,0]
    v_pk_mul_f32 v[174:175], v[174:175], s[6:7] op_sel_hi:[1,0]
    v_cvt_pk_bf16_f32 v208, v160, v161
    v_cvt_pk_bf16_f32 v209, v162, v163
    v_cvt_pk_bf16_f32 v210, v164, v165
    v_cvt_pk_bf16_f32 v211, v166, v167
    v_cvt_pk_bf16_f32 v212, v168, v169
    v_cvt_pk_bf16_f32 v213, v170, v171
    v_cvt_pk_bf16_f32 v214, v172, v173
    v_cvt_pk_bf16_f32 v215, v174, v175
    buffer_store_dwordx4 v[208:211], v30, s[44:47], s94 offen offset:0 sc1
    buffer_store_dwordx4 v[212:215], v30, s[44:47], s94 offen offset:1024 sc1
    v_pk_mul_f32 v[176:177], v[176:177], s[6:7] op_sel_hi:[1,0]
    v_pk_mul_f32 v[178:179], v[178:179], s[6:7] op_sel_hi:[1,0]
    v_pk_mul_f32 v[180:181], v[180:181], s[6:7] op_sel_hi:[1,0]
    v_pk_mul_f32 v[182:183], v[182:183], s[6:7] op_sel_hi:[1,0]
    v_pk_mul_f32 v[184:185], v[184:185], s[6:7] op_sel_hi:[1,0]
    v_pk_mul_f32 v[186:187], v[186:187], s[6:7] op_sel_hi:[1,0]
    v_pk_mul_f32 v[188:189], v[188:189], s[6:7] op_sel_hi:[1,0]
    v_pk_mul_f32 v[190:191], v[190:191], s[6:7] op_sel_hi:[1,0]
    v_cvt_pk_bf16_f32 v216, v176, v177
    v_cvt_pk_bf16_f32 v217, v178, v179
    v_cvt_pk_bf16_f32 v218, v180, v181
    v_cvt_pk_bf16_f32 v219, v182, v183
    v_cvt_pk_bf16_f32 v220, v184, v185
    v_cvt_pk_bf16_f32 v221, v186, v187
    v_cvt_pk_bf16_f32 v222, v188, v189
    v_cvt_pk_bf16_f32 v223, v190, v191
    buffer_store_dwordx4 v[216:219], v30, s[44:47], s94 offen offset:2048 sc1
    buffer_store_dwordx4 v[220:223], v30, s[44:47], s94 offen offset:3072 sc1
    s_add_u32 m0, s4, 8192
    s_nop 0
    buffer_load_dwordx4 v2, s[8:11], s56 offen nt lds
    buffer_load_dwordx4 v3, s[8:11], s56 offen offset:1024 nt lds
    buffer_load_dwordx4 v4, s[8:11], s56 offen offset:2048 nt lds
    s_waitcnt vmcnt(3)
    v_mov_b32 v31, 1
    v_lshlrev_b32 v103, 2, v1
    s_mov_b64 exec, 1
    buffer_store_dword v31, v103, s[44:47], s96 offen sc1
    s_mov_b64 exec, -1
    s_barrier
    s_and_b32 s7, s52, 3
    s_cmp_eq_u32 s7, 1
    s_cselect_b32 s97, 1, 0
    ds_read_b128 a[0:3], v10 offset:0
    ds_read_b128 a[4:7], v11 offset:0
    ds_read_b128 a[8:11], v12 offset:0
    ds_read_b128 a[12:15], v13 offset:0
    ds_read_b128 a[16:19], v14 offset:0
    ds_read_b128 a[20:23], v15 offset:0
    ds_read_b128 a[24:27], v16 offset:0
    ds_read_b128 a[28:31], v17 offset:0
    s_waitcnt lgkmcnt(0)
    v_and_b32 v35, 7, v1
    v_lshlrev_b32 v35, 5, v35
    global_load_dword v34, v35, s[38:39] sc1
    s_cmp_lg_u32 s97, 0
    s_cbranch_scc1 L_lag1
    s_waitcnt vmcnt(3)
L_lag1:
    buffer_load_dwordx4 v5, s[8:11], s56 offen offset:3072 nt lds
    s_cmp_lg_u32 s97, 0
    s_cbranch_scc1 L_lag2
    s_waitcnt vmcnt(3)
L_lag2:
    s_add_u32 s57, s56, 16384
    s_add_u32 m0, s4, 12288
    s_nop 0
    buffer_load_dwordx4 v2, s[8:11], s57 offen nt lds
    s_cmp_lg_u32 s97, 0
    s_cbranch_scc1 L_lag3
    s_waitcnt vmcnt(3)
L_lag3:
    buffer_load_dwordx4 v3, s[8:11], s57 offen offset:1024 nt lds
    s_cmp_lg_u32 s97, 0
    s_cbranch_scc1 L_lag4
    s_waitcnt vmcnt(3)
L_lag4:
    buffer_load_dwordx4 v4, s[8:11], s57 offen offset:2048 nt lds
    s_cmp_lg_u32 s97, 0
    s_cbranch_scc1 L_lag5
    s_waitcnt vmcnt(3)
L_lag5:
    buffer_load_dwordx4 v5, s[8:11], s57 offen offset:3072 nt lds
    s_add_u32 s56, s56, 32768
    s_cmp_lg_u32 s97, 0
    s_cbranch_scc1 L_lag6
    s_waitcnt vmcnt(3)
L_lag6:
    s_add_u32 m0, s4, 16384
    s_nop 0
    buffer_load_dwordx4 v2, s[8:11], s56 offen nt lds
    s_cmp_lg_u32 s97, 0
    s_cbranch_scc1 L_lag7
    s_waitcnt vmcnt(3)
L_lag7:
    buffer_load_dwordx4 v3, s[8:11], s56 offen offset:1024 nt lds
    s_cmp_lg_u32 s97, 0
    s_cbranch_scc1 L_lag8
    s_waitcnt vmcnt(3)
L_lag8:
    s_waitcnt vmcnt(11)
    buffer_load_dwordx4 v4, s[8:11], s56 offen offset:2048 nt lds
    s_cmp_lg_u32 s97, 0
    s_cbranch_scc1 L_lag9
    s_waitcnt vmcnt(3)
L_lag9:
    s_waitcnt vmcnt(11)
    buffer_load_dwordx4 v5, s[8:11], s56 offen offset:3072 nt lds
    s_cmp_lg_u32 s97, 0
    s_cbranch_scc1 L_lag10
    s_waitcnt vmcnt(3)
L_lag10:
    s_waitcnt vmcnt(11)
    s_add_u32 s57, s56, 16384
    s_add_u32 m0, s4, 20480
    s_nop 0
    buffer_load_dwordx4 v2, s[8:11], s57 offen nt lds
    s_cmp_lg_u32 s97, 0
    s_cbranch_scc1 L_lag11
    s_waitcnt vmcnt(3)
L_lag11:
    s_waitcnt vmcnt(11)
    buffer_load_dwordx4 v3, s[8:11], s57 offen offset:1024 nt lds
    s_cmp_lg_u32 s97, 0
    s_cbranch_scc1 L_lag12
    s_waitcnt vmcnt(3)
L_lag12:
    s_waitcnt vmcnt(11)
    buffer_load_dwordx4 v4, s[8:11], s57 offen offset:2048 nt lds
    s_cmp_lg_u32 s97, 0
    s_cbranch_scc1 L_lag13
    s_waitcnt vmcnt(3)
L_lag13:
    s_waitcnt vmcnt(11)
    buffer_load_dwordx4 v5, s[8:11], s57 offen offset:3072 nt lds
    s_add_u32 s56, s56, 32768
    s_cmp_lg_u32 s97, 0
    s_cbranch_scc1 L_lag14
    s_waitcnt vmcnt(3)
L_lag14:
    s_waitcnt vmcnt(11)
    s_add_u32 m0, s4, 24576
    s_nop 0
    buffer_load_dwordx4 v2, s[8:11], s56 offen nt lds
    s_cmp_lg_u32 s97, 0
    s_cbranch_scc1 L_lag15
    s_waitcnt vmcnt(3)
L_lag15:
    s_waitcnt vmcnt(11)
    buffer_load_dwordx4 v3, s[8:11], s56 offen offset:1024 nt lds
    s_cmp_lg_u32 s97, 0
    s_cbranch_scc1 L_lag16
    s_waitcnt vmcnt(3)
L_lag16:
    s_waitcnt vmcnt(11)
    buffer_load_dwordx4 v4, s[8:11], s56 offen offset:2048 nt lds
    s_cmp_lg_u32 s97, 0
    s_cbranch_scc1 L_lag17
    s_waitcnt vmcnt(3)
L_lag17:
    s_waitcnt vmcnt(11)
    buffer_load_dwordx4 v5, s[8:11], s56 offen offset:3072 nt lds
    ds_read_b128 a[32:35], v10 offset:8192
    ds_read_b128 a[36:39], v11 offset:8192
    ds_read_b128 a[40:43], v12 offset:8192
    ds_read_b128 a[44:47], v13 offset:8192
    ds_read_b128 a[48:51], v14 offset:8192
    ds_read_b128 a[52:55], v15 offset:8192
    ds_read_b128 a[56:59], v16 offset:8192
    ds_read_b128 a[60:63], v17 offset:8192
    s_waitcnt lgkmcnt(0)
    s_mov_b32 s68, 262144
L_g1clr:
    v_cmp_gt_u32 vcc, 32, v34
    s_cbranch_vccz L_g1clr_x
    global_load_dword v34, v35, s[38:39] sc1
    s_sub_u32 s68, s68, 1
    s_waitcnt vmcnt(0)
    s_cbranch_scc0 L_g1clr
L_g1clr_x:
    v_and_b32 v35, 0, v1
    v_lshlrev_b32 v35, 2, v35
    v_mov_b32 v34, 1
    s_mov_b64 exec, 1
    v_mov_b32 v34, 0
    buffer_atomic_or v34, v35, s[44:47], s66 offen sc0 sc1
    s_mov_b64 exec, -1
    s_cmp_lg_u32 s97, 0
    s_cbranch_scc1 L_lag18
    s_waitcnt vmcnt(3)
L_lag18:
    s_waitcnt vmcnt(11)
    s_add_u32 s57, s56, 16384
    s_add_u32 m0, s4, 28672
    s_nop 0
    buffer_load_dwordx4 v2, s[8:11], s57 offen nt lds
    s_cmp_lg_u32 s97, 0
    s_cbranch_scc1 L_lag19
    s_waitcnt vmcnt(3)
L_lag19:
    s_waitcnt vmcnt(11)
    buffer_load_dwordx4 v3, s[8:11], s57 offen offset:1024 nt lds
    s_cmp_lg_u32 s97, 0
    s_cbranch_scc1 L_lag20
    s_waitcnt vmcnt(3)
L_lag20:
    s_waitcnt vmcnt(11)
    buffer_load_dwordx4 v4, s[8:11], s57 offen offset:2048 nt lds
    s_cmp_lg_u32 s97, 0
    s_cbranch_scc1 L_lag21
    s_waitcnt vmcnt(3)
L_lag21:
    s_waitcnt vmcnt(11)
    buffer_load_dwordx4 v5, s[8:11], s57 offen offset:3072 nt lds
    s_add_u32 s56, s56, 32768
    s_add_u32 m0, s4, 0
    s_nop 0
    buffer_load_dwordx4 v2, s[8:11], s56 offen nt lds
    buffer_load_dwordx4 v3, s[8:11], s56 offen offset:1024 nt lds
    buffer_load_dwordx4 v4, s[8:11], s56 offen offset:2048 nt lds
    buffer_load_dwordx4 v5, s[8:11], s56 offen offset:3072 nt lds
    s_waitcnt vmcnt(15)
    s_add_u32 s57, s56, 16384
    s_add_u32 m0, s4, 4096
    s_nop 0
    buffer_load_dwordx4 v2, s[8:11], s57 offen nt lds
    s_waitcnt vmcnt(15)
    buffer_load_dwordx4 v3, s[8:11], s57 offen offset:1024 nt lds
    s_waitcnt vmcnt(15)
    buffer_load_dwordx4 v4, s[8:11], s57 offen offset:2048 nt lds
    ds_read_b128 a[64:67], v10 offset:16384
    ds_read_b128 a[68:71], v11 offset:16384
    ds_read_b128 a[72:75], v12 offset:16384
    ds_read_b128 a[76:79], v13 offset:16384
    ds_read_b128 a[80:83], v14 offset:16384
    ds_read_b128 a[84:87], v15 offset:16384
    ds_read_b128 a[88:91], v16 offset:16384
    ds_read_b128 a[92:95], v17 offset:16384
    s_waitcnt lgkmcnt(0)
    s_waitcnt vmcnt(11)
    s_mov_b32 s68, 262144
L_g1q:
    v_cmp_ne_u32 vcc, 1, v34
    s_cbranch_vccz L_g1q_x
    v_mov_b32 v34, 1
    s_mov_b64 exec, 1
    v_mov_b32 v34, 0
    buffer_atomic_or v34, v35, s[44:47], s66 offen sc0 sc1
    s_mov_b64 exec, -1
    s_sub_u32 s68, s68, 1
    s_waitcnt vmcnt(0)
    s_cbranch_scc0 L_g1q
L_g1q_x:
    s_lshl_b32 s5, s3, 13
    s_add_u32 m0, s5, 136192
    s_lshl_b32 s5, s3, 11
    s_add_u32 s5, s5, s64
    buffer_load_dwordx4 v30, s[44:47], s5 offen offset:0 sc1 lds
    buffer_load_dwordx4 v30, s[44:47], s5 offen offset:1024 sc1 lds
    s_add_u32 m0, s4, 4096
    s_nop 0
    buffer_load_dwordx4 v5, s[8:11], s57 offen offset:3072 nt lds
    s_add_u32 s56, s56, 32768
    s_add_u32 m0, s4, 8192
    s_nop 0
    buffer_load_dwordx4 v2, s[8:11], s56 offen nt lds
    buffer_load_dwordx4 v3, s[8:11], s56 offen offset:1024 nt lds
    s_waitcnt vmcnt(15)
    buffer_load_dwordx4 v4, s[8:11], s56 offen offset:2048 nt lds
    s_waitcnt vmcnt(15)
    buffer_load_dwordx4 v5, s[8:11], s56 offen offset:3072 nt lds
    s_waitcnt vmcnt(15)
    s_add_u32 s57, s56, 16384
    s_add_u32 m0, s4, 12288
    s_nop 0
    buffer_load_dwordx4 v2, s[8:11], s57 offen nt lds
    s_waitcnt vmcnt(15)
    buffer_load_dwordx4 v3, s[8:11], s57 offen offset:1024 nt lds
    ds_read_b128 a[96:99], v10 offset:24576
    ds_read_b128 a[100:103], v11 offset:24576
    ds_read_b128 a[104:107], v12 offset:24576
    ds_read_b128 a[108:111], v13 offset:24576
    ds_read_b128 a[112:115], v14 offset:24576
    ds_read_b128 a[116:119], v15 offset:24576
    ds_read_b128 a[120:123], v16 offset:24576
    ds_read_b128 a[124:127], v17 offset:24576
    s_waitcnt lgkmcnt(0)
    s_waitcnt vmcnt(7)
    s_barrier
    v_add_u32 v35, 131072, v30
    ds_read_b128 v[40:43], v35 offset:5120
    ds_read_b128 v[44:47], v35 offset:6144
    ds_read_b128 v[48:51], v35 offset:13312
    ds_read_b128 v[52:55], v35 offset:14336
    ds_read_b128 v[56:59], v35 offset:21504
    ds_read_b128 v[60:63], v35 offset:22528
    ds_read_b128 v[64:67], v35 offset:29696
    ds_read_b128 v[68:71], v35 offset:30720
    s_waitcnt lgkmcnt(0)
    v_mfma_f32_32x32x16_bf16 v[128:143], a[0:3], v[40:43], 0
    buffer_load_dwordx4 v4, s[8:11], s57 offen offset:2048 nt lds
    v_mfma_f32_32x32x16_bf16 v[128:143], a[4:7], v[44:47], v[128:143]
    v_mfma_f32_32x32x16_bf16 v[128:143], a[8:11], v[48:51], v[128:143]
    buffer_load_dwordx4 v5, s[8:11], s57 offen offset:3072 nt lds
    s_add_u32 s56, s56, 32768
    v_mfma_f32_32x32x16_bf16 v[128:143], a[12:15], v[52:55], v[128:143]
    v_mfma_f32_32x32x16_bf16 v[128:143], a[16:19], v[56:59], v[128:143]
    v_mfma_f32_32x32x16_bf16 v[128:143], a[20:23], v[60:63], v[128:143]
    v_mfma_f32_32x32x16_bf16 v[128:143], a[24:27], v[64:67], v[128:143]
    v_mfma_f32_32x32x16_bf16 v[128:143], a[28:31], v[68:71], v[128:143]
    v_mfma_f32_32x32x16_bf16 v[144:159], a[32:35], v[40:43], 0
    s_add_u32 m0, s4, 16384
    s_nop 0
    buffer_load_dwordx4 v2, s[8:11], s56 offen nt lds
    v_mfma_f32_32x32x16_bf16 v[144:159], a[36:39], v[44:47], v[144:159]
    v_mfma_f32_32x32x16_bf16 v[144:159], a[40:43], v[48:51], v[144:159]
    buffer_load_dwordx4 v3, s[8:11], s56 offen offset:1024 nt lds
    v_mfma_f32_32x32x16_bf16 v[144:159], a[44:47], v[52:55], v[144:159]
    v_mfma_f32_32x32x16_bf16 v[144:159], a[48:51], v[56:59], v[144:159]
    s_nop 2
    v_max3_f32 v32, v128, v129, v130
    v_max3_f32 v32, v32, v131, v132
    v_mfma_f32_32x32x16_bf16 v[144:159], a[52:55], v[60:63], v[144:159]
    v_max3_f32 v32, v32, v133, v134
    v_max3_f32 v32, v32, v135, v136
    v_mfma_f32_32x32x16_bf16 v[144:159], a[56:59], v[64:67], v[144:159]
    v_max3_f32 v32, v32, v137, v138
    v_max3_f32 v32, v32, v139, v140
    v_mfma_f32_32x32x16_bf16 v[144:159], a[60:63], v[68:71], v[144:159]
    v_max3_f32 v32, v32, v141, v142
    v_max_f32 v32, v32, v143
    buffer_load_dwordx4 v4, s[8:11], s56 offen offset:2048 nt lds
    buffer_load_dwordx4 v5, s[8:11], s56 offen offset:3072 nt lds
    s_add_u32 s57, s56, 16384
    s_add_u32 m0, s4, 20480
    s_nop 0
    buffer_load_dwordx4 v2, s[8:11], s57 offen nt lds
    buffer_load_dwordx4 v3, s[8:11], s57 offen offset:1024 nt lds
    buffer_load_dwordx4 v4, s[8:11], s57 offen offset:2048 nt lds
    s_waitcnt vmcnt(15)
    buffer_load_dwordx4 v5, s[8:11], s57 offen offset:3072 nt lds
    s_add_u32 s56, s56, 32768
    ds_read_b128 a[128:131], v10 offset:0
    ds_read_b128 a[132:135], v11 offset:0
    ds_read_b128 a[136:139], v12 offset:0
    ds_read_b128 a[140:143], v13 offset:0
    ds_read_b128 a[144:147], v14 offset:0
    ds_read_b128 a[148:151], v15 offset:0
    ds_read_b128 a[152:155], v16 offset:0
    ds_read_b128 a[156:159], v17 offset:0
    s_waitcnt lgkmcnt(0)
    v_mfma_f32_32x32x16_bf16 v[160:175], a[64:67], v[40:43], 0
    s_waitcnt vmcnt(15)
    s_add_u32 m0, s4, 24576
    s_nop 0
    buffer_load_dwordx4 v2, s[8:11], s56 offen nt lds
    v_mfma_f32_32x32x16_bf16 v[160:175], a[68:71], v[44:47], v[160:175]
    v_mfma_f32_32x32x16_bf16 v[160:175], a[72:75], v[48:51], v[160:175]
    s_waitcnt vmcnt(15)
    buffer_load_dwordx4 v3, s[8:11], s56 offen offset:1024 nt lds
    v_mfma_f32_32x32x16_bf16 v[160:175], a[76:79], v[52:55], v[160:175]
    v_mfma_f32_32x32x16_bf16 v[160:175], a[80:83], v[56:59], v[160:175]
    v_max3_f32 v32, v32, v144, v145
    v_max3_f32 v32, v32, v146, v147
    v_mfma_f32_32x32x16_bf16 v[160:175], a[84:87], v[60:63], v[160:175]
    v_max3_f32 v32, v32, v148, v149
    v_max3_f32 v32, v32, v150, v151
    v_mfma_f32_32x32x16_bf16 v[160:175], a[88:91], v[64:67], v[160:175]
    v_max3_f32 v32, v32, v152, v153
    v_max3_f32 v32, v32, v154, v155
    v_mfma_f32_32x32x16_bf16 v[160:175], a[92:95], v[68:71], v[160:175]
    v_max3_f32 v32, v32, v156, v157
    v_max3_f32 v32, v32, v158, v159
    v_mfma_f32_32x32x16_bf16 v[176:191], a[96:99], v[40:43], 0
    s_waitcnt vmcnt(15)
    buffer_load_dwordx4 v4, s[8:11], s56 offen offset:2048 nt lds
    v_mfma_f32_32x32x16_bf16 v[176:191], a[100:103], v[44:47], v[176:191]
    v_mfma_f32_32x32x16_bf16 v[176:191], a[104:107], v[48:51], v[176:191]
    s_waitcnt vmcnt(15)
    buffer_load_dwordx4 v5, s[8:11], s56 offen offset:3072 nt lds
    v_mfma_f32_32x32x16_bf16 v[176:191], a[108:111], v[52:55], v[176:191]
    v_mfma_f32_32x32x16_bf16 v[176:191], a[112:115], v[56:59], v[176:191]
    s_nop 0
    v_max3_f32 v32, v32, v160, v161
    v_max3_f32 v32, v32, v162, v163
    v_mfma_f32_32x32x16_bf16 v[176:191], a[116:119], v[60:63], v[176:191]
    v_max3_f32 v32, v32, v164, v165
    v_max3_f32 v32, v32, v166, v167
    v_mfma_f32_32x32x16_bf16 v[176:191], a[120:123], v[64:67], v[176:191]
    v_max3_f32 v32, v32, v168, v169
    v_max3_f32 v32, v32, v170, v171
    v_mfma_f32_32x32x16_bf16 v[176:191], a[124:127], v[68:71], v[176:191]
    v_max3_f32 v32, v32, v172, v173
    v_max3_f32 v32, v32, v174, v175
    s_waitcnt vmcnt(15)
    s_add_u32 s57, s56, 16384
    s_add_u32 m0, s4, 28672
    s_nop 0
    buffer_load_dwordx4 v2, s[8:11], s57 offen nt lds
    s_waitcnt vmcnt(15)
    buffer_load_dwordx4 v3, s[8:11], s57 offen offset:1024 nt lds
    s_waitcnt vmcnt(15)
    buffer_load_dwordx4 v4, s[8:11], s57 offen offset:2048 nt lds
    s_waitcnt vmcnt(15)
    buffer_load_dwordx4 v5, s[8:11], s57 offen offset:3072 nt lds
    s_add_u32 s56, s56, 32768
    ds_read_b128 a[160:163], v10 offset:8192
    ds_read_b128 a[164:167], v11 offset:8192
    ds_read_b128 a[168:171], v12 offset:8192
    ds_read_b128 a[172:175], v13 offset:8192
    ds_read_b128 a[176:179], v14 offset:8192
    ds_read_b128 a[180:183], v15 offset:8192
    ds_read_b128 a[184:187], v16 offset:8192
    ds_read_b128 a[188:191], v17 offset:8192
    s_waitcnt lgkmcnt(0)
    s_getpc_b64 s[48:49]
L_g1pf2:
    s_add_u32 s48, s48, L_g1tail-L_g1pf2
    s_addc_u32 s49, s49, 0
    s_lshl_b32 s7, s52, 2
    s_add_u32 s7, s7, s3
    s_mul_i32 s7, s7, 256
    v_lshl_add_u32 v101, v1, 7, s7
    v_min_u32 v101, L_g2-L_g1tail-4, v101
    s_mov_b64 exec, 3
    global_load_dword v31, v101, s[48:49]
    s_mov_b64 exec, -1
L_g1pf2_x:
    v_mfma_f32_32x32x16_bf16 v[192:207], a[128:131], v[40:43], 0
    s_waitcnt vmcnt(15)
    v_lshrrev_b32 v7, 4, v1
    v_and_b32 v8, 15, v1
    v_lshlrev_b32 v9, 2, v7
    v_xor_b32 v8, v8, v9
    v_lshlrev_b32 v8, 4, v8
    v_lshl_add_u32 v6, v7, 8, v8
    v_add_u32 v7, 3072, v6
    v_add_u32 v8, 6144, v6
    v_add_u32 v9, 9216, v6
    s_mov_b32 s12, s30
    s_mov_b32 s13, s31
    s_mov_b32 s14, 67108864
    s_mov_b32 s15, 0x20000
    s_lshl_b32 s63, s55, 18
    s_lshl_b32 s7, s3, 10
    s_add_u32 s63, s63, s7
    s_mov_b32 s60, s63
    s_add_u32 m0, s4, 0
    s_nop 0
    buffer_load_dwordx4 v6, s[12:15], s60 offen nt lds
    v_mfma_f32_32x32x16_bf16 v[192:207], a[132:135], v[44:47], v[192:207]
    v_mfma_f32_32x32x16_bf16 v[192:207], a[136:139], v[48:51], v[192:207]
    s_waitcnt vmcnt(15)
    buffer_load_dwordx4 v7, s[12:15], s60 offen offset:1024 nt lds
    v_mfma_f32_32x32x16_bf16 v[192:207], a[140:143], v[52:55], v[192:207]
    v_mfma_f32_32x32x16_bf16 v[192:207], a[144:147], v[56:59], v[192:207]
    v_max3_f32 v32, v32, v176, v177
    v_max3_f32 v32, v32, v178, v179
    v_mfma_f32_32x32x16_bf16 v[192:207], a[148:151], v[60:63], v[192:207]
    v_max3_f32 v32, v32, v180, v181
    v_max3_f32 v32, v32, v182, v183
    v_mfma_f32_32x32x16_bf16 v[192:207], a[152:155], v[64:67], v[192:207]
    v_max3_f32 v32, v32, v184, v185
    v_max3_f32 v32, v32, v186, v187
    v_mfma_f32_32x32x16_bf16 v[192:207], a[156:159], v[68:71], v[192:207]
    v_max3_f32 v32, v32, v188, v189
    v_max3_f32 v32, v32, v190, v191
    v_mfma_f32_32x32x16_bf16 v[208:223], a[160:163], v[40:43], 0
    s_waitcnt vmcnt(15)
    buffer_load_dwordx4 v8, s[12:15], s60 offen offset:2048 nt lds
    v_mfma_f32_32x32x16_bf16 v[208:223], a[164:167], v[44:47], v[208:223]
    v_mfma_f32_32x32x16_bf16 v[208:223], a[168:171], v[48:51], v[208:223]
    s_waitcnt vmcnt(15)
    buffer_load_dwordx4 v9, s[12:15], s60 offen offset:3072 nt lds
    v_mfma_f32_32x32x16_bf16 v[208:223], a[172:175], v[52:55], v[208:223]
    v_mfma_f32_32x32x16_bf16 v[208:223], a[176:179], v[56:59], v[208:223]
    s_nop 0
    v_max3_f32 v32, v32, v192, v193
    v_max3_f32 v32, v32, v194, v195
    v_mfma_f32_32x32x16_bf16 v[208:223], a[180:183], v[60:63], v[208:223]
    v_max3_f32 v32, v32, v196, v197
    v_max3_f32 v32, v32, v198, v199
    v_mfma_f32_32x32x16_bf16 v[208:223], a[184:187], v[64:67], v[208:223]
    v_max3_f32 v32, v32, v200, v201
    v_max3_f32 v32, v32, v202, v203
    v_mfma_f32_32x32x16_bf16 v[208:223], a[188:191], v[68:71], v[208:223]
    v_max3_f32 v32, v32, v204, v205
    v_max3_f32 v32, v32, v206, v207
    s_waitcnt vmcnt(15)
    s_add_u32 s61, s60, 16384
    s_add_u32 m0, s4, 4096
    s_nop 0
    buffer_load_dwordx4 v6, s[12:15], s61 offen nt lds
    s_waitcnt vmcnt(15)
    buffer_load_dwordx4 v7, s[12:15], s61 offen offset:1024 nt lds
    s_waitcnt vmcnt(15)
    buffer_load_dwordx4 v8, s[12:15], s61 offen offset:2048 nt lds
    s_waitcnt vmcnt(15)
    buffer_load_dwordx4 v9, s[12:15], s61 offen offset:3072 nt lds
    s_add_u32 s60, s60, 32768
    ds_read_b128 a[192:195], v10 offset:16384
    ds_read_b128 a[196:199], v11 offset:16384
    ds_read_b128 a[200:203], v12 offset:16384
    ds_read_b128 a[204:207], v13 offset:16384
    ds_read_b128 a[208:211], v14 offset:16384
    ds_read_b128 a[212:215], v15 offset:16384
    ds_read_b128 a[216:219], v16 offset:16384
    ds_read_b128 a[220:223], v17 offset:16384
    s_waitcnt lgkmcnt(0)
    v_mfma_f32_32x32x16_bf16 v[224:239], a[192:195], v[40:43], 0
    s_waitcnt vmcnt(15)
    s_add_u32 m0, s4, 8192
    s_nop 0
    buffer_load_dwordx4 v6, s[12:15], s60 offen nt lds
    v_mfma_f32_32x32x16_bf16 v[224:239], a[196:199], v[44:47], v[224:239]
    v_mfma_f32_32x32x16_bf16 v[224:239], a[200:203], v[48:51], v[224:239]
    s_waitcnt vmcnt(15)
    buffer_load_dwordx4 v7, s[12:15], s60 offen offset:1024 nt lds
    v_mfma_f32_32x32x16_bf16 v[224:239], a[204:207], v[52:55], v[224:239]
    v_mfma_f32_32x32x16_bf16 v[224:239], a[208:211], v[56:59], v[224:239]
    v_max3_f32 v32, v32, v208, v209
    v_max3_f32 v32, v32, v210, v211
    v_mfma_f32_32x32x16_bf16 v[224:239], a[212:215], v[60:63], v[224:239]
    v_max3_f32 v32, v32, v212, v213
    v_max3_f32 v32, v32, v214, v215
    v_mfma_f32_32x32x16_bf16 v[224:239], a[216:219], v[64:67], v[224:239]
    v_max3_f32 v32, v32, v216, v217
    v_max3_f32 v32, v32, v218, v219
    v_mfma_f32_32x32x16_bf16 v[224:239], a[220:223], v[68:71], v[224:239]
    v_max3_f32 v32, v32, v220, v221
    v_max3_f32 v32, v32, v222, v223
    s_waitcnt vmcnt(15)
    buffer_load_dwordx4 v8, s[12:15], s60 offen offset:2048 nt lds
    s_waitcnt vmcnt(15)
    buffer_load_dwordx4 v9, s[12:15], s60 offen offset:3072 nt lds
    s_waitcnt vmcnt(15)
    s_add_u32 s61, s60, 16384
    s_add_u32 m0, s4, 12288
    s_nop 0
    buffer_load_dwordx4 v6, s[12:15], s61 offen nt lds
    s_waitcnt vmcnt(15)
    buffer_load_dwordx4 v7, s[12:15], s61 offen offset:1024 nt lds
    s_waitcnt vmcnt(15)
    buffer_load_dwordx4 v8, s[12:15], s61 offen offset:2048 nt lds
    s_waitcnt vmcnt(15)
    buffer_load_dwordx4 v9, s[12:15], s61 offen offset:3072 nt lds
    s_add_u32 s60, s60, 32768
    ds_read_b128 a[224:227], v10 offset:24576
    ds_read_b128 a[228:231], v11 offset:24576
    ds_read_b128 a[232:235], v12 offset:24576
    ds_read_b128 a[236:239], v13 offset:24576
    ds_read_b128 a[240:243], v14 offset:24576
    ds_read_b128 a[244:247], v15 offset:24576
    ds_read_b128 a[248:251], v16 offset:24576
    ds_read_b128 a[252:255], v17 offset:24576
    s_waitcnt lgkmcnt(0)
    v_mfma_f32_32x32x16_bf16 v[240:255], a[224:227], v[40:43], 0
    s_waitcnt vmcnt(15)
    s_add_u32 m0, s4, 16384
    s_nop 0
    buffer_load_dwordx4 v6, s[12:15], s60 offen nt lds
    v_mfma_f32_32x32x16_bf16 v[240:255], a[228:231], v[44:47], v[240:255]
    v_mfma_f32_32x32x16_bf16 v[240:255], a[232:235], v[48:51], v[240:255]
    s_waitcnt vmcnt(15)
    buffer_load_dwordx4 v7, s[12:15], s60 offen offset:1024 nt lds
    v_mfma_f32_32x32x16_bf16 v[240:255], a[236:239], v[52:55], v[240:255]
    v_mfma_f32_32x32x16_bf16 v[240:255], a[240:243], v[56:59], v[240:255]
    v_max3_f32 v32, v32, v224, v225
    v_max3_f32 v32, v32, v226, v227
    v_mfma_f32_32x32x16_bf16 v[240:255], a[244:247], v[60:63], v[240:255]
    v_max3_f32 v32, v32, v228, v229
    v_max3_f32 v32, v32, v230, v231
    v_mfma_f32_32x32x16_bf16 v[240:255], a[248:251], v[64:67], v[240:255]
    v_max3_f32 v32, v32, v232, v233
    v_max3_f32 v32, v32, v234, v235
    v_mfma_f32_32x32x16_bf16 v[240:255], a[252:255], v[68:71], v[240:255]
    v_max3_f32 v32, v32, v236, v237
    v_max3_f32 v32, v32, v238, v239
    s_nop 9
    v_max3_f32 v32, v32, v240, v241
    v_max3_f32 v32, v32, v242, v243
    v_max3_f32 v32, v32, v244, v245
    v_max3_f32 v32, v32, v246, v247
    v_max3_f32 v32, v32, v248, v249
    v_max3_f32 v32, v32, v250, v251
    v_max3_f32 v32, v32, v252, v253
    v_max3_f32 v32, v32, v254, v255
    v_mov_b32 v33, v32
    s_nop 1
    v_permlane32_swap_b32 v32, v33
    v_max_f32 v32, v32, v33
    v_mul_f32 v32, -0.5, v32
    v_cvt_pk_bf16_f32 v33, v32, v32
    v_lshlrev_b32 v33, 16, v33
    v_sub_f32 v32, v32, v33
    v_cvt_pk_bf16_f32 v104, v33, v32
    v_and_b32 v32, 0xffff0000, v104
    v_add_f32 v32, v32, v33
    v_mul_f32 v32, -2.0, v32
    v_mov_b32 v105, 0
    v_mov_b32 v106, 0
    v_mov_b32 v107, 0
    v_mov_b32 v36, 0x3f803f80
    v_mov_b32 v37, 0x3f803f80
    v_mov_b32 v38, 0x3f803f80
    v_mov_b32 v39, 0x3f803f80
    v_lshrrev_b32 v26, 4, v1
    v_xor_b32 v26, v26, v1
    v_and_b32 v26, 1, v26
    v_add_u32 v26, -1, v26
    v_and_b32 v26, 0x3f803f80, v26
    v_mov_b32 v27, v26
    v_mov_b32 v28, v26
    v_mov_b32 v29, v26
    v_mfma_f32_32x32x16_bf16 v[128:143], v[36:39], v[104:107], v[128:143]
    v_mfma_f32_32x32x16_bf16 v[144:159], v[36:39], v[104:107], v[144:159]
    s_nop 10
    v_exp_f32 v128, v128
    v_exp_f32 v129, v129
    v_exp_f32 v130, v130
    v_exp_f32 v131, v131
    v_exp_f32 v132, v132
    v_exp_f32 v133, v133
    v_exp_f32 v134, v134
    v_exp_f32 v135, v135
    v_exp_f32 v136, v136
    v_exp_f32 v137, v137
    v_exp_f32 v138, v138
    v_exp_f32 v139, v139
    v_exp_f32 v140, v140
    v_exp_f32 v141, v141
    v_exp_f32 v142, v142
    v_exp_f32 v143, v143
    v_cvt_pk_bf16_f32 v128, v128, v129
    v_cvt_pk_bf16_f32 v129, v130, v131
    v_cvt_pk_bf16_f32 v130, v132, v133
    v_cvt_pk_bf16_f32 v131, v134, v135
    v_cvt_pk_bf16_f32 v132, v136, v137
    v_cvt_pk_bf16_f32 v133, v138, v139
    v_cvt_pk_bf16_f32 v134, v140, v141
    v_cvt_pk_bf16_f32 v135, v142, v143
    v_mfma_f32_32x32x16_bf16 v[160:175], v[36:39], v[104:107], v[160:175]
    s_waitcnt vmcnt(10)
    ds_read_b64_tr_b16 v[72:73], v18 offset:0
    ds_read_b64_tr_b16 v[74:75], v18 offset:2048
    ds_read_b64_tr_b16 v[76:77], v18 offset:4096
    ds_read_b64_tr_b16 v[78:79], v18 offset:6144
    ds_read_b64_tr_b16 v[80:81], v19 offset:0
    ds_read_b64_tr_b16 v[82:83], v19 offset:2048
    ds_read_b64_tr_b16 v[84:85], v19 offset:4096
    ds_read_b64_tr_b16 v[86:87], v19 offset:6144
    ds_read_b64_tr_b16 v[88:89], v20 offset:0
    ds_read_b64_tr_b16 v[90:91], v20 offset:2048
    ds_read_b64_tr_b16 v[92:93], v20 offset:4096
    ds_read_b64_tr_b16 v[94:95], v20 offset:6144
    ds_read_b64_tr_b16 v[96:97], v21 offset:0
    ds_read_b64_tr_b16 v[98:99], v21 offset:2048
    ds_read_b64_tr_b16 v[100:101], v21 offset:4096
    ds_read_b64_tr_b16 v[102:103], v21 offset:6144
    v_mfma_f32_16x16x32_bf16 a[64:67], v[26:29], v[128:131], 0
    v_exp_f32 v144, v144
    v_exp_f32 v145, v145
    v_mfma_f32_16x16x32_bf16 a[64:67], v[26:29], v[132:135], a[64:67]
    v_exp_f32 v146, v146
    v_exp_f32 v147, v147
    s_waitcnt lgkmcnt(12)
    v_mfma_f32_32x32x16_bf16 a[0:15], v[72:75], v[128:131], 0
    v_exp_f32 v148, v148
    v_exp_f32 v149, v149
    v_exp_f32 v150, v150
    buffer_load_dwordx4 v8, s[12:15], s60 offen offset:2048 nt lds
    v_mfma_f32_32x32x16_bf16 a[0:15], v[76:79], v[132:135], a[0:15]
    v_exp_f32 v151, v151
    v_exp_f32 v152, v152
    v_exp_f32 v153, v153
    buffer_load_dwordx4 v9, s[12:15], s60 offen offset:3072 nt lds
    s_waitcnt lgkmcnt(8)
    v_mfma_f32_32x32x16_bf16 a[16:31], v[80:83], v[128:131], 0
    v_exp_f32 v154, v154
    v_exp_f32 v155, v155
    v_exp_f32 v156, v156
    s_add_u32 s61, s60, 16384
    s_add_u32 m0, s4, 20480
    s_nop 0
    buffer_load_dwordx4 v6, s[12:15], s61 offen nt lds
    v_mfma_f32_32x32x16_bf16 a[16:31], v[84:87], v[132:135], a[16:31]
    v_exp_f32 v157, v157
    v_exp_f32 v158, v158
    v_exp_f32 v159, v159
    buffer_load_dwordx4 v7, s[12:15], s61 offen offset:1024 nt lds
    s_waitcnt lgkmcnt(4)
    v_mfma_f32_32x32x16_bf16 a[32:47], v[88:91], v[128:131], 0
    v_cvt_pk_bf16_f32 v144, v144, v145
    v_cvt_pk_bf16_f32 v145, v146, v147
    v_cvt_pk_bf16_f32 v146, v148, v149
    buffer_load_dwordx4 v8, s[12:15], s61 offen offset:2048 nt lds
    v_mfma_f32_32x32x16_bf16 a[32:47], v[92:95], v[132:135], a[32:47]
    v_cvt_pk_bf16_f32 v147, v150, v151
    v_cvt_pk_bf16_f32 v148, v152, v153
    v_cvt_pk_bf16_f32 v149, v154, v155
    buffer_load_dwordx4 v9, s[12:15], s61 offen offset:3072 nt lds
    s_add_u32 s60, s60, 32768
    s_waitcnt lgkmcnt(0)
    v_mfma_f32_32x32x16_bf16 a[48:63], v[96:99], v[128:131], 0
    v_cvt_pk_bf16_f32 v150, v156, v157
    v_cvt_pk_bf16_f32 v151, v158, v159
    s_waitcnt vmcnt(15)
    s_add_u32 m0, s4, 24576
    s_nop 0
    buffer_load_dwordx4 v6, s[12:15], s60 offen nt lds
    v_mfma_f32_32x32x16_bf16 a[48:63], v[100:103], v[132:135], a[48:63]
    s_waitcnt vmcnt(15)
    buffer_load_dwordx4 v7, s[12:15], s60 offen offset:1024 nt lds
    v_mfma_f32_32x32x16_bf16 v[176:191], v[36:39], v[104:107], v[176:191]
    s_waitcnt vmcnt(10)
    ds_read_b64_tr_b16 v[72:73], v18 offset:8192
    ds_read_b64_tr_b16 v[74:75], v18 offset:10240
    ds_read_b64_tr_b16 v[76:77], v18 offset:12288
    ds_read_b64_tr_b16 v[78:79], v18 offset:14336
    ds_read_b64_tr_b16 v[80:81], v19 offset:8192
    ds_read_b64_tr_b16 v[82:83], v19 offset:10240
    ds_read_b64_tr_b16 v[84:85], v19 offset:12288
    ds_read_b64_tr_b16 v[86:87], v19 offset:14336
    ds_read_b64_tr_b16 v[88:89], v20 offset:8192
    ds_read_b64_tr_b16 v[90:91], v20 offset:10240
    ds_read_b64_tr_b16 v[92:93], v20 offset:12288
    ds_read_b64_tr_b16 v[94:95], v20 offset:14336
    ds_read_b64_tr_b16 v[96:97], v21 offset:8192
    ds_read_b64_tr_b16 v[98:99], v21 offset:10240
    ds_read_b64_tr_b16 v[100:101], v21 offset:12288
    ds_read_b64_tr_b16 v[102:103], v21 offset:14336
    v_mfma_f32_16x16x32_bf16 a[64:67], v[26:29], v[144:147], a[64:67]
    v_exp_f32 v160, v160
    v_exp_f32 v161, v161
    v_mfma_f32_16x16x32_bf16 a[64:67], v[26:29], v[148:151], a[64:67]
    v_exp_f32 v162, v162
    v_exp_f32 v163, v163
    s_waitcnt lgkmcnt(12)
    v_mfma_f32_32x32x16_bf16 a[0:15], v[72:75], v[144:147], a[0:15]
    v_exp_f32 v164, v164
    v_exp_f32 v165, v165
    v_exp_f32 v166, v166
    buffer_load_dwordx4 v8, s[12:15], s60 offen offset:2048 nt lds
    v_mfma_f32_32x32x16_bf16 a[0:15], v[76:79], v[148:151], a[0:15]
    v_exp_f32 v167, v167
    v_exp_f32 v168, v168
    v_exp_f32 v169, v169
    buffer_load_dwordx4 v9, s[12:15], s60 offen offset:3072 nt lds
    s_waitcnt lgkmcnt(8)
    v_mfma_f32_32x32x16_bf16 a[16:31], v[80:83], v[144:147], a[16:31]
    v_exp_f32 v170, v170
    v_exp_f32 v171, v171
    v_exp_f32 v172, v172
    s_add_u32 s61, s60, 16384
    s_add_u32 m0, s4, 28672
    s_nop 0
    buffer_load_dwordx4 v6, s[12:15], s61 offen nt lds
    v_mfma_f32_32x32x16_bf16 a[16:31], v[84:87], v[148:151], a[16:31]
    v_exp_f32 v173, v173
    v_exp_f32 v174, v174
    v_exp_f32 v175, v175
    buffer_load_dwordx4 v7, s[12:15], s61 offen offset:1024 nt lds
    s_waitcnt lgkmcnt(4)
    v_mfma_f32_32x32x16_bf16 a[32:47], v[88:91], v[144:147], a[32:47]
    v_cvt_pk_bf16_f32 v160, v160, v161
    v_cvt_pk_bf16_f32 v161, v162, v163
    v_cvt_pk_bf16_f32 v162, v164, v165
    buffer_load_dwordx4 v8, s[12:15], s61 offen offset:2048 nt lds
    v_mfma_f32_32x32x16_bf16 a[32:47], v[92:95], v[148:151], a[32:47]
    v_cvt_pk_bf16_f32 v163, v166, v167
    v_cvt_pk_bf16_f32 v164, v168, v169
    v_cvt_pk_bf16_f32 v165, v170, v171
    buffer_load_dwordx4 v9, s[12:15], s61 offen offset:3072 nt lds
    s_add_u32 s60, s60, 32768
    s_waitcnt lgkmcnt(0)
    v_mfma_f32_32x32x16_bf16 a[48:63], v[96:99], v[144:147], a[48:63]
    v_cvt_pk_bf16_f32 v166, v172, v173
    v_cvt_pk_bf16_f32 v167, v174, v175
    s_waitcnt vmcnt(15)
    s_add_u32 m0, s4, 0
    s_nop 0
    buffer_load_dwordx4 v6, s[12:15], s60 offen nt lds
    v_mfma_f32_32x32x16_bf16 a[48:63], v[100:103], v[148:151], a[48:63]
    s_waitcnt vmcnt(15)
    buffer_load_dwordx4 v7, s[12:15], s60 offen offset:1024 nt lds
    v_mfma_f32_32x32x16_bf16 v[192:207], v[36:39], v[104:107], v[192:207]
    s_waitcnt vmcnt(10)
    ds_read_b64_tr_b16 v[72:73], v18 offset:16384
    ds_read_b64_tr_b16 v[74:75], v18 offset:18432
    ds_read_b64_tr_b16 v[76:77], v18 offset:20480
    ds_read_b64_tr_b16 v[78:79], v18 offset:22528
    ds_read_b64_tr_b16 v[80:81], v19 offset:16384
    ds_read_b64_tr_b16 v[82:83], v19 offset:18432
    ds_read_b64_tr_b16 v[84:85], v19 offset:20480
    ds_read_b64_tr_b16 v[86:87], v19 offset:22528
    ds_read_b64_tr_b16 v[88:89], v20 offset:16384
    ds_read_b64_tr_b16 v[90:91], v20 offset:18432
    ds_read_b64_tr_b16 v[92:93], v20 offset:20480
    ds_read_b64_tr_b16 v[94:95], v20 offset:22528
    ds_read_b64_tr_b16 v[96:97], v21 offset:16384
    ds_read_b64_tr_b16 v[98:99], v21 offset:18432
    ds_read_b64_tr_b16 v[100:101], v21 offset:20480
    ds_read_b64_tr_b16 v[102:103], v21 offset:22528
    v_mfma_f32_16x16x32_bf16 a[64:67], v[26:29], v[160:163], a[64:67]
    v_exp_f32 v176, v176
    v_exp_f32 v177, v177
    v_mfma_f32_16x16x32_bf16 a[64:67], v[26:29], v[164:167], a[64:67]
    v_exp_f32 v178, v178
    v_exp_f32 v179, v179
    s_waitcnt lgkmcnt(12)
    v_mfma_f32_32x32x16_bf16 a[0:15], v[72:75], v[160:163], a[0:15]
    v_exp_f32 v180, v180
    v_exp_f32 v181, v181
    v_exp_f32 v182, v182
    buffer_load_dwordx4 v8, s[12:15], s60 offen offset:2048 nt lds
    v_mfma_f32_32x32x16_bf16 a[0:15], v[76:79], v[164:167], a[0:15]
    v_exp_f32 v183, v183
    v_exp_f32 v184, v184
    v_exp_f32 v185, v185
    buffer_load_dwordx4 v9, s[12:15], s60 offen offset:3072 nt lds
    s_waitcnt lgkmcnt(8)
    v_mfma_f32_32x32x16_bf16 a[16:31], v[80:83], v[160:163], a[16:31]
    v_exp_f32 v186, v186
    v_exp_f32 v187, v187
    v_exp_f32 v188, v188
    s_add_u32 s61, s60, 16384
    s_add_u32 m0, s4, 4096
    s_nop 0
    buffer_load_dwordx4 v6, s[12:15], s61 offen nt lds
    v_mfma_f32_32x32x16_bf16 a[16:31], v[84:87], v[164:167], a[16:31]
    v_exp_f32 v189, v189
    v_exp_f32 v190, v190
    v_exp_f32 v191, v191
    buffer_load_dwordx4 v7, s[12:15], s61 offen offset:1024 nt lds
    s_waitcnt lgkmcnt(4)
    v_mfma_f32_32x32x16_bf16 a[32:47], v[88:91], v[160:163], a[32:47]
    v_cvt_pk_bf16_f32 v176, v176, v177
    v_cvt_pk_bf16_f32 v177, v178, v179
    v_cvt_pk_bf16_f32 v178, v180, v181
    buffer_load_dwordx4 v8, s[12:15], s61 offen offset:2048 nt lds
    v_mfma_f32_32x32x16_bf16 a[32:47], v[92:95], v[164:167], a[32:47]
    v_cvt_pk_bf16_f32 v179, v182, v183
    v_cvt_pk_bf16_f32 v180, v184, v185
    v_cvt_pk_bf16_f32 v181, v186, v187
    buffer_load_dwordx4 v9, s[12:15], s61 offen offset:3072 nt lds
    s_add_u32 s60, s60, 32768
    s_waitcnt lgkmcnt(0)
    v_mfma_f32_32x32x16_bf16 a[48:63], v[96:99], v[160:163], a[48:63]
    v_cvt_pk_bf16_f32 v182, v188, v189
    v_cvt_pk_bf16_f32 v183, v190, v191
    s_waitcnt vmcnt(15)
    s_add_u32 m0, s4, 8192
    s_nop 0
    buffer_load_dwordx4 v6, s[12:15], s60 offen nt lds
    v_mfma_f32_32x32x16_bf16 a[48:63], v[100:103], v[164:167], a[48:63]
    s_waitcnt vmcnt(15)
    buffer_load_dwordx4 v7, s[12:15], s60 offen offset:1024 nt lds
    v_mfma_f32_32x32x16_bf16 v[208:223], v[36:39], v[104:107], v[208:223]
    s_waitcnt vmcnt(10)
    ds_read_b64_tr_b16 v[72:73], v18 offset:24576
    ds_read_b64_tr_b16 v[74:75], v18 offset:26624
    ds_read_b64_tr_b16 v[76:77], v18 offset:28672
    ds_read_b64_tr_b16 v[78:79], v18 offset:30720
    ds_read_b64_tr_b16 v[80:81], v19 offset:24576
    ds_read_b64_tr_b16 v[82:83], v19 offset:26624
    ds_read_b64_tr_b16 v[84:85], v19 offset:28672
    ds_read_b64_tr_b16 v[86:87], v19 offset:30720
    ds_read_b64_tr_b16 v[88:89], v20 offset:24576
    ds_read_b64_tr_b16 v[90:91], v20 offset:26624
    ds_read_b64_tr_b16 v[92:93], v20 offset:28672
    ds_read_b64_tr_b16 v[94:95], v20 offset:30720
    ds_read_b64_tr_b16 v[96:97], v21 offset:24576
    ds_read_b64_tr_b16 v[98:99], v21 offset:26624
    ds_read_b64_tr_b16 v[100:101], v21 offset:28672
    ds_read_b64_tr_b16 v[102:103], v21 offset:30720
    v_mfma_f32_16x16x32_bf16 a[64:67], v[26:29], v[176:179], a[64:67]
    v_exp_f32 v192, v192
    v_exp_f32 v193, v193
    v_mfma_f32_16x16x32_bf16 a[64:67], v[26:29], v[180:183], a[64:67]
    v_exp_f32 v194, v194
    v_exp_f32 v195, v195
    s_waitcnt lgkmcnt(12)
    v_mfma_f32_32x32x16_bf16 a[0:15], v[72:75], v[176:179], a[0:15]
    v_exp_f32 v196, v196
    v_exp_f32 v197, v197
    v_exp_f32 v198, v198
    buffer_load_dwordx4 v8, s[12:15], s60 offen offset:2048 nt lds
    v_mfma_f32_32x32x16_bf16 a[0:15], v[76:79], v[180:183], a[0:15]
    v_exp_f32 v199, v199
    v_exp_f32 v200, v200
    v_exp_f32 v201, v201
    buffer_load_dwordx4 v9, s[12:15], s60 offen offset:3072 nt lds
    s_waitcnt lgkmcnt(8)
    v_mfma_f32_32x32x16_bf16 a[16:31], v[80:83], v[176:179], a[16:31]
    v_exp_f32 v202, v202
    v_exp_f32 v203, v203
    v_exp_f32 v204, v204
    s_add_u32 s61, s60, 16384
    s_add_u32 m0, s4, 12288
    s_nop 0
    buffer_load_dwordx4 v6, s[12:15], s61 offen nt lds
    v_mfma_f32_32x32x16_bf16 a[16:31], v[84:87], v[180:183], a[16:31]
    v_exp_f32 v205, v205
    v_exp_f32 v206, v206
    v_exp_f32 v207, v207
    buffer_load_dwordx4 v7, s[12:15], s61 offen offset:1024 nt lds
    s_waitcnt lgkmcnt(4)
    v_mfma_f32_32x32x16_bf16 a[32:47], v[88:91], v[176:179], a[32:47]
    v_cvt_pk_bf16_f32 v192, v192, v193
    v_cvt_pk_bf16_f32 v193, v194, v195
    v_cvt_pk_bf16_f32 v194, v196, v197
    buffer_load_dwordx4 v8, s[12:15], s61 offen offset:2048 nt lds
    v_mfma_f32_32x32x16_bf16 a[32:47], v[92:95], v[180:183], a[32:47]
    v_cvt_pk_bf16_f32 v195, v198, v199
    v_cvt_pk_bf16_f32 v196, v200, v201
    v_cvt_pk_bf16_f32 v197, v202, v203
    buffer_load_dwordx4 v9, s[12:15], s61 offen offset:3072 nt lds
    s_add_u32 s60, s60, 32768
    s_waitcnt lgkmcnt(0)
    v_mfma_f32_32x32x16_bf16 a[48:63], v[96:99], v[176:179], a[48:63]
    v_cvt_pk_bf16_f32 v198, v204, v205
    v_cvt_pk_bf16_f32 v199, v206, v207
    s_waitcnt vmcnt(15)
    s_add_u32 m0, s4, 16384
    s_nop 0
    buffer_load_dwordx4 v6, s[12:15], s60 offen nt lds
    v_mfma_f32_32x32x16_bf16 a[48:63], v[100:103], v[180:183], a[48:63]
    s_waitcnt vmcnt(15)
    buffer_load_dwordx4 v7, s[12:15], s60 offen offset:1024 nt lds
    v_mfma_f32_32x32x16_bf16 v[224:239], v[36:39], v[104:107], v[224:239]
    s_waitcnt vmcnt(10)
    ds_read_b64_tr_b16 v[72:73], v18 offset:0
    ds_read_b64_tr_b16 v[74:75], v18 offset:2048
    ds_read_b64_tr_b16 v[76:77], v18 offset:4096
    ds_read_b64_tr_b16 v[78:79], v18 offset:6144
    ds_read_b64_tr_b16 v[80:81], v19 offset:0
    ds_read_b64_tr_b16 v[82:83], v19 offset:2048
    ds_read_b64_tr_b16 v[84:85], v19 offset:4096
    ds_read_b64_tr_b16 v[86:87], v19 offset:6144
    ds_read_b64_tr_b16 v[88:89], v20 offset:0
    ds_read_b64_tr_b16 v[90:91], v20 offset:2048
    ds_read_b64_tr_b16 v[92:93], v20 offset:4096
    ds_read_b64_tr_b16 v[94:95], v20 offset:6144
    ds_read_b64_tr_b16 v[96:97], v21 offset:0
    ds_read_b64_tr_b16 v[98:99], v21 offset:2048
    ds_read_b64_tr_b16 v[100:101], v21 offset:4096
    ds_read_b64_tr_b16 v[102:103], v21 offset:6144
    v_mfma_f32_16x16x32_bf16 a[64:67], v[26:29], v[192:195], a[64:67]
    v_exp_f32 v208, v208
    v_exp_f32 v209, v209
    v_mfma_f32_16x16x32_bf16 a[64:67], v[26:29], v[196:199], a[64:67]
    v_exp_f32 v210, v210
    v_exp_f32 v211, v211
    s_waitcnt lgkmcnt(12)
    v_mfma_f32_32x32x16_bf16 a[0:15], v[72:75], v[192:195], a[0:15]
    v_exp_f32 v212, v212
    v_exp_f32 v213, v213
    v_exp_f32 v214, v214
    buffer_load_dwordx4 v8, s[12:15], s60 offen offset:2048 nt lds
    v_mfma_f32_32x32x16_bf16 a[0:15], v[76:79], v[196:199], a[0:15]
    v_exp_f32 v215, v215
    v_exp_f32 v216, v216
    v_exp_f32 v217, v217
    buffer_load_dwordx4 v9, s[12:15], s60 offen offset:3072 nt lds
    s_waitcnt lgkmcnt(8)
    v_mfma_f32_32x32x16_bf16 a[16:31], v[80:83], v[192:195], a[16:31]
    v_exp_f32 v218, v218
    v_exp_f32 v219, v219
    v_exp_f32 v220, v220
    s_add_u32 s61, s60, 16384
    s_add_u32 m0, s4, 20480
    s_nop 0
    buffer_load_dwordx4 v6, s[12:15], s61 offen nt lds
    v_mfma_f32_32x32x16_bf16 a[16:31], v[84:87], v[196:199], a[16:31]
    v_exp_f32 v221, v221
    v_exp_f32 v222, v222
    v_exp_f32 v223, v223
    buffer_load_dwordx4 v7, s[12:15], s61 offen offset:1024 nt lds
    s_waitcnt lgkmcnt(4)
    v_mfma_f32_32x32x16_bf16 a[32:47], v[88:91], v[192:195], a[32:47]
    v_cvt_pk_bf16_f32 v208, v208, v209
    v_cvt_pk_bf16_f32 v209, v210, v211
    v_cvt_pk_bf16_f32 v210, v212, v213
    buffer_load_dwordx4 v8, s[12:15], s61 offen offset:2048 nt lds
    v_mfma_f32_32x32x16_bf16 a[32:47], v[92:95], v[196:199], a[32:47]
    v_cvt_pk_bf16_f32 v211, v214, v215
    v_cvt_pk_bf16_f32 v212, v216, v217
    v_cvt_pk_bf16_f32 v213, v218, v219
    buffer_load_dwordx4 v9, s[12:15], s61 offen offset:3072 nt lds
    s_add_u32 s60, s60, 32768
    s_waitcnt lgkmcnt(0)
    v_mfma_f32_32x32x16_bf16 a[48:63], v[96:99], v[192:195], a[48:63]
    v_cvt_pk_bf16_f32 v214, v220, v221
    v_cvt_pk_bf16_f32 v215, v222, v223
    s_waitcnt vmcnt(15)
    s_add_u32 m0, s4, 24576
    s_nop 0
    buffer_load_dwordx4 v6, s[12:15], s60 offen nt lds
    v_mfma_f32_32x32x16_bf16 a[48:63], v[100:103], v[196:199], a[48:63]
    s_waitcnt vmcnt(15)
    buffer_load_dwordx4 v7, s[12:15], s60 offen offset:1024 nt lds
    v_mfma_f32_32x32x16_bf16 v[240:255], v[36:39], v[104:107], v[240:255]
    s_waitcnt vmcnt(10)
    ds_read_b64_tr_b16 v[72:73], v18 offset:8192
    ds_read_b64_tr_b16 v[74:75], v18 offset:10240
    ds_read_b64_tr_b16 v[76:77], v18 offset:12288
    ds_read_b64_tr_b16 v[78:79], v18 offset:14336
    ds_read_b64_tr_b16 v[80:81], v19 offset:8192
    ds_read_b64_tr_b16 v[82:83], v19 offset:10240
    ds_read_b64_tr_b16 v[84:85], v19 offset:12288
    ds_read_b64_tr_b16 v[86:87], v19 offset:14336
    ds_read_b64_tr_b16 v[88:89], v20 offset:8192
    ds_read_b64_tr_b16 v[90:91], v20 offset:10240
    ds_read_b64_tr_b16 v[92:93], v20 offset:12288
    ds_read_b64_tr_b16 v[94:95], v20 offset:14336
    ds_read_b64_tr_b16 v[96:97], v21 offset:8192
    ds_read_b64_tr_b16 v[98:99], v21 offset:10240
    ds_read_b64_tr_b16 v[100:101], v21 offset:12288
    ds_read_b64_tr_b16 v[102:103], v21 offset:14336
    v_mfma_f32_16x16x32_bf16 a[64:67], v[26:29], v[208:211], a[64:67]
    v_exp_f32 v224, v224
    v_exp_f32 v225, v225
    v_mfma_f32_16x16x32_bf16 a[64:67], v[26:29], v[212:215], a[64:67]
    v_exp_f32 v226, v226
    v_exp_f32 v227, v227
    s_waitcnt lgkmcnt(12)
    v_mfma_f32_32x32x16_bf16 a[0:15], v[72:75], v[208:211], a[0:15]
    v_exp_f32 v228, v228
    v_exp_f32 v229, v229
    v_exp_f32 v230, v230
    buffer_load_dwordx4 v8, s[12:15], s60 offen offset:2048 nt lds
    v_mfma_f32_32x32x16_bf16 a[0:15], v[76:79], v[212:215], a[0:15]
    v_exp_f32 v231, v231
    v_exp_f32 v232, v232
    v_exp_f32 v233, v233
    buffer_load_dwordx4 v9, s[12:15], s60 offen offset:3072 nt lds
    s_waitcnt lgkmcnt(8)
    v_mfma_f32_32x32x16_bf16 a[16:31], v[80:83], v[208:211], a[16:31]
    v_exp_f32 v234, v234
    v_exp_f32 v235, v235
    v_exp_f32 v236, v236
    s_add_u32 s61, s60, 16384
    s_add_u32 m0, s4, 28672
    s_nop 0
    buffer_load_dwordx4 v6, s[12:15], s61 offen nt lds
    v_mfma_f32_32x32x16_bf16 a[16:31], v[84:87], v[212:215], a[16:31]
    v_exp_f32 v237, v237
    v_exp_f32 v238, v238
    v_exp_f32 v239, v239
    buffer_load_dwordx4 v7, s[12:15], s61 offen offset:1024 nt lds
    s_waitcnt lgkmcnt(4)
    v_mfma_f32_32x32x16_bf16 a[32:47], v[88:91], v[208:211], a[32:47]
    v_cvt_pk_bf16_f32 v224, v224, v225
    v_cvt_pk_bf16_f32 v225, v226, v227
    v_cvt_pk_bf16_f32 v226, v228, v229
    buffer_load_dwordx4 v8, s[12:15], s61 offen offset:2048 nt lds
    v_mfma_f32_32x32x16_bf16 a[32:47], v[92:95], v[212:215], a[32:47]
    v_cvt_pk_bf16_f32 v227, v230, v231
    v_cvt_pk_bf16_f32 v228, v232, v233
    v_cvt_pk_bf16_f32 v229, v234, v235
    buffer_load_dwordx4 v9, s[12:15], s61 offen offset:3072 nt lds
    s_add_u32 s60, s60, 32768
    s_waitcnt lgkmcnt(0)
    v_mfma_f32_32x32x16_bf16 a[48:63], v[96:99], v[208:211], a[48:63]
    v_cvt_pk_bf16_f32 v230, v236, v237
    v_cvt_pk_bf16_f32 v231, v238, v239
    v_mfma_f32_32x32x16_bf16 a[48:63], v[100:103], v[212:215], a[48:63]
    s_waitcnt vmcnt(8)
    ds_read_b64_tr_b16 v[72:73], v18 offset:16384
    ds_read_b64_tr_b16 v[74:75], v18 offset:18432
    ds_read_b64_tr_b16 v[76:77], v18 offset:20480
    ds_read_b64_tr_b16 v[78:79], v18 offset:22528
    ds_read_b64_tr_b16 v[80:81], v19 offset:16384
    ds_read_b64_tr_b16 v[82:83], v19 offset:18432
    ds_read_b64_tr_b16 v[84:85], v19 offset:20480
    ds_read_b64_tr_b16 v[86:87], v19 offset:22528
    ds_read_b64_tr_b16 v[88:89], v20 offset:16384
    ds_read_b64_tr_b16 v[90:91], v20 offset:18432
    ds_read_b64_tr_b16 v[92:93], v20 offset:20480
    ds_read_b64_tr_b16 v[94:95], v20 offset:22528
    ds_read_b64_tr_b16 v[96:97], v21 offset:16384
    ds_read_b64_tr_b16 v[98:99], v21 offset:18432
    ds_read_b64_tr_b16 v[100:101], v21 offset:20480
    ds_read_b64_tr_b16 v[102:103], v21 offset:22528
    v_mfma_f32_16x16x32_bf16 a[64:67], v[26:29], v[224:227], a[64:67]
    v_exp_f32 v240, v240
    v_exp_f32 v241, v241
    v_mfma_f32_16x16x32_bf16 a[64:67], v[26:29], v[228:231], a[64:67]
    v_exp_f32 v242, v242
    v_exp_f32 v243, v243
    s_waitcnt lgkmcnt(12)
    v_mfma_f32_32x32x16_bf16 a[0:15], v[72:75], v[224:227], a[0:15]
    v_exp_f32 v244, v244
    v_exp_f32 v245, v245
    v_exp_f32 v246, v246
    v_mfma_f32_32x32x16_bf16 a[0:15], v[76:79], v[228:231], a[0:15]
    v_exp_f32 v247, v247
    v_exp_f32 v248, v248
    v_exp_f32 v249, v249
    s_waitcnt lgkmcnt(8)
    v_mfma_f32_32x32x16_bf16 a[16:31], v[80:83], v[224:227], a[16:31]
    v_exp_f32 v250, v250
    v_exp_f32 v251, v251
    v_exp_f32 v252, v252
    v_mfma_f32_32x32x16_bf16 a[16:31], v[84:87], v[228:231], a[16:31]
    v_exp_f32 v253, v253
    v_exp_f32 v254, v254
    v_exp_f32 v255, v255
    s_waitcnt lgkmcnt(4)
    v_mfma_f32_32x32x16_bf16 a[32:47], v[88:91], v[224:227], a[32:47]
    v_cvt_pk_bf16_f32 v240, v240, v241
    v_cvt_pk_bf16_f32 v241, v242, v243
    v_cvt_pk_bf16_f32 v242, v244, v245
    v_mfma_f32_32x32x16_bf16 a[32:47], v[92:95], v[228:231], a[32:47]
    v_cvt_pk_bf16_f32 v243, v246, v247
    v_cvt_pk_bf16_f32 v244, v248, v249
    v_cvt_pk_bf16_f32 v245, v250, v251
    s_waitcnt lgkmcnt(0)
    v_mfma_f32_32x32x16_bf16 a[48:63], v[96:99], v[224:227], a[48:63]
    v_cvt_pk_bf16_f32 v246, v252, v253
    v_cvt_pk_bf16_f32 v247, v254, v255
    v_mfma_f32_32x32x16_bf16 a[48:63], v[100:103], v[228:231], a[48:63]
    v_mfma_f32_16x16x32_bf16 a[64:67], v[26:29], v[240:243], a[64:67]
    v_mfma_f32_16x16x32_bf16 a[64:67], v[26:29], v[244:247], a[64:67]
    s_lshl_b32 s5, s3, 13
    s_add_u32 s5, s5, 131072
    v_add_u32 v112, s4, v30
    v_add_u32 v113, s5, v30
    s_sub_u32 s5, s3, 1
    s_and_b32 s5, s5, 3
    s_lshl_b32 s7, s5, 13
    s_add_u32 s7, s7, 131072
    s_lshl_b32 s5, s5, 15
    v_add_u32 v114, s5, v30
    v_add_u32 v115, s7, v30
    s_sub_u32 s5, s3, 2
    s_and_b32 s5, s5, 3
    s_lshl_b32 s7, s5, 13
    s_add_u32 s7, s7, 131072
    s_lshl_b32 s5, s5, 15
    v_add_u32 v116, s5, v30
    v_add_u32 v117, s7, v30
    s_sub_u32 s5, s3, 3
    s_and_b32 s5, s5, 3
    s_lshl_b32 s7, s5, 13
    s_add_u32 s7, s7, 131072
    s_lshl_b32 s5, s5, 15
    v_add_u32 v118, s5, v30
    v_add_u32 v119, s7, v30
    s_mov_b32 vcc_lo, 0xffff0000
    s_mov_b32 vcc_hi, 0xffff0000
    v_accvgpr_read_b32 v2, a64
    v_accvgpr_read_b32 v3, a65
    v_cndmask_b32 v3, v2, v3, vcc
    v_mov_b32 v2, v32
    ds_write_b64 v113, v[2:3] offset:4096
    s_waitcnt vmcnt(0)
    v_lshrrev_b32 v7, 4, v1
    v_and_b32 v8, 15, v1
    v_lshlrev_b32 v9, 2, v7
    v_xor_b32 v8, v8, v9
    v_lshlrev_b32 v8, 4, v8
    v_lshl_add_u32 v6, v7, 11, v8
    v_add_u32 v7, 7168, v6
    v_add_u32 v8, 14336, v6
    v_add_u32 v9, 21504, v6
    s_mov_b32 s12, s34
    s_mov_b32 s13, s35
    s_mov_b32 s14, 8388608
    s_mov_b32 s15, 0x20000
    s_add_u32 s7, s3, s52
    s_and_b32 s7, s7, 3
    s_lshl_b32 s63, s50, 2
    s_add_u32 s63, s63, s7
    s_lshl_b32 s63, s63, 18
    s_and_b32 s7, s52, 7
    s_lshl_b32 s7, s7, 8
    s_add_u32 s63, s63, s7
    s_lshr_b32 s62, s52, 3
    s_lshl_b32 s62, s62, 17
    s_add_u32 s60, s63, s62
    ds_read_b64_tr_b16 v[80:81], v19 offset:24576
    ds_read_b64_tr_b16 v[82:83], v19 offset:26624
    ds_read_b64_tr_b16 v[84:85], v19 offset:28672
    ds_read_b64_tr_b16 v[86:87], v19 offset:30720
    ds_read_b64_tr_b16 v[88:89], v20 offset:24576
    ds_read_b64_tr_b16 v[90:91], v20 offset:26624
    ds_read_b64_tr_b16 v[92:93], v20 offset:28672
    ds_read_b64_tr_b16 v[94:95], v20 offset:30720
    ds_read_b64_tr_b16 v[96:97], v21 offset:24576
    ds_read_b64_tr_b16 v[98:99], v21 offset:26624
    ds_read_b64_tr_b16 v[100:101], v21 offset:28672
    ds_read_b64_tr_b16 v[102:103], v21 offset:30720
    ds_read_b64_tr_b16 v[72:73], v18 offset:24576
    ds_read_b64_tr_b16 v[74:75], v18 offset:26624
    ds_read_b64_tr_b16 v[76:77], v18 offset:28672
    ds_read_b64_tr_b16 v[78:79], v18 offset:30720
    s_waitcnt lgkmcnt(12)
    v_mfma_f32_32x32x16_bf16 a[16:31], v[80:83], v[240:243], a[16:31]
    s_add_u32 m0, s4, 0
    s_nop 0
    buffer_load_dwordx4 v6, s[12:15], s60 offen lds
    v_mfma_f32_32x32x16_bf16 a[16:31], v[84:87], v[244:247], a[16:31]
    buffer_load_dwordx4 v7, s[12:15], s60 offen offset:1024 lds
    s_waitcnt lgkmcnt(8)
    v_mfma_f32_32x32x16_bf16 a[32:47], v[88:91], v[240:243], a[32:47]
    buffer_load_dwordx4 v8, s[12:15], s60 offen offset:2048 lds
    v_mfma_f32_32x32x16_bf16 a[32:47], v[92:95], v[244:247], a[32:47]
    buffer_load_dwordx4 v9, s[12:15], s60 offen offset:3072 lds
    s_waitcnt lgkmcnt(4)
    v_mfma_f32_32x32x16_bf16 a[48:63], v[96:99], v[240:243], a[48:63]
    s_add_u32 s61, s60, 32768
    s_add_u32 m0, s4, 4096
    s_nop 0
    buffer_load_dwordx4 v6, s[12:15], s61 offen lds
    v_mfma_f32_32x32x16_bf16 a[48:63], v[100:103], v[244:247], a[48:63]
    buffer_load_dwordx4 v7, s[12:15], s61 offen offset:1024 lds
    ds_write_b128 v112, a[16:19] offset:24576
    ds_write_b128 v112, a[20:23] offset:25600
    ds_write_b128 v112, a[24:27] offset:26624
    ds_write_b128 v112, a[28:31] offset:27648
    s_waitcnt lgkmcnt(4)
    v_mfma_f32_32x32x16_bf16 a[0:15], v[72:75], v[240:243], a[0:15]
    buffer_load_dwordx4 v8, s[12:15], s61 offen offset:2048 lds
    v_mfma_f32_32x32x16_bf16 a[0:15], v[76:79], v[244:247], a[0:15]
    buffer_load_dwordx4 v9, s[12:15], s61 offen offset:3072 lds
    s_xor_b32 s7, s62, 65536
    s_add_u32 s60, s63, s7
    ds_write_b128 v112, a[32:35] offset:28672
    ds_write_b128 v112, a[36:39] offset:29696
    ds_write_b128 v112, a[40:43] offset:30720
    ds_write_b128 v112, a[44:47] offset:31744
L_g1tail:
    ds_write_b128 v113, a[48:51] offset:0
    ds_write_b128 v113, a[52:55] offset:1024
    ds_write_b128 v113, a[56:59] offset:2048
    ds_write_b128 v113, a[60:63] offset:3072
    s_nop 0
    v_accvgpr_read_b32 v128, a0
    v_accvgpr_read_b32 v129, a1
    v_accvgpr_read_b32 v130, a2
    v_accvgpr_read_b32 v131, a3
    v_accvgpr_read_b32 v132, a4
    v_accvgpr_read_b32 v133, a5
    v_accvgpr_read_b32 v134, a6
    v_accvgpr_read_b32 v135, a7
    v_accvgpr_read_b32 v136, a8
    v_accvgpr_read_b32 v137, a9
    v_accvgpr_read_b32 v138, a10
    v_accvgpr_read_b32 v139, a11
    v_accvgpr_read_b32 v140, a12
    v_accvgpr_read_b32 v141, a13
    v_accvgpr_read_b32 v142, a14
    v_accvgpr_read_b32 v143, a15
    v_mov_b32 v72, v2
    v_mov_b32 v73, v3
    s_lshr_b32 s94, s52, 3
    s_lshl_b32 s94, s94, 2
    s_add_u32 s94, s94, s3
    s_add_u32 s94, s94, 8
    s_lshl_b32 s95, s94, 3
    s_add_u32 s95, s95, s50
    s_lshl_b32 s96, s95, 15
    s_add_u32 s96, s96, 4194304
    s_lshl_b32 s95, s95, 8
    s_add_u32 s95, s95, 18874368
    v_add_u32 v26, 0x10000, v22
    v_add_u32 v27, 0x10000, v23
    v_add_u32 v28, 0x10000, v24
    v_add_u32 v29, 0x10000, v25
    v_and_b32 v10, 15, v1
    v_lshlrev_b32 v10, 4, v10
    v_lshrrev_b32 v11, 5, v1
    v_lshl_add_u32 v10, v11, 8, v10
    v_bfe_u32 v11, v1, 4, 1
    v_lshl_add_u32 v10, v11, 15, v10
    v_and_b32 v11, 3, v1
    v_lshlrev_b32 v11, 2, v11
    s_lshl_b32 s58, s92, 3
    s_lshl_b32 s7, s3, 1
    s_add_u32 s58, s58, s7
    s_lshl_b32 s58, s58, 3
    s_add_u32 s58, s58, s50
    s_lshl_b32 s58, s58, 12
    s_add_u32 s58, s58, 8388608
    s_lshr_b32 s59, s52, 3
    s_lshl_b32 s59, s59, 12
    s_lshl_b32 s64, s92, 2
    s_lshr_b32 s7, s50, 1
    s_add_u32 s64, s64, s7
    s_lshl_b32 s64, s64, 8
    s_add_u32 s64, s64, 20971520
    v_and_b32 v15, 7, v1
    v_lshlrev_b32 v15, 2, v15
    s_lshl_b32 s53, s92, 3
    s_add_u32 s53, s53, s50
    s_lshl_b32 s53, s53, 15
    s_add_u32 s53, s53, 8388608
    s_add_u32 s54, s53, 16384
    v_lshlrev_b32 v13, 4, v0
    s_bfe_u32 s66, s92, 0x10003
    s_lshl_b32 s66, s66, 3
    s_add_u32 s66, s66, s50
    s_lshl_b32 s66, s66, 16
    s_lshr_b32 s7, s92, 4
    s_lshl_b32 s7, s7, 11
    s_add_u32 s66, s66, s7
    s_and_b32 s7, s92, 7
    s_lshl_b32 s7, s7, 8
    s_add_u32 s66, s66, s7
    v_and_b32 v14, 15, v0
    v_lshlrev_b32 v14, 12, v14
    v_lshrrev_b32 v16, 4, v0
    v_lshl_add_u32 v14, v16, 4, v14
    s_mov_b32 s8, s36
    s_mov_b32 s9, s37
    s_mov_b32 s10, 1048576
    s_mov_b32 s11, 0x20000
    s_waitcnt lgkmcnt(0)
    s_barrier
    ds_read_b64 v[74:75], v115 offset:4096
    ds_read_b64 v[76:77], v117 offset:4096
    ds_read_b64 v[78:79], v119 offset:4096
    ds_read_b128 v[144:147], v114 offset:24576
    ds_read_b128 v[148:151], v114 offset:25600
    ds_read_b128 v[152:155], v114 offset:26624
    ds_read_b128 v[156:159], v114 offset:27648
    ds_read_b128 v[160:163], v116 offset:28672
    ds_read_b128 v[164:167], v116 offset:29696
    ds_read_b128 v[168:171], v116 offset:30720
    ds_read_b128 v[172:175], v116 offset:31744
    v_mov_b32 v12, 1
    s_mov_b64 exec, 15
    v_mov_b32 v12, 0
    buffer_atomic_or v12, v11, s[44:47], s95 offen sc0 sc1
    s_mov_b64 exec, -1
    s_waitcnt lgkmcnt(8)
    ds_read_b128 v[176:179], v119 offset:0
    ds_read_b128 v[180:183], v119 offset:1024
    ds_read_b128 v[184:187], v119 offset:2048
    ds_read_b128 v[188:191], v119 offset:3072
    v_max3_f32 v88, v72, v74, v76
    v_max_f32 v88, v88, v78
    v_sub_f32 v90, v72, v88
    v_sub_f32 v91, v74, v88
    v_sub_f32 v92, v76, v88
    v_sub_f32 v93, v78, v88
    v_exp_f32 v90, v90
    v_exp_f32 v91, v91
    v_exp_f32 v92, v92
    v_exp_f32 v93, v93
    v_mul_f32 v89, v90, v73
    v_fmac_f32 v89, v91, v75
    v_fmac_f32 v89, v92, v77
    v_fmac_f32 v89, v93, v79
    v_rcp_f32 v89, v89
    s_nop 0
    v_mul_f32 v90, v90, v89
    v_mul_f32 v91, v91, v89
    v_mul_f32 v92, v92, v89
    v_mul_f32 v93, v93, v89
    v_pk_mul_f32 v[128:129], v[128:129], v[90:91] op_sel_hi:[1,0]
    v_pk_mul_f32 v[130:131], v[130:131], v[90:91] op_sel_hi:[1,0]
    v_pk_mul_f32 v[132:133], v[132:133], v[90:91] op_sel_hi:[1,0]
    v_pk_mul_f32 v[134:135], v[134:135], v[90:91] op_sel_hi:[1,0]
    v_pk_mul_f32 v[136:137], v[136:137], v[90:91] op_sel_hi:[1,0]
    v_pk_mul_f32 v[138:139], v[138:139], v[90:91] op_sel_hi:[1,0]
    v_pk_mul_f32 v[140:141], v[140:141], v[90:91] op_sel_hi:[1,0]
    v_pk_mul_f32 v[142:143], v[142:143], v[90:91] op_sel_hi:[1,0]
    s_waitcnt lgkmcnt(8)
    v_pk_fma_f32 v[128:129], v[144:145], v[90:91], v[128:129] op_sel:[0,1,0]
    v_pk_fma_f32 v[130:131], v[146:147], v[90:91], v[130:131] op_sel:[0,1,0]
    v_pk_fma_f32 v[132:133], v[148:149], v[90:91], v[132:133] op_sel:[0,1,0]
    v_pk_fma_f32 v[134:135], v[150:151], v[90:91], v[134:135] op_sel:[0,1,0]
    v_pk_fma_f32 v[136:137], v[152:153], v[90:91], v[136:137] op_sel:[0,1,0]
    v_pk_fma_f32 v[138:139], v[154:155], v[90:91], v[138:139] op_sel:[0,1,0]
    v_pk_fma_f32 v[140:141], v[156:157], v[90:91], v[140:141] op_sel:[0,1,0]
    v_pk_fma_f32 v[142:143], v[158:159], v[90:91], v[142:143] op_sel:[0,1,0]
    s_waitcnt lgkmcnt(4)
    v_pk_fma_f32 v[128:129], v[160:161], v[92:93], v[128:129] op_sel_hi:[1,0,1]
    v_pk_fma_f32 v[130:131], v[162:163], v[92:93], v[130:131] op_sel_hi:[1,0,1]
    v_pk_fma_f32 v[132:133], v[164:165], v[92:93], v[132:133] op_sel_hi:[1,0,1]
    v_pk_fma_f32 v[134:135], v[166:167], v[92:93], v[134:135] op_sel_hi:[1,0,1]
    v_pk_fma_f32 v[136:137], v[168:169], v[92:93], v[136:137] op_sel_hi:[1,0,1]
    v_pk_fma_f32 v[138:139], v[170:171], v[92:93], v[138:139] op_sel_hi:[1,0,1]
    v_pk_fma_f32 v[140:141], v[172:173], v[92:93], v[140:141] op_sel_hi:[1,0,1]
    v_pk_fma_f32 v[142:143], v[174:175], v[92:93], v[142:143] op_sel_hi:[1,0,1]
    s_waitcnt lgkmcnt(0)
    v_pk_fma_f32 v[128:129], v[176:177], v[92:93], v[128:129] op_sel:[0,1,0]
    v_pk_fma_f32 v[130:131], v[178:179], v[92:93], v[130:131] op_sel:[0,1,0]
    v_pk_fma_f32 v[132:133], v[180:181], v[92:93], v[132:133] op_sel:[0,1,0]
    v_pk_fma_f32 v[134:135], v[182:183], v[92:93], v[134:135] op_sel:[0,1,0]
    v_pk_fma_f32 v[136:137], v[184:185], v[92:93], v[136:137] op_sel:[0,1,0]
    v_pk_fma_f32 v[138:139], v[186:187], v[92:93], v[138:139] op_sel:[0,1,0]
    v_pk_fma_f32 v[140:141], v[188:189], v[92:93], v[140:141] op_sel:[0,1,0]
    v_pk_fma_f32 v[142:143], v[190:191], v[92:93], v[142:143] op_sel:[0,1,0]
    s_barrier
    v_cvt_pk_bf16_f32 v128, v128, v129
    v_cvt_pk_bf16_f32 v129, v130, v131
    v_cvt_pk_bf16_f32 v130, v132, v133
    v_cvt_pk_bf16_f32 v131, v134, v135
    v_cvt_pk_bf16_f32 v132, v136, v137
    v_cvt_pk_bf16_f32 v133, v138, v139
    v_cvt_pk_bf16_f32 v134, v140, v141
    v_cvt_pk_bf16_f32 v135, v142, v143
    s_lshl_b32 s5, s3, 11
    s_add_u32 s5, s5, s65
    buffer_store_dwordx4 v[128:131], v30, s[44:47], s5 offen sc1
    buffer_store_dwordx4 v[132:135], v30, s[44:47], s5 offen offset:1024 sc1
    s_waitcnt vmcnt(2)
    v_cmp_ne_u32 vcc, 1, v12
    s_cbranch_vccz L_g1early
    v_mov_b32 v12, 1
    s_mov_b64 exec, 15
    v_mov_b32 v12, 0
    buffer_atomic_or v12, v11, s[44:47], s95 offen sc0 sc1
    s_mov_b64 exec, -1
    s_waitcnt vmcnt(1)
    s_barrier
    s_cmp_lg_u32 s3, 0
    s_cbranch_scc1 L_g1pub1
    v_mov_b32 v31, 1
    v_lshlrev_b32 v103, 2, v1
    s_mov_b64 exec, 1
    buffer_store_dword v31, v103, s[44:47], s67 offen sc1
    s_mov_b64 exec, -1
    s_waitcnt vmcnt(1)
    s_branch L_g1pub1_j
L_g1pub1:
    s_waitcnt vmcnt(0)
L_g1pub1_j:
    v_cmp_ne_u32 vcc, 1, v12
    s_cbranch_vccz L_g1second
    s_add_u32 m0, s4, 8192
    s_nop 0
    buffer_load_dwordx4 v6, s[12:15], s60 offen lds
    buffer_load_dwordx4 v7, s[12:15], s60 offen offset:1024 lds
    buffer_load_dwordx4 v8, s[12:15], s60 offen offset:2048 lds
    buffer_load_dwordx4 v9, s[12:15], s60 offen offset:3072 lds
    s_add_u32 s61, s60, 32768
    s_add_u32 m0, s4, 12288
    s_nop 0
    buffer_load_dwordx4 v6, s[12:15], s61 offen lds
    buffer_load_dwordx4 v7, s[12:15], s61 offen offset:1024 lds
    buffer_load_dwordx4 v8, s[12:15], s61 offen offset:2048 lds
    buffer_load_dwordx4 v9, s[12:15], s61 offen offset:3072 lds
    s_xor_b32 s7, s62, 131072
    s_add_u32 s60, s63, s7
    s_add_u32 m0, s4, 16384
    s_nop 0
    buffer_load_dwordx4 v6, s[12:15], s60 offen lds
    buffer_load_dwordx4 v7, s[12:15], s60 offen offset:1024 lds
    buffer_load_dwordx4 v8, s[12:15], s60 offen offset:2048 lds
    buffer_load_dwordx4 v9, s[12:15], s60 offen offset:3072 lds
    s_add_u32 s61, s60, 32768
    s_add_u32 m0, s4, 20480
    s_nop 0
    buffer_load_dwordx4 v6, s[12:15], s61 offen lds
    buffer_load_dwordx4 v7, s[12:15], s61 offen offset:1024 lds
    buffer_load_dwordx4 v8, s[12:15], s61 offen offset:2048 lds
    buffer_load_dwordx4 v9, s[12:15], s61 offen offset:3072 lds
    s_xor_b32 s7, s62, 196608
    s_add_u32 s60, s63, s7
    s_add_u32 m0, s4, 24576
    s_nop 0
    buffer_load_dwordx4 v6, s[12:15], s60 offen lds
    buffer_load_dwordx4 v7, s[12:15], s60 offen offset:1024 lds
    buffer_load_dwordx4 v8, s[12:15], s60 offen offset:2048 lds
    buffer_load_dwordx4 v9, s[12:15], s60 offen offset:3072 lds
    s_add_u32 s61, s60, 32768
    s_add_u32 m0, s4, 28672
    s_nop 0
    buffer_load_dwordx4 v6, s[12:15], s61 offen lds
    buffer_load_dwordx4 v7, s[12:15], s61 offen offset:1024 lds
    buffer_load_dwordx4 v8, s[12:15], s61 offen offset:2048 lds
    buffer_load_dwordx4 v9, s[12:15], s61 offen offset:3072 lds
    s_mov_b32 s68, 262144
L_g1o:
    v_mov_b32 v31, 1
    s_mov_b64 exec, 15
    v_mov_b32 v31, 0
    buffer_atomic_or v31, v11, s[44:47], s95 offen sc0 sc1
    s_mov_b64 exec, -1
    s_waitcnt vmcnt(0)
    v_cmp_ne_u32 vcc, 1, v31
    s_cbranch_vccz L_g1o_x
    s_sub_u32 s68, s68, 1
    s_cbranch_scc0 L_g1o
L_g1o_x:
    s_add_u32 s7, s52, 0
    s_and_b32 s7, s7, 3
    s_lshl_b32 s7, s7, 13
    s_add_u32 s7, s7, s96
    s_add_u32 s56, s59, s7
    s_xor_b32 s57, s59, 4096
    s_add_u32 s57, s57, s7
    buffer_load_dwordx4 a[0:3], v30, s[44:47], s56 offen offset:0 sc1
    buffer_load_dwordx4 a[4:7], v30, s[44:47], s56 offen offset:1024 sc1
    s_add_u32 s7, s52, 1
    s_and_b32 s7, s7, 3
    s_lshl_b32 s7, s7, 13
    s_add_u32 s7, s7, s96
    s_add_u32 s56, s59, s7
    s_xor_b32 s57, s59, 4096
    s_add_u32 s57, s57, s7
    buffer_load_dwordx4 a[32:35], v30, s[44:47], s56 offen offset:0 sc1
    buffer_load_dwordx4 a[36:39], v30, s[44:47], s56 offen offset:1024 sc1
    s_add_u32 s7, s52, 2
    s_and_b32 s7, s7, 3
    s_lshl_b32 s7, s7, 13
    s_add_u32 s7, s7, s96
    s_add_u32 s56, s59, s7
    s_xor_b32 s57, s59, 4096
    s_add_u32 s57, s57, s7
    buffer_load_dwordx4 a[64:67], v30, s[44:47], s56 offen offset:0 sc1
    buffer_load_dwordx4 a[68:71], v30, s[44:47], s56 offen offset:1024 sc1
    s_add_u32 s7, s52, 3
    s_and_b32 s7, s7, 3
    s_lshl_b32 s7, s7, 13
    s_add_u32 s7, s7, s96
    s_add_u32 s56, s59, s7
    s_xor_b32 s57, s59, 4096
    s_add_u32 s57, s57, s7
    buffer_load_dwordx4 a[96:99], v30, s[44:47], s56 offen offset:0 sc1
    buffer_load_dwordx4 a[100:103], v30, s[44:47], s56 offen offset:1024 sc1
    ds_read_b64_tr_b16 v[72:73], v22 offset:0
    ds_read_b64_tr_b16 v[74:75], v22 offset:1024
    ds_read_b64_tr_b16 v[76:77], v23 offset:0
    ds_read_b64_tr_b16 v[78:79], v23 offset:1024
    ds_read_b64_tr_b16 v[80:81], v22 offset:4096
    ds_read_b64_tr_b16 v[82:83], v22 offset:5120
    ds_read_b64_tr_b16 v[84:85], v23 offset:4096
    ds_read_b64_tr_b16 v[86:87], v23 offset:5120
    s_waitcnt lgkmcnt(6)
    s_waitcnt vmcnt(7)
    s_add_u32 s7, s52, 0
    s_and_b32 s7, s7, 3
    s_lshl_b32 s7, s7, 13
    s_add_u32 s7, s7, s96
    s_add_u32 s56, s59, s7
    s_xor_b32 s57, s59, 4096
    s_add_u32 s57, s57, s7
    buffer_load_dwordx4 a[8:11], v30, s[44:47], s56 offen offset:2048 sc1
    v_mfma_f32_32x32x16_bf16 v[128:143], v[72:75], a[0:3], 0
    ds_read_b64_tr_b16 v[88:89], v22 offset:32768
    ds_read_b64_tr_b16 v[90:91], v22 offset:33792
    s_waitcnt lgkmcnt(6)
    v_mfma_f32_32x32x16_bf16 v[144:159], v[76:79], a[0:3], 0
    ds_read_b64_tr_b16 v[92:93], v23 offset:32768
    ds_read_b64_tr_b16 v[94:95], v23 offset:33792
    s_waitcnt lgkmcnt(6)
    s_waitcnt vmcnt(7)
    buffer_load_dwordx4 a[12:15], v30, s[44:47], s56 offen offset:3072 sc1
    v_mfma_f32_32x32x16_bf16 v[128:143], v[80:83], a[4:7], v[128:143]
    ds_read_b64_tr_b16 v[96:97], v22 offset:36864
    ds_read_b64_tr_b16 v[98:99], v22 offset:37888
    s_waitcnt lgkmcnt(6)
    v_mfma_f32_32x32x16_bf16 v[144:159], v[84:87], a[4:7], v[144:159]
    ds_read_b64_tr_b16 v[100:101], v23 offset:36864
    ds_read_b64_tr_b16 v[102:103], v23 offset:37888
    s_waitcnt lgkmcnt(6)
    s_waitcnt vmcnt(7)
    buffer_load_dwordx4 a[16:19], v30, s[44:47], s57 offen offset:0 sc1
    v_mfma_f32_32x32x16_bf16 v[128:143], v[88:91], a[32:35], v[128:143]
    ds_read_b64_tr_b16 v[72:73], v26 offset:0
    ds_read_b64_tr_b16 v[74:75], v26 offset:1024
    s_waitcnt lgkmcnt(6)
    v_mfma_f32_32x32x16_bf16 v[144:159], v[92:95], a[32:35], v[144:159]
    ds_read_b64_tr_b16 v[76:77], v27 offset:0
    ds_read_b64_tr_b16 v[78:79], v27 offset:1024
    s_waitcnt lgkmcnt(6)
    s_waitcnt vmcnt(7)
    buffer_load_dwordx4 a[20:23], v30, s[44:47], s57 offen offset:1024 sc1
    v_mfma_f32_32x32x16_bf16 v[128:143], v[96:99], a[36:39], v[128:143]
    ds_read_b64_tr_b16 v[80:81], v26 offset:4096
    ds_read_b64_tr_b16 v[82:83], v26 offset:5120
    s_waitcnt lgkmcnt(6)
    v_mfma_f32_32x32x16_bf16 v[144:159], v[100:103], a[36:39], v[144:159]
    ds_read_b64_tr_b16 v[84:85], v27 offset:4096
    ds_read_b64_tr_b16 v[86:87], v27 offset:5120
    s_waitcnt lgkmcnt(6)
    s_waitcnt vmcnt(7)
    buffer_load_dwordx4 a[24:27], v30, s[44:47], s57 offen offset:2048 sc1
    v_mfma_f32_32x32x16_bf16 v[128:143], v[72:75], a[64:67], v[128:143]
    ds_read_b64_tr_b16 v[88:89], v26 offset:32768
    ds_read_b64_tr_b16 v[90:91], v26 offset:33792
    s_waitcnt lgkmcnt(6)
    v_mfma_f32_32x32x16_bf16 v[144:159], v[76:79], a[64:67], v[144:159]
    ds_read_b64_tr_b16 v[92:93], v27 offset:32768
    ds_read_b64_tr_b16 v[94:95], v27 offset:33792
    s_waitcnt lgkmcnt(6)
    s_waitcnt vmcnt(7)
    buffer_load_dwordx4 a[28:31], v30, s[44:47], s57 offen offset:3072 sc1
    v_mfma_f32_32x32x16_bf16 v[128:143], v[80:83], a[68:71], v[128:143]
    ds_read_b64_tr_b16 v[96:97], v26 offset:36864
    ds_read_b64_tr_b16 v[98:99], v26 offset:37888
    s_waitcnt lgkmcnt(6)
    v_mfma_f32_32x32x16_bf16 v[144:159], v[84:87], a[68:71], v[144:159]
    ds_read_b64_tr_b16 v[100:101], v27 offset:36864
    ds_read_b64_tr_b16 v[102:103], v27 offset:37888
L_g1go:
    s_barrier
    s_waitcnt lgkmcnt(6)
    s_waitcnt vmcnt(7)
    s_add_u32 s7, s52, 1
    s_and_b32 s7, s7, 3
    s_lshl_b32 s7, s7, 13
    s_add_u32 s7, s7, s96
    s_add_u32 s56, s59, s7
    s_xor_b32 s57, s59, 4096
    s_add_u32 s57, s57, s7
    buffer_load_dwordx4 a[40:43], v30, s[44:47], s56 offen offset:2048 sc1
    v_mfma_f32_32x32x16_bf16 v[128:143], v[88:91], a[96:99], v[128:143]
    ds_read_b64_tr_b16 v[72:73], v22 offset:8192
    ds_read_b64_tr_b16 v[74:75], v22 offset:9216
    s_waitcnt lgkmcnt(6)
    v_mfma_f32_32x32x16_bf16 v[144:159], v[92:95], a[96:99], v[144:159]
    ds_read_b64_tr_b16 v[76:77], v23 offset:8192
    ds_read_b64_tr_b16 v[78:79], v23 offset:9216
    s_waitcnt lgkmcnt(6)
    s_waitcnt vmcnt(7)
    buffer_load_dwordx4 a[44:47], v30, s[44:47], s56 offen offset:3072 sc1
    v_mfma_f32_32x32x16_bf16 v[128:143], v[96:99], a[100:103], v[128:143]
    ds_read_b64_tr_b16 v[80:81], v22 offset:12288
    ds_read_b64_tr_b16 v[82:83], v22 offset:13312
    s_waitcnt lgkmcnt(6)
    v_mfma_f32_32x32x16_bf16 v[144:159], v[100:103], a[100:103], v[144:159]
    ds_read_b64_tr_b16 v[84:85], v23 offset:12288
    ds_read_b64_tr_b16 v[86:87], v23 offset:13312
    s_waitcnt lgkmcnt(6)
    s_waitcnt vmcnt(7)
    buffer_load_dwordx4 a[48:51], v30, s[44:47], s57 offen offset:0 sc1
    v_mfma_f32_32x32x16_bf16 v[128:143], v[72:75], a[8:11], v[128:143]
    ds_read_b64_tr_b16 v[88:89], v22 offset:16384
    ds_read_b64_tr_b16 v[90:91], v22 offset:17408
    s_waitcnt lgkmcnt(6)
    v_mfma_f32_32x32x16_bf16 v[144:159], v[76:79], a[8:11], v[144:159]
    ds_read_b64_tr_b16 v[92:93], v23 offset:16384
    ds_read_b64_tr_b16 v[94:95], v23 offset:17408
    s_waitcnt lgkmcnt(6)
    s_waitcnt vmcnt(7)
    buffer_load_dwordx4 a[52:55], v30, s[44:47], s57 offen offset:1024 sc1
    v_mfma_f32_32x32x16_bf16 v[128:143], v[80:83], a[12:15], v[128:143]
    ds_read_b64_tr_b16 v[96:97], v22 offset:20480
    ds_read_b64_tr_b16 v[98:99], v22 offset:21504
    s_waitcnt lgkmcnt(6)
    v_mfma_f32_32x32x16_bf16 v[144:159], v[84:87], a[12:15], v[144:159]
    ds_read_b64_tr_b16 v[100:101], v23 offset:20480
    ds_read_b64_tr_b16 v[102:103], v23 offset:21504
    s_waitcnt lgkmcnt(6)
    s_waitcnt vmcnt(7)
    buffer_load_dwordx4 a[56:59], v30, s[44:47], s57 offen offset:2048 sc1
    v_mfma_f32_32x32x16_bf16 v[128:143], v[88:91], a[16:19], v[128:143]
    ds_read_b64_tr_b16 v[72:73], v22 offset:24576
    ds_read_b64_tr_b16 v[74:75], v22 offset:25600
    s_waitcnt lgkmcnt(6)
    v_mfma_f32_32x32x16_bf16 v[144:159], v[92:95], a[16:19], v[144:159]
    ds_read_b64_tr_b16 v[76:77], v23 offset:24576
    ds_read_b64_tr_b16 v[78:79], v23 offset:25600
    s_waitcnt lgkmcnt(6)
    s_waitcnt vmcnt(7)
    buffer_load_dwordx4 a[60:63], v30, s[44:47], s57 offen offset:3072 sc1
    v_mfma_f32_32x32x16_bf16 v[128:143], v[96:99], a[20:23], v[128:143]
    ds_read_b64_tr_b16 v[80:81], v22 offset:28672
    ds_read_b64_tr_b16 v[82:83], v22 offset:29696
    s_waitcnt lgkmcnt(6)
    v_mfma_f32_32x32x16_bf16 v[144:159], v[100:103], a[20:23], v[144:159]
    ds_read_b64_tr_b16 v[84:85], v23 offset:28672
    ds_read_b64_tr_b16 v[86:87], v23 offset:29696
    s_waitcnt lgkmcnt(6)
    s_waitcnt vmcnt(7)
    s_add_u32 s7, s52, 2
    s_and_b32 s7, s7, 3
    s_lshl_b32 s7, s7, 13
    s_add_u32 s7, s7, s96
    s_add_u32 s56, s59, s7
    s_xor_b32 s57, s59, 4096
    s_add_u32 s57, s57, s7
    buffer_load_dwordx4 a[72:75], v30, s[44:47], s56 offen offset:2048 sc1
    v_mfma_f32_32x32x16_bf16 v[128:143], v[72:75], a[24:27], v[128:143]
    ds_read_b64_tr_b16 v[88:89], v22 offset:40960
    ds_read_b64_tr_b16 v[90:91], v22 offset:41984
    s_waitcnt lgkmcnt(6)
    v_mfma_f32_32x32x16_bf16 v[144:159], v[76:79], a[24:27], v[144:159]
    ds_read_b64_tr_b16 v[92:93], v23 offset:40960
    ds_read_b64_tr_b16 v[94:95], v23 offset:41984
    s_waitcnt lgkmcnt(6)
    s_waitcnt vmcnt(7)
    buffer_load_dwordx4 a[76:79], v30, s[44:47], s56 offen offset:3072 sc1
    v_mfma_f32_32x32x16_bf16 v[128:143], v[80:83], a[28:31], v[128:143]
    ds_read_b64_tr_b16 v[96:97], v22 offset:45056
    ds_read_b64_tr_b16 v[98:99], v22 offset:46080
    s_waitcnt lgkmcnt(6)
    v_mfma_f32_32x32x16_bf16 v[144:159], v[84:87], a[28:31], v[144:159]
    ds_read_b64_tr_b16 v[100:101], v23 offset:45056
    ds_read_b64_tr_b16 v[102:103], v23 offset:46080
    s_waitcnt lgkmcnt(6)
    s_waitcnt vmcnt(7)
    buffer_load_dwordx4 a[80:83], v30, s[44:47], s57 offen offset:0 sc1
    v_mfma_f32_32x32x16_bf16 v[128:143], v[88:91], a[40:43], v[128:143]
    ds_read_b64_tr_b16 v[72:73], v22 offset:49152
    ds_read_b64_tr_b16 v[74:75], v22 offset:50176
    s_waitcnt lgkmcnt(6)
    v_mfma_f32_32x32x16_bf16 v[144:159], v[92:95], a[40:43], v[144:159]
    ds_read_b64_tr_b16 v[76:77], v23 offset:49152
    ds_read_b64_tr_b16 v[78:79], v23 offset:50176
    s_waitcnt lgkmcnt(6)
    s_waitcnt vmcnt(7)
    buffer_load_dwordx4 a[84:87], v30, s[44:47], s57 offen offset:1024 sc1
    v_mfma_f32_32x32x16_bf16 v[128:143], v[96:99], a[44:47], v[128:143]
    ds_read_b64_tr_b16 v[80:81], v22 offset:53248
    ds_read_b64_tr_b16 v[82:83], v22 offset:54272
    s_waitcnt lgkmcnt(6)
    v_mfma_f32_32x32x16_bf16 v[144:159], v[100:103], a[44:47], v[144:159]
    ds_read_b64_tr_b16 v[84:85], v23 offset:53248
    ds_read_b64_tr_b16 v[86:87], v23 offset:54272
    s_waitcnt lgkmcnt(6)
    s_waitcnt vmcnt(7)
    buffer_load_dwordx4 a[88:91], v30, s[44:47], s57 offen offset:2048 sc1
    v_mfma_f32_32x32x16_bf16 v[128:143], v[72:75], a[48:51], v[128:143]
    ds_read_b64_tr_b16 v[88:89], v22 offset:57344
    ds_read_b64_tr_b16 v[90:91], v22 offset:58368
    s_waitcnt lgkmcnt(6)
    v_mfma_f32_32x32x16_bf16 v[144:159], v[76:79], a[48:51], v[144:159]
    ds_read_b64_tr_b16 v[92:93], v23 offset:57344
    ds_read_b64_tr_b16 v[94:95], v23 offset:58368
    s_waitcnt lgkmcnt(6)
    s_waitcnt vmcnt(7)
    buffer_load_dwordx4 a[92:95], v30, s[44:47], s57 offen offset:3072 sc1
    v_mfma_f32_32x32x16_bf16 v[128:143], v[80:83], a[52:55], v[128:143]
    ds_read_b64_tr_b16 v[96:97], v22 offset:61440
    ds_read_b64_tr_b16 v[98:99], v22 offset:62464
    s_waitcnt lgkmcnt(6)
    v_mfma_f32_32x32x16_bf16 v[144:159], v[84:87], a[52:55], v[144:159]
    ds_read_b64_tr_b16 v[100:101], v23 offset:61440
    ds_read_b64_tr_b16 v[102:103], v23 offset:62464
    s_waitcnt lgkmcnt(6)
    s_waitcnt vmcnt(7)
    s_add_u32 s7, s52, 3
    s_and_b32 s7, s7, 3
    s_lshl_b32 s7, s7, 13
    s_add_u32 s7, s7, s96
    s_add_u32 s56, s59, s7
    s_xor_b32 s57, s59, 4096
    s_add_u32 s57, s57, s7
    buffer_load_dwordx4 a[104:107], v30, s[44:47], s56 offen offset:2048 sc1
    v_mfma_f32_32x32x16_bf16 v[128:143], v[88:91], a[56:59], v[128:143]
    ds_read_b64_tr_b16 v[72:73], v26 offset:8192
    ds_read_b64_tr_b16 v[74:75], v26 offset:9216
    s_waitcnt lgkmcnt(6)
    v_mfma_f32_32x32x16_bf16 v[144:159], v[92:95], a[56:59], v[144:159]
    ds_read_b64_tr_b16 v[76:77], v27 offset:8192
    ds_read_b64_tr_b16 v[78:79], v27 offset:9216
    s_waitcnt lgkmcnt(6)
    s_waitcnt vmcnt(7)
    buffer_load_dwordx4 a[108:111], v30, s[44:47], s56 offen offset:3072 sc1
    v_mfma_f32_32x32x16_bf16 v[128:143], v[96:99], a[60:63], v[128:143]
    ds_read_b64_tr_b16 v[80:81], v26 offset:12288
    ds_read_b64_tr_b16 v[82:83], v26 offset:13312
    s_waitcnt lgkmcnt(6)
    v_mfma_f32_32x32x16_bf16 v[144:159], v[100:103], a[60:63], v[144:159]
    ds_read_b64_tr_b16 v[84:85], v27 offset:12288
    ds_read_b64_tr_b16 v[86:87], v27 offset:13312
    s_waitcnt lgkmcnt(6)
    s_waitcnt vmcnt(7)
    buffer_load_dwordx4 a[112:115], v30, s[44:47], s57 offen offset:0 sc1
    v_mfma_f32_32x32x16_bf16 v[128:143], v[72:75], a[72:75], v[128:143]
    ds_read_b64_tr_b16 v[88:89], v26 offset:16384
    ds_read_b64_tr_b16 v[90:91], v26 offset:17408
    s_waitcnt lgkmcnt(6)
    v_mfma_f32_32x32x16_bf16 v[144:159], v[76:79], a[72:75], v[144:159]
    ds_read_b64_tr_b16 v[92:93], v27 offset:16384
    ds_read_b64_tr_b16 v[94:95], v27 offset:17408
    s_waitcnt lgkmcnt(6)
    s_waitcnt vmcnt(7)
    buffer_load_dwordx4 a[116:119], v30, s[44:47], s57 offen offset:1024 sc1
    v_mfma_f32_32x32x16_bf16 v[128:143], v[80:83], a[76:79], v[128:143]
    ds_read_b64_tr_b16 v[96:97], v26 offset:20480
    ds_read_b64_tr_b16 v[98:99], v26 offset:21504
    s_waitcnt lgkmcnt(6)
    v_mfma_f32_32x32x16_bf16 v[144:159], v[84:87], a[76:79], v[144:159]
    ds_read_b64_tr_b16 v[100:101], v27 offset:20480
    ds_read_b64_tr_b16 v[102:103], v27 offset:21504
    s_waitcnt lgkmcnt(6)
    s_waitcnt vmcnt(7)
    buffer_load_dwordx4 a[120:123], v30, s[44:47], s57 offen offset:2048 sc1
    v_mfma_f32_32x32x16_bf16 v[128:143], v[88:91], a[80:83], v[128:143]
    ds_read_b64_tr_b16 v[72:73], v26 offset:24576
    ds_read_b64_tr_b16 v[74:75], v26 offset:25600
    s_waitcnt lgkmcnt(6)
    v_mfma_f32_32x32x16_bf16 v[144:159], v[92:95], a[80:83], v[144:159]
    ds_read_b64_tr_b16 v[76:77], v27 offset:24576
    ds_read_b64_tr_b16 v[78:79], v27 offset:25600
    s_waitcnt lgkmcnt(6)
    s_waitcnt vmcnt(7)
    buffer_load_dwordx4 a[124:127], v30, s[44:47], s57 offen offset:3072 sc1
    v_mfma_f32_32x32x16_bf16 v[128:143], v[96:99], a[84:87], v[128:143]
    ds_read_b64_tr_b16 v[80:81], v26 offset:28672
    ds_read_b64_tr_b16 v[82:83], v26 offset:29696
    s_waitcnt lgkmcnt(6)
    v_mfma_f32_32x32x16_bf16 v[144:159], v[100:103], a[84:87], v[144:159]
    ds_read_b64_tr_b16 v[84:85], v27 offset:28672
    ds_read_b64_tr_b16 v[86:87], v27 offset:29696
    s_waitcnt lgkmcnt(6)
    s_waitcnt vmcnt(7)
    v_mfma_f32_32x32x16_bf16 v[128:143], v[72:75], a[88:91], v[128:143]
    ds_read_b64_tr_b16 v[88:89], v26 offset:40960
    ds_read_b64_tr_b16 v[90:91], v26 offset:41984
    s_waitcnt lgkmcnt(6)
    v_mfma_f32_32x32x16_bf16 v[144:159], v[76:79], a[88:91], v[144:159]
    ds_read_b64_tr_b16 v[92:93], v27 offset:40960
    ds_read_b64_tr_b16 v[94:95], v27 offset:41984
    s_waitcnt lgkmcnt(6)
    s_waitcnt vmcnt(6)
    v_mfma_f32_32x32x16_bf16 v[128:143], v[80:83], a[92:95], v[128:143]
    ds_read_b64_tr_b16 v[96:97], v26 offset:45056
    ds_read_b64_tr_b16 v[98:99], v26 offset:46080
    s_waitcnt lgkmcnt(6)
    v_mfma_f32_32x32x16_bf16 v[144:159], v[84:87], a[92:95], v[144:159]
    ds_read_b64_tr_b16 v[100:101], v27 offset:45056
    ds_read_b64_tr_b16 v[102:103], v27 offset:46080
    s_waitcnt lgkmcnt(6)
    s_waitcnt vmcnt(5)
    v_mfma_f32_32x32x16_bf16 v[128:143], v[88:91], a[104:107], v[128:143]
    ds_read_b64_tr_b16 v[72:73], v26 offset:49152
    ds_read_b64_tr_b16 v[74:75], v26 offset:50176
    s_waitcnt lgkmcnt(6)
    v_mfma_f32_32x32x16_bf16 v[144:159], v[92:95], a[104:107], v[144:159]
    ds_read_b64_tr_b16 v[76:77], v27 offset:49152
    ds_read_b64_tr_b16 v[78:79], v27 offset:50176
    s_waitcnt lgkmcnt(6)
    s_waitcnt vmcnt(4)
    v_mfma_f32_32x32x16_bf16 v[128:143], v[96:99], a[108:111], v[128:143]
    ds_read_b64_tr_b16 v[80:81], v26 offset:53248
    ds_read_b64_tr_b16 v[82:83], v26 offset:54272
    s_waitcnt lgkmcnt(6)
    v_mfma_f32_32x32x16_bf16 v[144:159], v[100:103], a[108:111], v[144:159]
    ds_read_b64_tr_b16 v[84:85], v27 offset:53248
    ds_read_b64_tr_b16 v[86:87], v27 offset:54272
    s_waitcnt lgkmcnt(6)
    s_waitcnt vmcnt(3)
    v_mfma_f32_32x32x16_bf16 v[128:143], v[72:75], a[112:115], v[128:143]
    ds_read_b64_tr_b16 v[88:89], v26 offset:57344
    ds_read_b64_tr_b16 v[90:91], v26 offset:58368
    s_waitcnt lgkmcnt(6)
    v_mfma_f32_32x32x16_bf16 v[144:159], v[76:79], a[112:115], v[144:159]
    ds_read_b64_tr_b16 v[92:93], v27 offset:57344
    ds_read_b64_tr_b16 v[94:95], v27 offset:58368
    s_waitcnt lgkmcnt(6)
    s_waitcnt vmcnt(2)
    v_mfma_f32_32x32x16_bf16 v[128:143], v[80:83], a[116:119], v[128:143]
    ds_read_b64_tr_b16 v[96:97], v26 offset:61440
    ds_read_b64_tr_b16 v[98:99], v26 offset:62464
    s_waitcnt lgkmcnt(6)
    v_mfma_f32_32x32x16_bf16 v[144:159], v[84:87], a[116:119], v[144:159]
    ds_read_b64_tr_b16 v[100:101], v27 offset:61440
    ds_read_b64_tr_b16 v[102:103], v27 offset:62464
    s_waitcnt lgkmcnt(6)
    s_waitcnt vmcnt(1)
    v_mfma_f32_32x32x16_bf16 v[128:143], v[88:91], a[120:123], v[128:143]
    ds_read_b64_tr_b16 v[72:73], v24 offset:0
    ds_read_b64_tr_b16 v[74:75], v24 offset:1024
    s_waitcnt lgkmcnt(6)
    v_mfma_f32_32x32x16_bf16 v[144:159], v[92:95], a[120:123], v[144:159]
    ds_read_b64_tr_b16 v[76:77], v24 offset:4096
    ds_read_b64_tr_b16 v[78:79], v24 offset:5120
    s_waitcnt lgkmcnt(6)
    s_waitcnt vmcnt(0)
    v_mfma_f32_32x32x16_bf16 v[128:143], v[96:99], a[124:127], v[128:143]
    ds_read_b64_tr_b16 v[80:81], v24 offset:32768
    ds_read_b64_tr_b16 v[82:83], v24 offset:33792
    s_waitcnt lgkmcnt(6)
    v_mfma_f32_32x32x16_bf16 v[144:159], v[100:103], a[124:127], v[144:159]
    ds_read_b64_tr_b16 v[84:85], v24 offset:36864
    ds_read_b64_tr_b16 v[86:87], v24 offset:37888
    s_waitcnt lgkmcnt(6)
    v_mfma_f32_32x32x16_bf16 v[160:175], v[72:75], a[0:3], 0
    ds_read_b64_tr_b16 v[88:89], v28 offset:0
    ds_read_b64_tr_b16 v[90:91], v28 offset:1024
    s_waitcnt lgkmcnt(6)
    v_mfma_f32_32x32x16_bf16 v[160:175], v[76:79], a[4:7], v[160:175]
    ds_read_b64_tr_b16 v[92:93], v28 offset:4096
    ds_read_b64_tr_b16 v[94:95], v28 offset:5120
    s_waitcnt lgkmcnt(6)
    v_mfma_f32_32x32x16_bf16 v[160:175], v[80:83], a[32:35], v[160:175]
    ds_read_b64_tr_b16 v[96:97], v28 offset:32768
    ds_read_b64_tr_b16 v[98:99], v28 offset:33792
    v_cvt_pk_bf16_f32 v192, v128, v129
    v_cvt_pk_bf16_f32 v193, v130, v131
    s_waitcnt lgkmcnt(6)
    v_mfma_f32_32x32x16_bf16 v[160:175], v[84:87], a[36:39], v[160:175]
    ds_read_b64_tr_b16 v[100:101], v28 offset:36864
    ds_read_b64_tr_b16 v[102:103], v28 offset:37888
    v_cvt_pk_bf16_f32 v194, v132, v133
    v_cvt_pk_bf16_f32 v195, v134, v135
    s_waitcnt lgkmcnt(6)
    v_mfma_f32_32x32x16_bf16 v[160:175], v[88:91], a[64:67], v[160:175]
    ds_read_b64_tr_b16 v[72:73], v24 offset:8192
    ds_read_b64_tr_b16 v[74:75], v24 offset:9216
    v_cvt_pk_bf16_f32 v196, v136, v137
    v_cvt_pk_bf16_f32 v197, v138, v139
    s_waitcnt lgkmcnt(6)
    v_mfma_f32_32x32x16_bf16 v[160:175], v[92:95], a[68:71], v[160:175]
    ds_read_b64_tr_b16 v[76:77], v24 offset:12288
    ds_read_b64_tr_b16 v[78:79], v24 offset:13312
    v_cvt_pk_bf16_f32 v198, v140, v141
    v_cvt_pk_bf16_f32 v199, v142, v143
    s_waitcnt lgkmcnt(6)
    v_mfma_f32_32x32x16_bf16 v[160:175], v[96:99], a[96:99], v[160:175]
    ds_read_b64_tr_b16 v[80:81], v24 offset:16384
    ds_read_b64_tr_b16 v[82:83], v24 offset:17408
    buffer_store_dwordx4 v[192:195], v10, s[44:47], s58 offen offset:0 sc1
    buffer_store_dwordx4 v[196:199], v10, s[44:47], s58 offen offset:512 sc1
    s_waitcnt lgkmcnt(6)
    v_mfma_f32_32x32x16_bf16 v[160:175], v[100:103], a[100:103], v[160:175]
    ds_read_b64_tr_b16 v[84:85], v24 offset:20480
    ds_read_b64_tr_b16 v[86:87], v24 offset:21504
    v_cvt_pk_bf16_f32 v200, v144, v145
    v_cvt_pk_bf16_f32 v201, v146, v147
    s_waitcnt lgkmcnt(6)
    v_mfma_f32_32x32x16_bf16 v[160:175], v[72:75], a[8:11], v[160:175]
    ds_read_b64_tr_b16 v[88:89], v24 offset:24576
    ds_read_b64_tr_b16 v[90:91], v24 offset:25600
    v_cvt_pk_bf16_f32 v202, v148, v149
    v_cvt_pk_bf16_f32 v203, v150, v151
    s_waitcnt lgkmcnt(6)
    v_mfma_f32_32x32x16_bf16 v[160:175], v[76:79], a[12:15], v[160:175]
    ds_read_b64_tr_b16 v[92:93], v24 offset:28672
    ds_read_b64_tr_b16 v[94:95], v24 offset:29696
    v_cvt_pk_bf16_f32 v204, v152, v153
    v_cvt_pk_bf16_f32 v205, v154, v155
    s_waitcnt lgkmcnt(6)
    v_mfma_f32_32x32x16_bf16 v[160:175], v[80:83], a[16:19], v[160:175]
    ds_read_b64_tr_b16 v[96:97], v24 offset:40960
    ds_read_b64_tr_b16 v[98:99], v24 offset:41984
    v_cvt_pk_bf16_f32 v206, v156, v157
    v_cvt_pk_bf16_f32 v207, v158, v159
    s_waitcnt lgkmcnt(6)
    v_mfma_f32_32x32x16_bf16 v[160:175], v[84:87], a[20:23], v[160:175]
    ds_read_b64_tr_b16 v[100:101], v24 offset:45056
    ds_read_b64_tr_b16 v[102:103], v24 offset:46080
    buffer_store_dwordx4 v[200:203], v10, s[44:47], s58 offen offset:1024 sc1
    buffer_store_dwordx4 v[204:207], v10, s[44:47], s58 offen offset:1536 sc1
    s_waitcnt lgkmcnt(6)
    v_mfma_f32_32x32x16_bf16 v[160:175], v[88:91], a[24:27], v[160:175]
    ds_read_b64_tr_b16 v[72:73], v24 offset:49152
    ds_read_b64_tr_b16 v[74:75], v24 offset:50176
    s_waitcnt lgkmcnt(6)
    v_mfma_f32_32x32x16_bf16 v[160:175], v[92:95], a[28:31], v[160:175]
    ds_read_b64_tr_b16 v[76:77], v24 offset:53248
    ds_read_b64_tr_b16 v[78:79], v24 offset:54272
    s_waitcnt lgkmcnt(6)
    v_mfma_f32_32x32x16_bf16 v[160:175], v[96:99], a[40:43], v[160:175]
    ds_read_b64_tr_b16 v[80:81], v24 offset:57344
    ds_read_b64_tr_b16 v[82:83], v24 offset:58368
    s_waitcnt lgkmcnt(6)
    v_mfma_f32_32x32x16_bf16 v[160:175], v[100:103], a[44:47], v[160:175]
    ds_read_b64_tr_b16 v[84:85], v24 offset:61440
    ds_read_b64_tr_b16 v[86:87], v24 offset:62464
    s_waitcnt lgkmcnt(6)
    v_mfma_f32_32x32x16_bf16 v[160:175], v[72:75], a[48:51], v[160:175]
    ds_read_b64_tr_b16 v[88:89], v28 offset:8192
    ds_read_b64_tr_b16 v[90:91], v28 offset:9216
    s_waitcnt lgkmcnt(6)
    v_mfma_f32_32x32x16_bf16 v[160:175], v[76:79], a[52:55], v[160:175]
    ds_read_b64_tr_b16 v[92:93], v28 offset:12288
    ds_read_b64_tr_b16 v[94:95], v28 offset:13312
    s_waitcnt lgkmcnt(6)
    v_mfma_f32_32x32x16_bf16 v[160:175], v[80:83], a[56:59], v[160:175]
    ds_read_b64_tr_b16 v[96:97], v28 offset:16384
    ds_read_b64_tr_b16 v[98:99], v28 offset:17408
    s_waitcnt lgkmcnt(6)
    v_mfma_f32_32x32x16_bf16 v[160:175], v[84:87], a[60:63], v[160:175]
    ds_read_b64_tr_b16 v[100:101], v28 offset:20480
    ds_read_b64_tr_b16 v[102:103], v28 offset:21504
    s_waitcnt lgkmcnt(6)
    v_mfma_f32_32x32x16_bf16 v[160:175], v[88:91], a[72:75], v[160:175]
    ds_read_b64_tr_b16 v[72:73], v28 offset:24576
    ds_read_b64_tr_b16 v[74:75], v28 offset:25600
    s_waitcnt lgkmcnt(6)
    v_mfma_f32_32x32x16_bf16 v[160:175], v[92:95], a[76:79], v[160:175]
    ds_read_b64_tr_b16 v[76:77], v28 offset:28672
    ds_read_b64_tr_b16 v[78:79], v28 offset:29696
    s_waitcnt lgkmcnt(6)
    v_mfma_f32_32x32x16_bf16 v[160:175], v[96:99], a[80:83], v[160:175]
    ds_read_b64_tr_b16 v[80:81], v28 offset:40960
    ds_read_b64_tr_b16 v[82:83], v28 offset:41984
    s_waitcnt lgkmcnt(6)
    v_mfma_f32_32x32x16_bf16 v[160:175], v[100:103], a[84:87], v[160:175]
    ds_read_b64_tr_b16 v[84:85], v28 offset:45056
    ds_read_b64_tr_b16 v[86:87], v28 offset:46080
    s_waitcnt lgkmcnt(6)
    v_mfma_f32_32x32x16_bf16 v[160:175], v[72:75], a[88:91], v[160:175]
    ds_read_b64_tr_b16 v[88:89], v28 offset:49152
    ds_read_b64_tr_b16 v[90:91], v28 offset:50176
    s_waitcnt lgkmcnt(6)
    v_mfma_f32_32x32x16_bf16 v[160:175], v[76:79], a[92:95], v[160:175]
    ds_read_b64_tr_b16 v[92:93], v28 offset:53248
    ds_read_b64_tr_b16 v[94:95], v28 offset:54272
    s_waitcnt lgkmcnt(6)
    v_mfma_f32_32x32x16_bf16 v[160:175], v[80:83], a[104:107], v[160:175]
    ds_read_b64_tr_b16 v[96:97], v28 offset:57344
    ds_read_b64_tr_b16 v[98:99], v28 offset:58368
    s_waitcnt lgkmcnt(6)
    v_mfma_f32_32x32x16_bf16 v[160:175], v[84:87], a[108:111], v[160:175]
    ds_read_b64_tr_b16 v[100:101], v28 offset:61440
    ds_read_b64_tr_b16 v[102:103], v28 offset:62464
    s_waitcnt lgkmcnt(6)
    v_mfma_f32_32x32x16_bf16 v[160:175], v[88:91], a[112:115], v[160:175]
    ds_read_b64_tr_b16 v[72:73], v25 offset:0
    ds_read_b64_tr_b16 v[74:75], v25 offset:1024
    s_waitcnt lgkmcnt(6)
    v_mfma_f32_32x32x16_bf16 v[160:175], v[92:95], a[116:119], v[160:175]
    ds_read_b64_tr_b16 v[76:77], v25 offset:4096
    ds_read_b64_tr_b16 v[78:79], v25 offset:5120
    s_waitcnt lgkmcnt(6)
    v_mfma_f32_32x32x16_bf16 v[160:175], v[96:99], a[120:123], v[160:175]
    ds_read_b64_tr_b16 v[80:81], v25 offset:32768
    ds_read_b64_tr_b16 v[82:83], v25 offset:33792
    s_waitcnt lgkmcnt(6)
    v_mfma_f32_32x32x16_bf16 v[160:175], v[100:103], a[124:127], v[160:175]
    ds_read_b64_tr_b16 v[84:85], v25 offset:36864
    ds_read_b64_tr_b16 v[86:87], v25 offset:37888
    s_waitcnt lgkmcnt(6)
    v_mfma_f32_32x32x16_bf16 v[176:191], v[72:75], a[0:3], 0
    ds_read_b64_tr_b16 v[88:89], v29 offset:0
    ds_read_b64_tr_b16 v[90:91], v29 offset:1024
    s_waitcnt lgkmcnt(6)
    v_mfma_f32_32x32x16_bf16 v[176:191], v[76:79], a[4:7], v[176:191]
    ds_read_b64_tr_b16 v[92:93], v29 offset:4096
    ds_read_b64_tr_b16 v[94:95], v29 offset:5120
    s_waitcnt lgkmcnt(6)
    v_mfma_f32_32x32x16_bf16 v[176:191], v[80:83], a[32:35], v[176:191]
    ds_read_b64_tr_b16 v[96:97], v29 offset:32768
    ds_read_b64_tr_b16 v[98:99], v29 offset:33792
    s_waitcnt lgkmcnt(6)
    v_mfma_f32_32x32x16_bf16 v[176:191], v[84:87], a[36:39], v[176:191]
    ds_read_b64_tr_b16 v[100:101], v29 offset:36864
    ds_read_b64_tr_b16 v[102:103], v29 offset:37888
    v_cvt_pk_bf16_f32 v208, v160, v161
    v_cvt_pk_bf16_f32 v209, v162, v163
    s_waitcnt lgkmcnt(6)
    v_mfma_f32_32x32x16_bf16 v[176:191], v[88:91], a[64:67], v[176:191]
    ds_read_b64_tr_b16 v[72:73], v25 offset:8192
    ds_read_b64_tr_b16 v[74:75], v25 offset:9216
    v_cvt_pk_bf16_f32 v210, v164, v165
    v_cvt_pk_bf16_f32 v211, v166, v167
    s_waitcnt lgkmcnt(6)
    v_mfma_f32_32x32x16_bf16 v[176:191], v[92:95], a[68:71], v[176:191]
    ds_read_b64_tr_b16 v[76:77], v25 offset:12288
    ds_read_b64_tr_b16 v[78:79], v25 offset:13312
    v_cvt_pk_bf16_f32 v212, v168, v169
    v_cvt_pk_bf16_f32 v213, v170, v171
    s_waitcnt lgkmcnt(6)
    v_mfma_f32_32x32x16_bf16 v[176:191], v[96:99], a[96:99], v[176:191]
    ds_read_b64_tr_b16 v[80:81], v25 offset:16384
    ds_read_b64_tr_b16 v[82:83], v25 offset:17408
    v_cvt_pk_bf16_f32 v214, v172, v173
    v_cvt_pk_bf16_f32 v215, v174, v175
    s_waitcnt lgkmcnt(6)
    v_mfma_f32_32x32x16_bf16 v[176:191], v[100:103], a[100:103], v[176:191]
    ds_read_b64_tr_b16 v[84:85], v25 offset:20480
    ds_read_b64_tr_b16 v[86:87], v25 offset:21504
    buffer_store_dwordx4 v[208:211], v10, s[44:47], s58 offen offset:2048 sc1
    buffer_store_dwordx4 v[212:215], v10, s[44:47], s58 offen offset:2560 sc1
    s_waitcnt lgkmcnt(6)
    v_mfma_f32_32x32x16_bf16 v[176:191], v[72:75], a[8:11], v[176:191]
    ds_read_b64_tr_b16 v[88:89], v25 offset:24576
    ds_read_b64_tr_b16 v[90:91], v25 offset:25600
    s_waitcnt lgkmcnt(6)
    v_mfma_f32_32x32x16_bf16 v[176:191], v[76:79], a[12:15], v[176:191]
    ds_read_b64_tr_b16 v[92:93], v25 offset:28672
    ds_read_b64_tr_b16 v[94:95], v25 offset:29696
    s_waitcnt lgkmcnt(6)
    v_mfma_f32_32x32x16_bf16 v[176:191], v[80:83], a[16:19], v[176:191]
    ds_read_b64_tr_b16 v[96:97], v25 offset:40960
    ds_read_b64_tr_b16 v[98:99], v25 offset:41984
    s_waitcnt lgkmcnt(6)
    v_mfma_f32_32x32x16_bf16 v[176:191], v[84:87], a[20:23], v[176:191]
    ds_read_b64_tr_b16 v[100:101], v25 offset:45056
    ds_read_b64_tr_b16 v[102:103], v25 offset:46080
    s_waitcnt lgkmcnt(6)
    v_mfma_f32_32x32x16_bf16 v[176:191], v[88:91], a[24:27], v[176:191]
    ds_read_b64_tr_b16 v[72:73], v25 offset:49152
    ds_read_b64_tr_b16 v[74:75], v25 offset:50176
    s_waitcnt lgkmcnt(6)
    v_mfma_f32_32x32x16_bf16 v[176:191], v[92:95], a[28:31], v[176:191]
    ds_read_b64_tr_b16 v[76:77], v25 offset:53248
    ds_read_b64_tr_b16 v[78:79], v25 offset:54272
    s_waitcnt lgkmcnt(6)
    v_mfma_f32_32x32x16_bf16 v[176:191], v[96:99], a[40:43], v[176:191]
    ds_read_b64_tr_b16 v[80:81], v25 offset:57344
    ds_read_b64_tr_b16 v[82:83], v25 offset:58368
    s_waitcnt lgkmcnt(6)
    v_mfma_f32_32x32x16_bf16 v[176:191], v[100:103], a[44:47], v[176:191]
    ds_read_b64_tr_b16 v[84:85], v25 offset:61440
    ds_read_b64_tr_b16 v[86:87], v25 offset:62464
    s_waitcnt lgkmcnt(6)
    v_mfma_f32_32x32x16_bf16 v[176:191], v[72:75], a[48:51], v[176:191]
    ds_read_b64_tr_b16 v[88:89], v29 offset:8192
    ds_read_b64_tr_b16 v[90:91], v29 offset:9216
    s_waitcnt lgkmcnt(6)
    v_mfma_f32_32x32x16_bf16 v[176:191], v[76:79], a[52:55], v[176:191]
    ds_read_b64_tr_b16 v[92:93], v29 offset:12288
    ds_read_b64_tr_b16 v[94:95], v29 offset:13312
    s_waitcnt lgkmcnt(6)
    v_mfma_f32_32x32x16_bf16 v[176:191], v[80:83], a[56:59], v[176:191]
    ds_read_b64_tr_b16 v[96:97], v29 offset:16384
    ds_read_b64_tr_b16 v[98:99], v29 offset:17408
    s_waitcnt lgkmcnt(6)
    v_mfma_f32_32x32x16_bf16 v[176:191], v[84:87], a[60:63], v[176:191]
    ds_read_b64_tr_b16 v[100:101], v29 offset:20480
    ds_read_b64_tr_b16 v[102:103], v29 offset:21504
    s_waitcnt lgkmcnt(6)
    v_mfma_f32_32x32x16_bf16 v[176:191], v[88:91], a[72:75], v[176:191]
    ds_read_b64_tr_b16 v[72:73], v29 offset:24576
    ds_read_b64_tr_b16 v[74:75], v29 offset:25600
    s_waitcnt lgkmcnt(6)
    v_mfma_f32_32x32x16_bf16 v[176:191], v[92:95], a[76:79], v[176:191]
    ds_read_b64_tr_b16 v[76:77], v29 offset:28672
    ds_read_b64_tr_b16 v[78:79], v29 offset:29696
    s_waitcnt lgkmcnt(6)
    v_mfma_f32_32x32x16_bf16 v[176:191], v[96:99], a[80:83], v[176:191]
    ds_read_b64_tr_b16 v[80:81], v29 offset:40960
    ds_read_b64_tr_b16 v[82:83], v29 offset:41984
    s_waitcnt lgkmcnt(6)
    v_mfma_f32_32x32x16_bf16 v[176:191], v[100:103], a[84:87], v[176:191]
    ds_read_b64_tr_b16 v[84:85], v29 offset:45056
    ds_read_b64_tr_b16 v[86:87], v29 offset:46080
    s_waitcnt lgkmcnt(6)
    v_mfma_f32_32x32x16_bf16 v[176:191], v[72:75], a[88:91], v[176:191]
    ds_read_b64_tr_b16 v[88:89], v29 offset:49152
    ds_read_b64_tr_b16 v[90:91], v29 offset:50176
    s_waitcnt lgkmcnt(6)
    v_mfma_f32_32x32x16_bf16 v[176:191], v[76:79], a[92:95], v[176:191]
    ds_read_b64_tr_b16 v[92:93], v29 offset:53248
    ds_read_b64_tr_b16 v[94:95], v29 offset:54272
    s_waitcnt lgkmcnt(6)
    v_mfma_f32_32x32x16_bf16 v[176:191], v[80:83], a[104:107], v[176:191]
    ds_read_b64_tr_b16 v[96:97], v29 offset:57344
    ds_read_b64_tr_b16 v[98:99], v29 offset:58368
    s_waitcnt lgkmcnt(6)
    v_mfma_f32_32x32x16_bf16 v[176:191], v[84:87], a[108:111], v[176:191]
    ds_read_b64_tr_b16 v[100:101], v29 offset:61440
    ds_read_b64_tr_b16 v[102:103], v29 offset:62464
    s_waitcnt lgkmcnt(6)
    v_mfma_f32_32x32x16_bf16 v[176:191], v[88:91], a[112:115], v[176:191]
    s_waitcnt lgkmcnt(4)
    v_mfma_f32_32x32x16_bf16 v[176:191], v[92:95], a[116:119], v[176:191]
    s_waitcnt lgkmcnt(2)
    v_mfma_f32_32x32x16_bf16 v[176:191], v[96:99], a[120:123], v[176:191]
    s_waitcnt lgkmcnt(0)
    v_mfma_f32_32x32x16_bf16 v[176:191], v[100:103], a[124:127], v[176:191]
    s_nop 11
    v_cvt_pk_bf16_f32 v216, v176, v177
    v_cvt_pk_bf16_f32 v217, v178, v179
    v_cvt_pk_bf16_f32 v218, v180, v181
    v_cvt_pk_bf16_f32 v219, v182, v183
    v_cvt_pk_bf16_f32 v220, v184, v185
    v_cvt_pk_bf16_f32 v221, v186, v187
    v_cvt_pk_bf16_f32 v222, v188, v189
    v_cvt_pk_bf16_f32 v223, v190, v191
    buffer_store_dwordx4 v[216:219], v10, s[44:47], s58 offen offset:3072 sc1
    buffer_store_dwordx4 v[220:223], v10, s[44:47], s58 offen offset:3584 sc1
    s_waitcnt vmcnt(0)
    v_mov_b32 v31, 1
    v_lshlrev_b32 v103, 2, v1
    s_mov_b64 exec, 1
    buffer_store_dword v31, v103, s[44:47], s93 offen sc1
    s_mov_b64 exec, -1
    s_cmp_lg_u32 s3, 0
    s_cbranch_scc1 L_g1red_x
    s_mov_b32 s68, 262144
L_g1red:
    v_mov_b32 v31, 1
    s_mov_b64 exec, 255
    v_mov_b32 v31, 0
    buffer_atomic_or v31, v15, s[44:47], s64 offen sc0 sc1
    s_mov_b64 exec, -1
    s_waitcnt vmcnt(0)
    v_cmp_ne_u32 vcc, 1, v31
    s_cbranch_vccz L_g1red_x
    s_sub_u32 s68, s68, 1
    s_cbranch_scc0 L_g1red
L_g1red_x:
    s_barrier
    buffer_load_dwordx4 v[72:75], v13, s[44:47], s53 offen sc1
    s_add_u32 s53, s53, 4096
    buffer_load_dwordx4 v[76:79], v13, s[44:47], s53 offen sc1
    s_add_u32 s53, s53, 4096
    buffer_load_dwordx4 v[80:83], v13, s[44:47], s53 offen sc1
    s_add_u32 s53, s53, 4096
    buffer_load_dwordx4 v[84:87], v13, s[44:47], s53 offen sc1
    buffer_load_dwordx4 v[88:91], v13, s[44:47], s54 offen sc1
    s_add_u32 s54, s54, 4096
    buffer_load_dwordx4 v[92:95], v13, s[44:47], s54 offen sc1
    s_add_u32 s54, s54, 4096
    buffer_load_dwordx4 v[96:99], v13, s[44:47], s54 offen sc1
    s_add_u32 s54, s54, 4096
    buffer_load_dwordx4 v[100:103], v13, s[44:47], s54 offen sc1
    s_waitcnt vmcnt(7)
    v_lshlrev_b32 v128, 16, v72
    v_and_b32 v129, 0xffff0000, v72
    v_lshlrev_b32 v130, 16, v73
    v_and_b32 v131, 0xffff0000, v73
    v_lshlrev_b32 v132, 16, v74
    v_and_b32 v133, 0xffff0000, v74
    v_lshlrev_b32 v134, 16, v75
    v_and_b32 v135, 0xffff0000, v75
    s_waitcnt vmcnt(6)
    v_lshlrev_b32 v136, 16, v76
    v_and_b32 v137, 0xffff0000, v76
    v_lshlrev_b32 v138, 16, v77
    v_and_b32 v139, 0xffff0000, v77
    v_lshlrev_b32 v140, 16, v78
    v_and_b32 v141, 0xffff0000, v78
    v_lshlrev_b32 v142, 16, v79
    v_and_b32 v143, 0xffff0000, v79
    v_pk_add_f32 v[128:129], v[128:129], v[136:137]
    v_pk_add_f32 v[130:131], v[130:131], v[138:139]
    v_pk_add_f32 v[132:133], v[132:133], v[140:141]
    v_pk_add_f32 v[134:135], v[134:135], v[142:143]
    s_waitcnt vmcnt(5)
    v_lshlrev_b32 v136, 16, v80
    v_and_b32 v137, 0xffff0000, v80
    v_lshlrev_b32 v138, 16, v81
    v_and_b32 v139, 0xffff0000, v81
    v_lshlrev_b32 v140, 16, v82
    v_and_b32 v141, 0xffff0000, v82
    v_lshlrev_b32 v142, 16, v83
    v_and_b32 v143, 0xffff0000, v83
    v_pk_add_f32 v[128:129], v[128:129], v[136:137]
    v_pk_add_f32 v[130:131], v[130:131], v[138:139]
    v_pk_add_f32 v[132:133], v[132:133], v[140:141]
    v_pk_add_f32 v[134:135], v[134:135], v[142:143]
    s_waitcnt vmcnt(4)
    v_lshlrev_b32 v136, 16, v84
    v_and_b32 v137, 0xffff0000, v84
    v_lshlrev_b32 v138, 16, v85
    v_and_b32 v139, 0xffff0000, v85
    v_lshlrev_b32 v140, 16, v86
    v_and_b32 v141, 0xffff0000, v86
    v_lshlrev_b32 v142, 16, v87
    v_and_b32 v143, 0xffff0000, v87
    v_pk_add_f32 v[128:129], v[128:129], v[136:137]
    v_pk_add_f32 v[130:131], v[130:131], v[138:139]
    v_pk_add_f32 v[132:133], v[132:133], v[140:141]
    v_pk_add_f32 v[134:135], v[134:135], v[142:143]
    s_waitcnt vmcnt(3)
    v_lshlrev_b32 v136, 16, v88
    v_and_b32 v137, 0xffff0000, v88
    v_lshlrev_b32 v138, 16, v89
    v_and_b32 v139, 0xffff0000, v89
    v_lshlrev_b32 v140, 16, v90
    v_and_b32 v141, 0xffff0000, v90
    v_lshlrev_b32 v142, 16, v91
    v_and_b32 v143, 0xffff0000, v91
    v_pk_add_f32 v[128:129], v[128:129], v[136:137]
    v_pk_add_f32 v[130:131], v[130:131], v[138:139]
    v_pk_add_f32 v[132:133], v[132:133], v[140:141]
    v_pk_add_f32 v[134:135], v[134:135], v[142:143]
    s_waitcnt vmcnt(2)
    v_lshlrev_b32 v136, 16, v92
    v_and_b32 v137, 0xffff0000, v92
    v_lshlrev_b32 v138, 16, v93
    v_and_b32 v139, 0xffff0000, v93
    v_lshlrev_b32 v140, 16, v94
    v_and_b32 v141, 0xffff0000, v94
    v_lshlrev_b32 v142, 16, v95
    v_and_b32 v143, 0xffff0000, v95
    v_pk_add_f32 v[128:129], v[128:129], v[136:137]
    v_pk_add_f32 v[130:131], v[130:131], v[138:139]
    v_pk_add_f32 v[132:133], v[132:133], v[140:141]
    v_pk_add_f32 v[134:135], v[134:135], v[142:143]
    s_waitcnt vmcnt(1)
    v_lshlrev_b32 v136, 16, v96
    v_and_b32 v137, 0xffff0000, v96
    v_lshlrev_b32 v138, 16, v97
    v_and_b32 v139, 0xffff0000, v97
    v_lshlrev_b32 v140, 16, v98
    v_and_b32 v141, 0xffff0000, v98
    v_lshlrev_b32 v142, 16, v99
    v_and_b32 v143, 0xffff0000, v99
    v_pk_add_f32 v[128:129], v[128:129], v[136:137]
    v_pk_add_f32 v[130:131], v[130:131], v[138:139]
    v_pk_add_f32 v[132:133], v[132:133], v[140:141]
    v_pk_add_f32 v[134:135], v[134:135], v[142:143]
    s_waitcnt vmcnt(0)
    v_lshlrev_b32 v136, 16, v100
    v_and_b32 v137, 0xffff0000, v100
    v_lshlrev_b32 v138, 16, v101
    v_and_b32 v139, 0xffff0000, v101
    v_lshlrev_b32 v140, 16, v102
    v_and_b32 v141, 0xffff0000, v102
    v_lshlrev_b32 v142, 16, v103
    v_and_b32 v143, 0xffff0000, v103
    v_pk_add_f32 v[128:129], v[128:129], v[136:137]
    v_pk_add_f32 v[130:131], v[130:131], v[138:139]
    v_pk_add_f32 v[132:133], v[132:133], v[140:141]
    v_pk_add_f32 v[134:135], v[134:135], v[142:143]
    v_cvt_pk_bf16_f32 v144, v128, v129
    v_cvt_pk_bf16_f32 v145, v130, v131
    v_cvt_pk_bf16_f32 v146, v132, v133
    v_cvt_pk_bf16_f32 v147, v134, v135
    buffer_store_dwordx4 v[144:147], v14, s[8:11], s66 offen
    s_endpgm
L_g1early:
    s_add_u32 s7, s52, 0
    s_and_b32 s7, s7, 3
    s_lshl_b32 s7, s7, 13
    s_add_u32 s7, s7, s96
    s_add_u32 s56, s59, s7
    s_xor_b32 s57, s59, 4096
    s_add_u32 s57, s57, s7
    buffer_load_dwordx4 a[0:3], v30, s[44:47], s56 offen offset:0 sc1
    buffer_load_dwordx4 a[4:7], v30, s[44:47], s56 offen offset:1024 sc1
    s_add_u32 s7, s52, 1
    s_and_b32 s7, s7, 3
    s_lshl_b32 s7, s7, 13
    s_add_u32 s7, s7, s96
    s_add_u32 s56, s59, s7
    s_xor_b32 s57, s59, 4096
    s_add_u32 s57, s57, s7
    buffer_load_dwordx4 a[32:35], v30, s[44:47], s56 offen offset:0 sc1
    buffer_load_dwordx4 a[36:39], v30, s[44:47], s56 offen offset:1024 sc1
    s_add_u32 s7, s52, 2
    s_and_b32 s7, s7, 3
    s_lshl_b32 s7, s7, 13
    s_add_u32 s7, s7, s96
    s_add_u32 s56, s59, s7
    s_xor_b32 s57, s59, 4096
    s_add_u32 s57, s57, s7
    buffer_load_dwordx4 a[64:67], v30, s[44:47], s56 offen offset:0 sc1
    buffer_load_dwordx4 a[68:71], v30, s[44:47], s56 offen offset:1024 sc1
    s_add_u32 s7, s52, 3
    s_and_b32 s7, s7, 3
    s_lshl_b32 s7, s7, 13
    s_add_u32 s7, s7, s96
    s_add_u32 s56, s59, s7
    s_xor_b32 s57, s59, 4096
    s_add_u32 s57, s57, s7
    buffer_load_dwordx4 a[96:99], v30, s[44:47], s56 offen offset:0 sc1
    buffer_load_dwordx4 a[100:103], v30, s[44:47], s56 offen offset:1024 sc1
    s_waitcnt vmcnt(8)
    s_barrier
    s_cmp_lg_u32 s3, 0
    s_cbranch_scc1 L_g1pub0
    v_mov_b32 v31, 1
    v_lshlrev_b32 v103, 2, v1
    s_mov_b64 exec, 1
    buffer_store_dword v31, v103, s[44:47], s67 offen sc1
    s_mov_b64 exec, -1
L_g1pub0:
L_g1ready:
    ds_read_b64_tr_b16 v[72:73], v22 offset:0
    ds_read_b64_tr_b16 v[74:75], v22 offset:1024
    ds_read_b64_tr_b16 v[76:77], v23 offset:0
    ds_read_b64_tr_b16 v[78:79], v23 offset:1024
    ds_read_b64_tr_b16 v[80:81], v22 offset:4096
    ds_read_b64_tr_b16 v[82:83], v22 offset:5120
    ds_read_b64_tr_b16 v[84:85], v23 offset:4096
    ds_read_b64_tr_b16 v[86:87], v23 offset:5120
    s_waitcnt lgkmcnt(6)
    s_waitcnt vmcnt(7)
    s_add_u32 s7, s52, 0
    s_and_b32 s7, s7, 3
    s_lshl_b32 s7, s7, 13
    s_add_u32 s7, s7, s96
    s_add_u32 s56, s59, s7
    s_xor_b32 s57, s59, 4096
    s_add_u32 s57, s57, s7
    buffer_load_dwordx4 a[8:11], v30, s[44:47], s56 offen offset:2048 sc1
    s_add_u32 m0, s4, 8192
    s_nop 0
    buffer_load_dwordx4 v6, s[12:15], s60 offen lds
    buffer_load_dwordx4 v7, s[12:15], s60 offen offset:1024 lds
    v_mfma_f32_32x32x16_bf16 v[128:143], v[72:75], a[0:3], 0
    ds_read_b64_tr_b16 v[88:89], v22 offset:32768
    ds_read_b64_tr_b16 v[90:91], v22 offset:33792
    s_waitcnt lgkmcnt(6)
    v_mfma_f32_32x32x16_bf16 v[144:159], v[76:79], a[0:3], 0
    ds_read_b64_tr_b16 v[92:93], v23 offset:32768
    ds_read_b64_tr_b16 v[94:95], v23 offset:33792
    s_waitcnt lgkmcnt(6)
    s_waitcnt vmcnt(9)
    buffer_load_dwordx4 a[12:15], v30, s[44:47], s56 offen offset:3072 sc1
    buffer_load_dwordx4 v8, s[12:15], s60 offen offset:2048 lds
    buffer_load_dwordx4 v9, s[12:15], s60 offen offset:3072 lds
    v_mfma_f32_32x32x16_bf16 v[128:143], v[80:83], a[4:7], v[128:143]
    ds_read_b64_tr_b16 v[96:97], v22 offset:36864
    ds_read_b64_tr_b16 v[98:99], v22 offset:37888
    s_waitcnt lgkmcnt(6)
    v_mfma_f32_32x32x16_bf16 v[144:159], v[84:87], a[4:7], v[144:159]
    ds_read_b64_tr_b16 v[100:101], v23 offset:36864
    ds_read_b64_tr_b16 v[102:103], v23 offset:37888
    s_waitcnt lgkmcnt(6)
    s_waitcnt vmcnt(11)
    buffer_load_dwordx4 a[16:19], v30, s[44:47], s57 offen offset:0 sc1
    s_add_u32 s61, s60, 32768
    s_add_u32 m0, s4, 12288
    s_nop 0
    buffer_load_dwordx4 v6, s[12:15], s61 offen lds
    buffer_load_dwordx4 v7, s[12:15], s61 offen offset:1024 lds
    v_mfma_f32_32x32x16_bf16 v[128:143], v[88:91], a[32:35], v[128:143]
    ds_read_b64_tr_b16 v[72:73], v26 offset:0
    ds_read_b64_tr_b16 v[74:75], v26 offset:1024
    s_waitcnt lgkmcnt(6)
    v_mfma_f32_32x32x16_bf16 v[144:159], v[92:95], a[32:35], v[144:159]
    ds_read_b64_tr_b16 v[76:77], v27 offset:0
    ds_read_b64_tr_b16 v[78:79], v27 offset:1024
    s_waitcnt lgkmcnt(6)
    s_waitcnt vmcnt(13)
    buffer_load_dwordx4 a[20:23], v30, s[44:47], s57 offen offset:1024 sc1
    buffer_load_dwordx4 v8, s[12:15], s61 offen offset:2048 lds
    buffer_load_dwordx4 v9, s[12:15], s61 offen offset:3072 lds
    s_xor_b32 s7, s62, 131072
    s_add_u32 s60, s63, s7
    v_mfma_f32_32x32x16_bf16 v[128:143], v[96:99], a[36:39], v[128:143]
    ds_read_b64_tr_b16 v[80:81], v26 offset:4096
    ds_read_b64_tr_b16 v[82:83], v26 offset:5120
    s_waitcnt lgkmcnt(6)
    v_mfma_f32_32x32x16_bf16 v[144:159], v[100:103], a[36:39], v[144:159]
    ds_read_b64_tr_b16 v[84:85], v27 offset:4096
    ds_read_b64_tr_b16 v[86:87], v27 offset:5120
    s_waitcnt lgkmcnt(6)
    s_waitcnt vmcnt(15)
    buffer_load_dwordx4 a[24:27], v30, s[44:47], s57 offen offset:2048 sc1
    s_add_u32 m0, s4, 16384
    s_nop 0
    buffer_load_dwordx4 v6, s[12:15], s60 offen lds
    buffer_load_dwordx4 v7, s[12:15], s60 offen offset:1024 lds
    v_mfma_f32_32x32x16_bf16 v[128:143], v[72:75], a[64:67], v[128:143]
    ds_read_b64_tr_b16 v[88:89], v26 offset:32768
    ds_read_b64_tr_b16 v[90:91], v26 offset:33792
    s_waitcnt lgkmcnt(6)
    v_mfma_f32_32x32x16_bf16 v[144:159], v[76:79], a[64:67], v[144:159]
    ds_read_b64_tr_b16 v[92:93], v27 offset:32768
    ds_read_b64_tr_b16 v[94:95], v27 offset:33792
    s_waitcnt lgkmcnt(6)
    s_waitcnt vmcnt(17)
    buffer_load_dwordx4 a[28:31], v30, s[44:47], s57 offen offset:3072 sc1
    buffer_load_dwordx4 v8, s[12:15], s60 offen offset:2048 lds
    buffer_load_dwordx4 v9, s[12:15], s60 offen offset:3072 lds
    v_mfma_f32_32x32x16_bf16 v[128:143], v[80:83], a[68:71], v[128:143]
    ds_read_b64_tr_b16 v[96:97], v26 offset:36864
    ds_read_b64_tr_b16 v[98:99], v26 offset:37888
    s_waitcnt lgkmcnt(6)
    v_mfma_f32_32x32x16_bf16 v[144:159], v[84:87], a[68:71], v[144:159]
    ds_read_b64_tr_b16 v[100:101], v27 offset:36864
    ds_read_b64_tr_b16 v[102:103], v27 offset:37888
    s_add_u32 s61, s60, 32768
    s_add_u32 m0, s4, 20480
    s_nop 0
    buffer_load_dwordx4 v6, s[12:15], s61 offen lds
    buffer_load_dwordx4 v7, s[12:15], s61 offen offset:1024 lds
    buffer_load_dwordx4 v8, s[12:15], s61 offen offset:2048 lds
    buffer_load_dwordx4 v9, s[12:15], s61 offen offset:3072 lds
    s_xor_b32 s7, s62, 196608
    s_add_u32 s60, s63, s7
    s_add_u32 m0, s4, 24576
    s_nop 0
    buffer_load_dwordx4 v6, s[12:15], s60 offen lds
    buffer_load_dwordx4 v7, s[12:15], s60 offen offset:1024 lds
    buffer_load_dwordx4 v8, s[12:15], s60 offen offset:2048 lds
    buffer_load_dwordx4 v9, s[12:15], s60 offen offset:3072 lds
    s_add_u32 s61, s60, 32768
    s_add_u32 m0, s4, 28672
    s_nop 0
    buffer_load_dwordx4 v6, s[12:15], s61 offen lds
    buffer_load_dwordx4 v7, s[12:15], s61 offen offset:1024 lds
    buffer_load_dwordx4 v8, s[12:15], s61 offen offset:2048 lds
    buffer_load_dwordx4 v9, s[12:15], s61 offen offset:3072 lds
    s_waitcnt vmcnt(0)
    s_branch L_g1go
L_g1second:
    s_add_u32 s7, s52, 0
    s_and_b32 s7, s7, 3
    s_lshl_b32 s7, s7, 13
    s_add_u32 s7, s7, s96
    s_add_u32 s56, s59, s7
    s_xor_b32 s57, s59, 4096
    s_add_u32 s57, s57, s7
    buffer_load_dwordx4 a[0:3], v30, s[44:47], s56 offen offset:0 sc1
    buffer_load_dwordx4 a[4:7], v30, s[44:47], s56 offen offset:1024 sc1
    s_add_u32 s7, s52, 1
    s_and_b32 s7, s7, 3
    s_lshl_b32 s7, s7, 13
    s_add_u32 s7, s7, s96
    s_add_u32 s56, s59, s7
    s_xor_b32 s57, s59, 4096
    s_add_u32 s57, s57, s7
    buffer_load_dwordx4 a[32:35], v30, s[44:47], s56 offen offset:0 sc1
    buffer_load_dwordx4 a[36:39], v30, s[44:47], s56 offen offset:1024 sc1
    s_add_u32 s7, s52, 2
    s_and_b32 s7, s7, 3
    s_lshl_b32 s7, s7, 13
    s_add_u32 s7, s7, s96
    s_add_u32 s56, s59, s7
    s_xor_b32 s57, s59, 4096
    s_add_u32 s57, s57, s7
    buffer_load_dwordx4 a[64:67], v30, s[44:47], s56 offen offset:0 sc1
    buffer_load_dwordx4 a[68:71], v30, s[44:47], s56 offen offset:1024 sc1
    s_add_u32 s7, s52, 3
    s_and_b32 s7, s7, 3
    s_lshl_b32 s7, s7, 13
    s_add_u32 s7, s7, s96
    s_add_u32 s56, s59, s7
    s_xor_b32 s57, s59, 4096
    s_add_u32 s57, s57, s7
    buffer_load_dwordx4 a[96:99], v30, s[44:47], s56 offen offset:0 sc1
    buffer_load_dwordx4 a[100:103], v30, s[44:47], s56 offen offset:1024 sc1
    s_branch L_g1ready
L_g2:
    s_mov_b32 s44, s40
    s_mov_b32 s45, s41
    s_mov_b32 s46, 268435456
    s_mov_b32 s47, 0x20000
    s_lshl_b32 s64, s55, 13
    s_add_u32 s64, s64, 2097152
    s_add_u32 s65, s64, 4194304
    s_lshl_b32 s66, s55, 6
    s_add_u32 s66, s66, 16793600
    s_lshl_b32 s67, s54, 3
    s_add_u32 s67, s67, s50
    s_lshl_b32 s67, s67, 8
    s_and_b32 s7, s51, 3
    s_lshl_b32 s7, s7, 2
    s_add_u32 s67, s67, s7
    s_add_u32 s67, s67, 18890752
    s_mov_b32 s6, 0x3e0293ee
    s_lshl_b32 s97, s52, 1
    s_lshl_b32 s98, s50, 5
    s_add_u32 s98, s98, s97
    s_lshl_b32 s99, s98, 6
    s_add_u32 s99, s99, 16777216
    s_lshl_b32 s98, s98, 13
    s_lshl_b32 s100, s50, 3
    s_lshr_b32 s7, s52, 1
    s_add_u32 s100, s100, s7
    s_lshl_b32 s100, s100, 8
    s_and_b32 s7, s52, 1
    s_lshl_b32 s7, s7, 3
    s_add_u32 s100, s100, s7
    s_add_u32 s100, s100, 18874368
    s_add_u32 s101, s100, 4
    s_lshl_b32 s69, s3, 13
    s_add_u32 s69, s69, 131072
    s_xor_b32 s92, s51, 16
    s_lshl_b32 s93, s92, 2
    s_add_u32 s93, s93, s3
    s_lshl_b32 s93, s93, 8
    s_lshl_b32 s7, s50, 2
    s_add_u32 s93, s93, s7
    s_add_u32 s93, s93, 20971520
    s_cmp_lg_u32 s3, 0
    s_cbranch_scc1 L_g2clear
    v_mov_b32 v31, 0
    v_lshlrev_b32 v103, 2, v1
    s_mov_b64 exec, 1
    buffer_store_dword v31, v103, s[44:47], s67 offen sc1
    s_mov_b64 exec, -1
    v_lshlrev_b32 v103, 2, v1
    s_mov_b64 exec, 3
    buffer_store_dword v31, v103, s[44:47], s100 offen sc1
    s_mov_b64 exec, -1
    v_lshlrev_b32 v103, 8, v1
    s_mov_b64 exec, 15
    buffer_store_dword v31, v103, s[44:47], s93 offen sc1
    s_mov_b64 exec, -1
L_g2clear:
    v_and_b32 v31, 31, v1
    v_lshrrev_b32 v32, 5, v1
    v_and_b32 v33, 15, v1
    v_xor_b32 v32, v32, v33
    v_lshlrev_b32 v32, 4, v32
    v_lshlrev_b32 v31, 8, v31
    v_add_u32 v31, s4, v31
    v_xor_b32 v10, 0, v32
    v_add_u32 v10, v10, v31
    v_xor_b32 v11, 32, v32
    v_add_u32 v11, v11, v31
    v_xor_b32 v12, 64, v32
    v_add_u32 v12, v12, v31
    v_xor_b32 v13, 96, v32
    v_add_u32 v13, v13, v31
    v_xor_b32 v14, 128, v32
    v_add_u32 v14, v14, v31
    v_xor_b32 v15, 160, v32
    v_add_u32 v15, v15, v31
    v_xor_b32 v16, 192, v32
    v_add_u32 v16, v16, v31
    v_xor_b32 v17, 224, v32
    v_add_u32 v17, v17, v31
    v_bfe_u32 v31, v1, 2, 2
    v_bfe_u32 v32, v1, 4, 1
    v_lshlrev_b32 v32, 5, v32
    v_and_b32 v33, 1, v1
    v_lshl_add_u32 v32, v33, 4, v32
    v_bfe_u32 v33, v1, 1, 1
    v_lshl_add_u32 v32, v33, 3, v32
    v_lshl_add_u32 v32, v31, 8, v32
    v_lshrrev_b32 v33, 5, v1
    v_lshlrev_b32 v31, 6, v31
    v_xor_b32 v34, 0, v31
    v_add_u32 v34, v34, v32
    v_lshl_add_u32 v22, v33, 11, v34
    v_add_u32 v26, 0x10000, v22
    v_xor_b32 v34, 64, v31
    v_add_u32 v34, v34, v32
    v_lshl_add_u32 v23, v33, 11, v34
    v_add_u32 v27, 0x10000, v23
    v_xor_b32 v34, 128, v31
    v_add_u32 v34, v34, v32
    v_lshl_add_u32 v24, v33, 11, v34
    v_add_u32 v28, 0x10000, v24
    v_xor_b32 v34, 192, v31
    v_add_u32 v34, v34, v32
    v_lshl_add_u32 v25, v33, 11, v34
    v_add_u32 v29, 0x10000, v25
    s_add_u32 s5, s3, 0
    s_and_b32 s5, s5, 3
    s_lshl_b32 s5, s5, 6
    v_xor_b32 v34, s5, v31
    v_add3_u32 v34, v34, v32, s4
    v_lshl_add_u32 v18, v33, 10, v34
    s_add_u32 s5, s3, 1
    s_and_b32 s5, s5, 3
    s_lshl_b32 s5, s5, 6
    v_xor_b32 v34, s5, v31
    v_add3_u32 v34, v34, v32, s4
    v_lshl_add_u32 v19, v33, 10, v34
    s_add_u32 s5, s3, 2
    s_and_b32 s5, s5, 3
    s_lshl_b32 s5, s5, 6
    v_xor_b32 v34, s5, v31
    v_add3_u32 v34, v34, v32, s4
    v_lshl_add_u32 v20, v33, 10, v34
    s_add_u32 s5, s3, 3
    s_and_b32 s5, s5, 3
    s_lshl_b32 s5, s5, 6
    v_xor_b32 v34, s5, v31
    v_add3_u32 v34, v34, v32, s4
    v_lshl_add_u32 v21, v33, 10, v34
    s_getpc_b64 s[48:49]
L_g2pf:
    s_add_u32 s48, s48, L_g2pf_x-L_g2pf
    s_addc_u32 s49, s49, 0
    s_lshl_b32 s7, s52, 2
    s_add_u32 s7, s7, s3
    s_mul_i32 s7, s7, 512
    v_lshl_add_u32 v101, v1, 7, s7
    v_min_u32 v101, L_end-L_g2pf_x-4, v101
    s_mov_b64 exec, 15
    global_load_dword v31, v101, s[48:49]
    s_mov_b64 exec, -1
L_g2pf_x:
    s_waitcnt vmcnt(15)
    s_add_u32 m0, s4, 16384
    s_nop 0
    buffer_load_dwordx4 v2, s[8:11], s56 offen nt lds
    s_waitcnt vmcnt(15)
    buffer_load_dwordx4 v3, s[8:11], s56 offen offset:1024 nt lds
    s_waitcnt vmcnt(15)
    buffer_load_dwordx4 v4, s[8:11], s56 offen offset:2048 nt lds
    s_waitcnt vmcnt(15)
    buffer_load_dwordx4 v5, s[8:11], s56 offen offset:3072 nt lds
    s_waitcnt vmcnt(15)
    s_add_u32 s57, s56, 16384
    s_add_u32 m0, s4, 20480
    s_nop 0
    buffer_load_dwordx4 v2, s[8:11], s57 offen nt lds
    s_waitcnt vmcnt(15)
    buffer_load_dwordx4 v3, s[8:11], s57 offen offset:1024 nt lds
    s_waitcnt vmcnt(15)
    buffer_load_dwordx4 v4, s[8:11], s57 offen offset:2048 nt lds
    s_waitcnt vmcnt(15)
    buffer_load_dwordx4 v5, s[8:11], s57 offen offset:3072 nt lds
    s_add_u32 s56, s56, 32768
    ds_read_b128 a[0:3], v10 offset:0
    ds_read_b128 a[4:7], v11 offset:0
    ds_read_b128 a[8:11], v12 offset:0
    ds_read_b128 a[12:15], v13 offset:0
    ds_read_b128 a[16:19], v14 offset:0
    ds_read_b128 a[20:23], v15 offset:0
    ds_read_b128 a[24:27], v16 offset:0
    ds_read_b128 a[28:31], v17 offset:0
    s_waitcnt lgkmcnt(0)
    s_waitcnt vmcnt(15)
    s_add_u32 m0, s4, 24576
    s_nop 0
    buffer_load_dwordx4 v2, s[8:11], s56 offen nt lds
    s_waitcnt vmcnt(15)
    buffer_load_dwordx4 v3, s[8:11], s56 offen offset:1024 nt lds
    s_waitcnt vmcnt(15)
    buffer_load_dwordx4 v4, s[8:11], s56 offen offset:2048 nt lds
    s_waitcnt vmcnt(15)
    buffer_load_dwordx4 v5, s[8:11], s56 offen offset:3072 nt lds
    s_waitcnt vmcnt(15)
    s_add_u32 s57, s56, 16384
    s_add_u32 m0, s4, 28672
    s_nop 0
    buffer_load_dwordx4 v2, s[8:11], s57 offen nt lds
    s_waitcnt vmcnt(15)
    buffer_load_dwordx4 v3, s[8:11], s57 offen offset:1024 nt lds
    s_waitcnt vmcnt(15)
    buffer_load_dwordx4 v4, s[8:11], s57 offen offset:2048 nt lds
    s_waitcnt vmcnt(15)
    buffer_load_dwordx4 v5, s[8:11], s57 offen offset:3072 nt lds
    s_add_u32 s56, s56, 32768
    ds_read_b128 a[32:35], v10 offset:8192
    ds_read_b128 a[36:39], v11 offset:8192
    ds_read_b128 a[40:43], v12 offset:8192
    ds_read_b128 a[44:47], v13 offset:8192
    ds_read_b128 a[48:51], v14 offset:8192
    ds_read_b128 a[52:55], v15 offset:8192
    ds_read_b128 a[56:59], v16 offset:8192
    ds_read_b128 a[60:63], v17 offset:8192
    s_waitcnt lgkmcnt(0)
    s_cmp_lg_u32 s3, 0
    s_cbranch_scc1 L_g2count
    s_lshl_b32 s7, s50, 5
    v_mov_b32 v31, 1
    v_mov_b32 v103, s7
    s_mov_b64 exec, 1
    global_atomic_add v103, v31, s[38:39] sc1
    s_mov_b64 exec, -1
L_g2count:
    s_waitcnt vmcnt(15)
    s_add_u32 m0, s4, 0
    s_nop 0
    buffer_load_dwordx4 v2, s[8:11], s56 offen nt lds
    s_waitcnt vmcnt(15)
    buffer_load_dwordx4 v3, s[8:11], s56 offen offset:1024 nt lds
    s_waitcnt vmcnt(15)
    buffer_load_dwordx4 v4, s[8:11], s56 offen offset:2048 nt lds
    s_waitcnt vmcnt(15)
    buffer_load_dwordx4 v5, s[8:11], s56 offen offset:3072 nt lds
    s_waitcnt vmcnt(15)
    s_add_u32 s57, s56, 16384
    s_add_u32 m0, s4, 4096
    s_nop 0
    buffer_load_dwordx4 v2, s[8:11], s57 offen nt lds
    s_waitcnt vmcnt(15)
    buffer_load_dwordx4 v3, s[8:11], s57 offen offset:1024 nt lds
    s_waitcnt vmcnt(15)
    buffer_load_dwordx4 v4, s[8:11], s57 offen offset:2048 nt lds
    s_waitcnt vmcnt(15)
    buffer_load_dwordx4 v5, s[8:11], s57 offen offset:3072 nt lds
    s_add_u32 s56, s56, 32768
    ds_read_b128 a[64:67], v10 offset:16384
    ds_read_b128 a[68:71], v11 offset:16384
    ds_read_b128 a[72:75], v12 offset:16384
    ds_read_b128 a[76:79], v13 offset:16384
    ds_read_b128 a[80:83], v14 offset:16384
    ds_read_b128 a[84:87], v15 offset:16384
    ds_read_b128 a[88:91], v16 offset:16384
    ds_read_b128 a[92:95], v17 offset:16384
    s_waitcnt lgkmcnt(0)
    s_waitcnt vmcnt(15)
    s_add_u32 m0, s4, 8192
    s_nop 0
    buffer_load_dwordx4 v2, s[8:11], s56 offen nt lds
    s_waitcnt vmcnt(15)
    buffer_load_dwordx4 v3, s[8:11], s56 offen offset:1024 nt lds
    s_waitcnt vmcnt(15)
    buffer_load_dwordx4 v4, s[8:11], s56 offen offset:2048 nt lds
    s_waitcnt vmcnt(15)
    buffer_load_dwordx4 v5, s[8:11], s56 offen offset:3072 nt lds
    s_waitcnt vmcnt(15)
    s_add_u32 s57, s56, 16384
    s_add_u32 m0, s4, 12288
    s_nop 0
    buffer_load_dwordx4 v2, s[8:11], s57 offen nt lds
    s_waitcnt vmcnt(15)
    buffer_load_dwordx4 v3, s[8:11], s57 offen offset:1024 nt lds
    s_waitcnt vmcnt(15)
    buffer_load_dwordx4 v4, s[8:11], s57 offen offset:2048 nt lds
    s_waitcnt vmcnt(15)
    buffer_load_dwordx4 v5, s[8:11], s57 offen offset:3072 nt lds
    s_add_u32 s56, s56, 32768
    ds_read_b128 a[96:99], v10 offset:24576
    ds_read_b128 a[100:103], v11 offset:24576
    ds_read_b128 a[104:107], v12 offset:24576
    ds_read_b128 a[108:111], v13 offset:24576
    ds_read_b128 a[112:115], v14 offset:24576
    ds_read_b128 a[116:119], v15 offset:24576
    ds_read_b128 a[120:123], v16 offset:24576
    ds_read_b128 a[124:127], v17 offset:24576
    s_waitcnt lgkmcnt(0)
    s_waitcnt vmcnt(15)
    s_add_u32 m0, s4, 16384
    s_nop 0
    buffer_load_dwordx4 v2, s[8:11], s56 offen nt lds
    s_waitcnt vmcnt(15)
    buffer_load_dwordx4 v3, s[8:11], s56 offen offset:1024 nt lds
    s_waitcnt vmcnt(15)
    buffer_load_dwordx4 v4, s[8:11], s56 offen offset:2048 nt lds
    s_waitcnt vmcnt(15)
    buffer_load_dwordx4 v5, s[8:11], s56 offen offset:3072 nt lds
    s_waitcnt vmcnt(15)
    s_add_u32 s57, s56, 16384
    s_add_u32 m0, s4, 20480
    s_nop 0
    buffer_load_dwordx4 v2, s[8:11], s57 offen nt lds
    s_waitcnt vmcnt(15)
    buffer_load_dwordx4 v3, s[8:11], s57 offen offset:1024 nt lds
    s_waitcnt vmcnt(15)
    buffer_load_dwordx4 v4, s[8:11], s57 offen offset:2048 nt lds
    s_waitcnt vmcnt(15)
    buffer_load_dwordx4 v5, s[8:11], s57 offen offset:3072 nt lds
    s_add_u32 s56, s56, 32768
    ds_read_b128 a[128:131], v10 offset:0
    ds_read_b128 a[132:135], v11 offset:0
    ds_read_b128 a[136:139], v12 offset:0
    ds_read_b128 a[140:143], v13 offset:0
    ds_read_b128 a[144:147], v14 offset:0
    ds_read_b128 a[148:151], v15 offset:0
    ds_read_b128 a[152:155], v16 offset:0
    ds_read_b128 a[156:159], v17 offset:0
    s_waitcnt lgkmcnt(0)
    s_waitcnt vmcnt(15)
    s_add_u32 m0, s4, 24576
    s_nop 0
    buffer_load_dwordx4 v2, s[8:11], s56 offen nt lds
    s_waitcnt vmcnt(15)
    buffer_load_dwordx4 v3, s[8:11], s56 offen offset:1024 nt lds
    s_waitcnt vmcnt(15)
    buffer_load_dwordx4 v4, s[8:11], s56 offen offset:2048 nt lds
    s_waitcnt vmcnt(15)
    buffer_load_dwordx4 v5, s[8:11], s56 offen offset:3072 nt lds
    s_waitcnt vmcnt(15)
    s_add_u32 s57, s56, 16384
    s_add_u32 m0, s4, 28672
    s_nop 0
    buffer_load_dwordx4 v2, s[8:11], s57 offen nt lds
    s_waitcnt vmcnt(15)
    buffer_load_dwordx4 v3, s[8:11], s57 offen offset:1024 nt lds
    s_waitcnt vmcnt(15)
    buffer_load_dwordx4 v4, s[8:11], s57 offen offset:2048 nt lds
    s_waitcnt vmcnt(15)
    buffer_load_dwordx4 v5, s[8:11], s57 offen offset:3072 nt lds
    s_add_u32 s56, s56, 32768
    ds_read_b128 a[160:163], v10 offset:8192
    ds_read_b128 a[164:167], v11 offset:8192
    ds_read_b128 a[168:171], v12 offset:8192
    ds_read_b128 a[172:175], v13 offset:8192
    ds_read_b128 a[176:179], v14 offset:8192
    ds_read_b128 a[180:183], v15 offset:8192
    ds_read_b128 a[184:187], v16 offset:8192
    ds_read_b128 a[188:191], v17 offset:8192
    s_waitcnt lgkmcnt(0)
    s_waitcnt vmcnt(15)
    v_lshrrev_b32 v7, 4, v1
    v_and_b32 v8, 15, v1
    v_lshlrev_b32 v9, 2, v7
    v_xor_b32 v8, v8, v9
    v_lshlrev_b32 v8, 4, v8
    v_lshl_add_u32 v6, v7, 8, v8
    v_add_u32 v7, 3072, v6
    v_add_u32 v8, 6144, v6
    v_add_u32 v9, 9216, v6
    s_mov_b32 s12, s30
    s_mov_b32 s13, s31
    s_mov_b32 s14, 67108864
    s_mov_b32 s15, 0x20000
    s_lshl_b32 s63, s55, 18
    s_lshl_b32 s7, s3, 10
    s_add_u32 s63, s63, s7
    s_mov_b32 s60, s63
    s_add_u32 m0, s4, 0
    s_nop 0
    buffer_load_dwordx4 v6, s[12:15], s60 offen nt lds
    s_waitcnt vmcnt(15)
    buffer_load_dwordx4 v7, s[12:15], s60 offen offset:1024 nt lds
    s_waitcnt vmcnt(15)
    buffer_load_dwordx4 v8, s[12:15], s60 offen offset:2048 nt lds
    s_waitcnt vmcnt(15)
    buffer_load_dwordx4 v9, s[12:15], s60 offen offset:3072 nt lds
    s_waitcnt vmcnt(15)
    s_add_u32 s61, s60, 16384
    s_add_u32 m0, s4, 4096
    s_nop 0
    buffer_load_dwordx4 v6, s[12:15], s61 offen nt lds
    s_waitcnt vmcnt(15)
    buffer_load_dwordx4 v7, s[12:15], s61 offen offset:1024 nt lds
    s_waitcnt vmcnt(15)
    buffer_load_dwordx4 v8, s[12:15], s61 offen offset:2048 nt lds
    s_waitcnt vmcnt(15)
    buffer_load_dwordx4 v9, s[12:15], s61 offen offset:3072 nt lds
    s_add_u32 s60, s60, 32768
    ds_read_b128 a[192:195], v10 offset:16384
    ds_read_b128 a[196:199], v11 offset:16384
    ds_read_b128 a[200:203], v12 offset:16384
    ds_read_b128 a[204:207], v13 offset:16384
    ds_read_b128 a[208:211], v14 offset:16384
    ds_read_b128 a[212:215], v15 offset:16384
    ds_read_b128 a[216:219], v16 offset:16384
    ds_read_b128 a[220:223], v17 offset:16384
    s_waitcnt lgkmcnt(0)
    s_waitcnt vmcnt(15)
    s_add_u32 m0, s4, 8192
    s_nop 0
    buffer_load_dwordx4 v6, s[12:15], s60 offen nt lds
    s_waitcnt vmcnt(15)
    buffer_load_dwordx4 v7, s[12:15], s60 offen offset:1024 nt lds
    s_waitcnt vmcnt(15)
    buffer_load_dwordx4 v8, s[12:15], s60 offen offset:2048 nt lds
    s_waitcnt vmcnt(15)
    buffer_load_dwordx4 v9, s[12:15], s60 offen offset:3072 nt lds
    s_waitcnt vmcnt(15)
    s_add_u32 s61, s60, 16384
    s_add_u32 m0, s4, 12288
    s_nop 0
    buffer_load_dwordx4 v6, s[12:15], s61 offen nt lds
    s_waitcnt vmcnt(15)
    buffer_load_dwordx4 v7, s[12:15], s61 offen offset:1024 nt lds
    s_waitcnt vmcnt(15)
    buffer_load_dwordx4 v8, s[12:15], s61 offen offset:2048 nt lds
    s_waitcnt vmcnt(15)
    buffer_load_dwordx4 v9, s[12:15], s61 offen offset:3072 nt lds
    s_add_u32 s60, s60, 32768
    ds_read_b128 a[224:227], v10 offset:24576
    ds_read_b128 a[228:231], v11 offset:24576
    ds_read_b128 a[232:235], v12 offset:24576
    ds_read_b128 a[236:239], v13 offset:24576
    ds_read_b128 a[240:243], v14 offset:24576
    ds_read_b128 a[244:247], v15 offset:24576
    ds_read_b128 a[248:251], v16 offset:24576
    ds_read_b128 a[252:255], v17 offset:24576
    s_waitcnt lgkmcnt(0)
    v_and_b32 v35, 7, v1
    v_lshlrev_b32 v35, 5, v35
    global_load_dword v34, v35, s[38:39] sc1
    s_waitcnt vmcnt(15)
    s_add_u32 m0, s4, 16384
    s_nop 0
    buffer_load_dwordx4 v6, s[12:15], s60 offen nt lds
    s_waitcnt vmcnt(15)
    buffer_load_dwordx4 v7, s[12:15], s60 offen offset:1024 nt lds
    s_waitcnt vmcnt(15)
    buffer_load_dwordx4 v8, s[12:15], s60 offen offset:2048 nt lds
    s_waitcnt vmcnt(15)
    buffer_load_dwordx4 v9, s[12:15], s60 offen offset:3072 nt lds
    s_waitcnt vmcnt(15)
    s_add_u32 s61, s60, 16384
    s_add_u32 m0, s4, 20480
    s_nop 0
    buffer_load_dwordx4 v6, s[12:15], s61 offen nt lds
    s_waitcnt vmcnt(15)
    buffer_load_dwordx4 v7, s[12:15], s61 offen offset:1024 nt lds
    s_waitcnt vmcnt(15)
    buffer_load_dwordx4 v8, s[12:15], s61 offen offset:2048 nt lds
    ds_read_b64_tr_b16 v[128:129], v18 offset:0
    ds_read_b64_tr_b16 v[130:131], v18 offset:2048
    ds_read_b64_tr_b16 v[132:133], v18 offset:4096
    ds_read_b64_tr_b16 v[134:135], v18 offset:6144
    ds_read_b64_tr_b16 v[136:137], v19 offset:0
    ds_read_b64_tr_b16 v[138:139], v19 offset:2048
    ds_read_b64_tr_b16 v[140:141], v19 offset:4096
    ds_read_b64_tr_b16 v[142:143], v19 offset:6144
    ds_read_b64_tr_b16 v[144:145], v20 offset:0
    ds_read_b64_tr_b16 v[146:147], v20 offset:2048
    ds_read_b64_tr_b16 v[148:149], v20 offset:4096
    ds_read_b64_tr_b16 v[150:151], v20 offset:6144
    ds_read_b64_tr_b16 v[152:153], v21 offset:0
    ds_read_b64_tr_b16 v[154:155], v21 offset:2048
    ds_read_b64_tr_b16 v[156:157], v21 offset:4096
    ds_read_b64_tr_b16 v[158:159], v21 offset:6144
    s_waitcnt lgkmcnt(0)
    s_waitcnt vmcnt(7)
    s_mov_b32 s68, 262144
L_g2clr:
    v_cmp_gt_u32 vcc, 32, v34
    s_cbranch_vccz L_g2clr_x
    global_load_dword v34, v35, s[38:39] sc1
    s_sub_u32 s68, s68, 1
    s_waitcnt vmcnt(0)
    s_cbranch_scc0 L_g2clr
L_g2clr_x:
    ds_read_b64_tr_b16 v[160:161], v18 offset:8192
    ds_read_b64_tr_b16 v[162:163], v18 offset:10240
    ds_read_b64_tr_b16 v[164:165], v18 offset:12288
    ds_read_b64_tr_b16 v[166:167], v18 offset:14336
    ds_read_b64_tr_b16 v[168:169], v19 offset:8192
    ds_read_b64_tr_b16 v[170:171], v19 offset:10240
    ds_read_b64_tr_b16 v[172:173], v19 offset:12288
    ds_read_b64_tr_b16 v[174:175], v19 offset:14336
    ds_read_b64_tr_b16 v[176:177], v20 offset:8192
    ds_read_b64_tr_b16 v[178:179], v20 offset:10240
    ds_read_b64_tr_b16 v[180:181], v20 offset:12288
    ds_read_b64_tr_b16 v[182:183], v20 offset:14336
    ds_read_b64_tr_b16 v[184:185], v21 offset:8192
    ds_read_b64_tr_b16 v[186:187], v21 offset:10240
    ds_read_b64_tr_b16 v[188:189], v21 offset:12288
    ds_read_b64_tr_b16 v[190:191], v21 offset:14336
    s_waitcnt lgkmcnt(0)
    v_and_b32 v35, 0, v1
    v_lshlrev_b32 v35, 2, v35
    v_mov_b32 v34, 1
    s_mov_b64 exec, 1
    v_mov_b32 v34, 0
    buffer_atomic_or v34, v35, s[44:47], s66 offen sc0 sc1
    s_mov_b64 exec, -1
    buffer_load_dwordx4 v9, s[12:15], s61 offen offset:3072 nt lds
    s_add_u32 s60, s60, 32768
    s_add_u32 m0, s4, 24576
    s_nop 0
    buffer_load_dwordx4 v6, s[12:15], s60 offen nt lds
    buffer_load_dwordx4 v7, s[12:15], s60 offen offset:1024 nt lds
    buffer_load_dwordx4 v8, s[12:15], s60 offen offset:2048 nt lds
    buffer_load_dwordx4 v9, s[12:15], s60 offen offset:3072 nt lds
    s_add_u32 s61, s60, 16384
    s_add_u32 m0, s4, 28672
    s_nop 0
    buffer_load_dwordx4 v6, s[12:15], s61 offen nt lds
    buffer_load_dwordx4 v7, s[12:15], s61 offen offset:1024 nt lds
    buffer_load_dwordx4 v8, s[12:15], s61 offen offset:2048 nt lds
    s_waitcnt vmcnt(15)
    buffer_load_dwordx4 v9, s[12:15], s61 offen offset:3072 nt lds
    s_add_u32 s60, s60, 32768
    s_waitcnt vmcnt(15)
    s_add_u32 m0, s4, 0
    s_nop 0
    buffer_load_dwordx4 v6, s[12:15], s60 offen nt lds
    s_waitcnt vmcnt(15)
    buffer_load_dwordx4 v7, s[12:15], s60 offen offset:1024 nt lds
    s_waitcnt vmcnt(15)
    buffer_load_dwordx4 v8, s[12:15], s60 offen offset:2048 nt lds
    s_waitcnt vmcnt(15)
    buffer_load_dwordx4 v9, s[12:15], s60 offen offset:3072 nt lds
    s_waitcnt vmcnt(15)
    s_add_u32 s61, s60, 16384
    s_add_u32 m0, s4, 4096
    s_nop 0
    buffer_load_dwordx4 v6, s[12:15], s61 offen nt lds
    s_waitcnt vmcnt(15)
    buffer_load_dwordx4 v7, s[12:15], s61 offen offset:1024 nt lds
    s_waitcnt vmcnt(15)
    buffer_load_dwordx4 v8, s[12:15], s61 offen offset:2048 nt lds
    s_waitcnt vmcnt(15)
    buffer_load_dwordx4 v9, s[12:15], s61 offen offset:3072 nt lds
    s_add_u32 s60, s60, 32768
    ds_read_b64_tr_b16 v[192:193], v18 offset:16384
    ds_read_b64_tr_b16 v[194:195], v18 offset:18432
    ds_read_b64_tr_b16 v[196:197], v18 offset:20480
    ds_read_b64_tr_b16 v[198:199], v18 offset:22528
    ds_read_b64_tr_b16 v[200:201], v19 offset:16384
    ds_read_b64_tr_b16 v[202:203], v19 offset:18432
    ds_read_b64_tr_b16 v[204:205], v19 offset:20480
    ds_read_b64_tr_b16 v[206:207], v19 offset:22528
    ds_read_b64_tr_b16 v[208:209], v20 offset:16384
    ds_read_b64_tr_b16 v[210:211], v20 offset:18432
    ds_read_b64_tr_b16 v[212:213], v20 offset:20480
    ds_read_b64_tr_b16 v[214:215], v20 offset:22528
    ds_read_b64_tr_b16 v[216:217], v21 offset:16384
    ds_read_b64_tr_b16 v[218:219], v21 offset:18432
    ds_read_b64_tr_b16 v[220:221], v21 offset:20480
    ds_read_b64_tr_b16 v[222:223], v21 offset:22528
    s_waitcnt lgkmcnt(0)
    s_mov_b32 s68, 262144
L_g2q:
    v_cmp_ne_u32 vcc, 1, v34
    s_cbranch_vccz L_g2q_x
    v_mov_b32 v34, 1
    s_mov_b64 exec, 1
    v_mov_b32 v34, 0
    buffer_atomic_or v34, v35, s[44:47], s66 offen sc0 sc1
    s_mov_b64 exec, -1
    s_sub_u32 s68, s68, 1
    s_waitcnt vmcnt(0)
    s_cbranch_scc0 L_g2q
L_g2q_x:
    s_lshl_b32 s5, s3, 13
    s_add_u32 m0, s5, 136192
    s_lshl_b32 s5, s3, 11
    s_add_u32 s5, s5, s64
    buffer_load_dwordx4 v30, s[44:47], s5 offen offset:0 sc1 lds
    buffer_load_dwordx4 v30, s[44:47], s5 offen offset:1024 sc1 lds
    s_waitcnt vmcnt(15)
    s_add_u32 m0, s4, 8192
    s_nop 0
    buffer_load_dwordx4 v6, s[12:15], s60 offen nt lds
    s_waitcnt vmcnt(15)
    buffer_load_dwordx4 v7, s[12:15], s60 offen offset:1024 nt lds
    s_waitcnt vmcnt(15)
    buffer_load_dwordx4 v8, s[12:15], s60 offen offset:2048 nt lds
    s_waitcnt vmcnt(15)
    buffer_load_dwordx4 v9, s[12:15], s60 offen offset:3072 nt lds
    s_waitcnt vmcnt(15)
    s_add_u32 s61, s60, 16384
    s_add_u32 m0, s4, 12288
    s_nop 0
    buffer_load_dwordx4 v6, s[12:15], s61 offen nt lds
    s_waitcnt vmcnt(15)
    buffer_load_dwordx4 v7, s[12:15], s61 offen offset:1024 nt lds
    ds_read_b64_tr_b16 v[224:225], v18 offset:24576
    ds_read_b64_tr_b16 v[226:227], v18 offset:26624
    ds_read_b64_tr_b16 v[228:229], v18 offset:28672
    ds_read_b64_tr_b16 v[230:231], v18 offset:30720
    ds_read_b64_tr_b16 v[232:233], v19 offset:24576
    ds_read_b64_tr_b16 v[234:235], v19 offset:26624
    ds_read_b64_tr_b16 v[236:237], v19 offset:28672
    ds_read_b64_tr_b16 v[238:239], v19 offset:30720
    ds_read_b64_tr_b16 v[240:241], v20 offset:24576
    ds_read_b64_tr_b16 v[242:243], v20 offset:26624
    ds_read_b64_tr_b16 v[244:245], v20 offset:28672
    ds_read_b64_tr_b16 v[246:247], v20 offset:30720
    ds_read_b64_tr_b16 v[248:249], v21 offset:24576
    ds_read_b64_tr_b16 v[250:251], v21 offset:26624
    ds_read_b64_tr_b16 v[252:253], v21 offset:28672
    ds_read_b64_tr_b16 v[254:255], v21 offset:30720
    s_waitcnt lgkmcnt(0)
    s_waitcnt vmcnt(6)
    s_barrier
    v_add_u32 v35, 131072, v30
    ds_read_b128 v[40:43], v35 offset:5120
    ds_read_b128 v[44:47], v35 offset:6144
    ds_read_b128 v[48:51], v35 offset:13312
    ds_read_b128 v[52:55], v35 offset:14336
    ds_read_b128 v[56:59], v35 offset:21504
    ds_read_b128 v[60:63], v35 offset:22528
    ds_read_b128 v[64:67], v35 offset:29696
    ds_read_b128 v[68:71], v35 offset:30720
    s_waitcnt lgkmcnt(0)
    v_mfma_f32_32x32x16_bf16 v[112:127], a[0:3], v[40:43], 0
    buffer_load_dwordx4 v8, s[12:15], s61 offen offset:2048 nt lds
    v_mfma_f32_32x32x16_bf16 v[112:127], a[4:7], v[44:47], v[112:127]
    buffer_load_dwordx4 v9, s[12:15], s61 offen offset:3072 nt lds
    s_add_u32 s60, s60, 32768
    v_mfma_f32_32x32x16_bf16 v[112:127], a[8:11], v[48:51], v[112:127]
    v_mfma_f32_32x32x16_bf16 v[112:127], a[12:15], v[52:55], v[112:127]
    v_mfma_f32_32x32x16_bf16 v[112:127], a[16:19], v[56:59], v[112:127]
    v_mfma_f32_32x32x16_bf16 v[112:127], a[20:23], v[60:63], v[112:127]
    v_mfma_f32_32x32x16_bf16 v[112:127], a[24:27], v[64:67], v[112:127]
    v_mfma_f32_32x32x16_bf16 v[112:127], a[28:31], v[68:71], v[112:127]
    v_mfma_f32_32x32x16_bf16 a[0:15], a[32:35], v[40:43], 0
    s_add_u32 m0, s4, 16384
    s_nop 0
    buffer_load_dwordx4 v6, s[12:15], s60 offen nt lds
    v_mfma_f32_32x32x16_bf16 a[0:15], a[36:39], v[44:47], a[0:15]
    buffer_load_dwordx4 v7, s[12:15], s60 offen offset:1024 nt lds
    v_mfma_f32_32x32x16_bf16 a[0:15], a[40:43], v[48:51], a[0:15]
    s_nop 4
    v_max3_f32 v32, v112, v113, v114
    v_max3_f32 v32, v32, v115, v116
    v_max3_f32 v32, v32, v117, v118
    v_max3_f32 v32, v32, v119, v120
    v_mfma_f32_32x32x16_bf16 a[0:15], a[44:47], v[52:55], a[0:15]
    v_max3_f32 v32, v32, v121, v122
    v_max3_f32 v32, v32, v123, v124
    v_max3_f32 v32, v32, v125, v126
    v_max_f32 v32, v32, v127
    v_mfma_f32_32x32x16_bf16 a[0:15], a[48:51], v[56:59], a[0:15]
    v_mfma_f32_32x32x16_bf16 a[0:15], a[52:55], v[60:63], a[0:15]
    v_mfma_f32_32x32x16_bf16 a[0:15], a[56:59], v[64:67], a[0:15]
    v_mfma_f32_32x32x16_bf16 a[0:15], a[60:63], v[68:71], a[0:15]
    v_mfma_f32_32x32x16_bf16 a[32:47], a[64:67], v[40:43], 0
    buffer_load_dwordx4 v8, s[12:15], s60 offen offset:2048 nt lds
    v_mfma_f32_32x32x16_bf16 a[32:47], a[68:71], v[44:47], a[32:47]
    buffer_load_dwordx4 v9, s[12:15], s60 offen offset:3072 nt lds
    v_mfma_f32_32x32x16_bf16 a[32:47], a[72:75], v[48:51], a[32:47]
    s_nop 6
    v_accvgpr_read_b32 v72, a0
    v_accvgpr_read_b32 v73, a1
    v_accvgpr_read_b32 v74, a2
    v_accvgpr_read_b32 v75, a3
    v_mfma_f32_32x32x16_bf16 a[32:47], a[76:79], v[52:55], a[32:47]
    v_accvgpr_read_b32 v76, a4
    v_accvgpr_read_b32 v77, a5
    v_accvgpr_read_b32 v78, a6
    v_accvgpr_read_b32 v79, a7
    v_mfma_f32_32x32x16_bf16 a[32:47], a[80:83], v[56:59], a[32:47]
    v_accvgpr_read_b32 v80, a8
    v_accvgpr_read_b32 v81, a9
    v_accvgpr_read_b32 v82, a10
    v_accvgpr_read_b32 v83, a11
    v_mfma_f32_32x32x16_bf16 a[32:47], a[84:87], v[60:63], a[32:47]
    v_accvgpr_read_b32 v84, a12
    v_accvgpr_read_b32 v85, a13
    v_accvgpr_read_b32 v86, a14
    v_accvgpr_read_b32 v87, a15
    v_mfma_f32_32x32x16_bf16 a[32:47], a[88:91], v[64:67], a[32:47]
    v_max3_f32 v32, v32, v72, v73
    v_max3_f32 v32, v32, v74, v75
    v_max3_f32 v32, v32, v76, v77
    v_max3_f32 v32, v32, v78, v79
    v_mfma_f32_32x32x16_bf16 a[32:47], a[92:95], v[68:71], a[32:47]
    v_max3_f32 v32, v32, v80, v81
    v_max3_f32 v32, v32, v82, v83
    v_max3_f32 v32, v32, v84, v85
    v_max3_f32 v32, v32, v86, v87
    v_mfma_f32_32x32x16_bf16 a[64:79], a[96:99], v[40:43], 0
    s_add_u32 s61, s60, 16384
    s_add_u32 m0, s4, 20480
    s_nop 0
    buffer_load_dwordx4 v6, s[12:15], s61 offen nt lds
    v_mfma_f32_32x32x16_bf16 a[64:79], a[100:103], v[44:47], a[64:79]
    buffer_load_dwordx4 v7, s[12:15], s61 offen offset:1024 nt lds
    v_mfma_f32_32x32x16_bf16 a[64:79], a[104:107], v[48:51], a[64:79]
    v_accvgpr_read_b32 v72, a32
    v_accvgpr_read_b32 v73, a33
    v_accvgpr_read_b32 v74, a34
    v_accvgpr_read_b32 v75, a35
    v_mfma_f32_32x32x16_bf16 a[64:79], a[108:111], v[52:55], a[64:79]
    v_accvgpr_read_b32 v76, a36
    v_accvgpr_read_b32 v77, a37
    v_accvgpr_read_b32 v78, a38
    v_accvgpr_read_b32 v79, a39
    v_mfma_f32_32x32x16_bf16 a[64:79], a[112:115], v[56:59], a[64:79]
    v_accvgpr_read_b32 v80, a40
    v_accvgpr_read_b32 v81, a41
    v_accvgpr_read_b32 v82, a42
    v_accvgpr_read_b32 v83, a43
    v_mfma_f32_32x32x16_bf16 a[64:79], a[116:119], v[60:63], a[64:79]
    v_accvgpr_read_b32 v84, a44
    v_accvgpr_read_b32 v85, a45
    v_accvgpr_read_b32 v86, a46
    v_accvgpr_read_b32 v87, a47
    v_mfma_f32_32x32x16_bf16 a[64:79], a[120:123], v[64:67], a[64:79]
    v_max3_f32 v32, v32, v72, v73
    v_max3_f32 v32, v32, v74, v75
    v_max3_f32 v32, v32, v76, v77
    v_max3_f32 v32, v32, v78, v79
    v_mfma_f32_32x32x16_bf16 a[64:79], a[124:127], v[68:71], a[64:79]
    v_max3_f32 v32, v32, v80, v81
    v_max3_f32 v32, v32, v82, v83
    v_max3_f32 v32, v32, v84, v85
    v_max3_f32 v32, v32, v86, v87
    v_mfma_f32_32x32x16_bf16 a[96:111], a[128:131], v[40:43], 0
    buffer_load_dwordx4 v8, s[12:15], s61 offen offset:2048 nt lds
    v_mfma_f32_32x32x16_bf16 a[96:111], a[132:135], v[44:47], a[96:111]
    buffer_load_dwordx4 v9, s[12:15], s61 offen offset:3072 nt lds
    s_add_u32 s60, s60, 32768
    v_mfma_f32_32x32x16_bf16 a[96:111], a[136:139], v[48:51], a[96:111]
    s_nop 1
    v_accvgpr_read_b32 v72, a64
    v_accvgpr_read_b32 v73, a65
    v_accvgpr_read_b32 v74, a66
    v_accvgpr_read_b32 v75, a67
    v_mfma_f32_32x32x16_bf16 a[96:111], a[140:143], v[52:55], a[96:111]
    v_accvgpr_read_b32 v76, a68
    v_accvgpr_read_b32 v77, a69
    v_accvgpr_read_b32 v78, a70
    v_accvgpr_read_b32 v79, a71
    v_mfma_f32_32x32x16_bf16 a[96:111], a[144:147], v[56:59], a[96:111]
    v_accvgpr_read_b32 v80, a72
    v_accvgpr_read_b32 v81, a73
    v_accvgpr_read_b32 v82, a74
    v_accvgpr_read_b32 v83, a75
    v_mfma_f32_32x32x16_bf16 a[96:111], a[148:151], v[60:63], a[96:111]
    v_accvgpr_read_b32 v84, a76
    v_accvgpr_read_b32 v85, a77
    v_accvgpr_read_b32 v86, a78
    v_accvgpr_read_b32 v87, a79
    v_mfma_f32_32x32x16_bf16 a[96:111], a[152:155], v[64:67], a[96:111]
    v_max3_f32 v32, v32, v72, v73
    v_max3_f32 v32, v32, v74, v75
    v_max3_f32 v32, v32, v76, v77
    v_max3_f32 v32, v32, v78, v79
    v_mfma_f32_32x32x16_bf16 a[96:111], a[156:159], v[68:71], a[96:111]
    v_max3_f32 v32, v32, v80, v81
    v_max3_f32 v32, v32, v82, v83
    v_max3_f32 v32, v32, v84, v85
    v_max3_f32 v32, v32, v86, v87
    v_mfma_f32_32x32x16_bf16 a[128:143], a[160:163], v[40:43], 0
    s_waitcnt vmcnt(15)
    s_add_u32 m0, s4, 24576
    s_nop 0
    buffer_load_dwordx4 v6, s[12:15], s60 offen nt lds
    v_mfma_f32_32x32x16_bf16 a[128:143], a[164:167], v[44:47], a[128:143]
    s_waitcnt vmcnt(15)
    buffer_load_dwordx4 v7, s[12:15], s60 offen offset:1024 nt lds
    v_mfma_f32_32x32x16_bf16 a[128:143], a[168:171], v[48:51], a[128:143]
    v_accvgpr_read_b32 v72, a96
    v_accvgpr_read_b32 v73, a97
    v_accvgpr_read_b32 v74, a98
    v_accvgpr_read_b32 v75, a99
    v_mfma_f32_32x32x16_bf16 a[128:143], a[172:175], v[52:55], a[128:143]
    v_accvgpr_read_b32 v76, a100
    v_accvgpr_read_b32 v77, a101
    v_accvgpr_read_b32 v78, a102
    v_accvgpr_read_b32 v79, a103
    v_mfma_f32_32x32x16_bf16 a[128:143], a[176:179], v[56:59], a[128:143]
    v_accvgpr_read_b32 v80, a104
    v_accvgpr_read_b32 v81, a105
    v_accvgpr_read_b32 v82, a106
    v_accvgpr_read_b32 v83, a107
    v_mfma_f32_32x32x16_bf16 a[128:143], a[180:183], v[60:63], a[128:143]
    v_accvgpr_read_b32 v84, a108
    v_accvgpr_read_b32 v85, a109
    v_accvgpr_read_b32 v86, a110
    v_accvgpr_read_b32 v87, a111
    v_mfma_f32_32x32x16_bf16 a[128:143], a[184:187], v[64:67], a[128:143]
    v_max3_f32 v32, v32, v72, v73
    v_max3_f32 v32, v32, v74, v75
    v_max3_f32 v32, v32, v76, v77
    v_max3_f32 v32, v32, v78, v79
    v_mfma_f32_32x32x16_bf16 a[128:143], a[188:191], v[68:71], a[128:143]
    v_max3_f32 v32, v32, v80, v81
    v_max3_f32 v32, v32, v82, v83
    v_max3_f32 v32, v32, v84, v85
    v_max3_f32 v32, v32, v86, v87
    v_mfma_f32_32x32x16_bf16 a[160:175], a[192:195], v[40:43], 0
    s_waitcnt vmcnt(15)
    buffer_load_dwordx4 v8, s[12:15], s60 offen offset:2048 nt lds
    v_mfma_f32_32x32x16_bf16 a[160:175], a[196:199], v[44:47], a[160:175]
    s_waitcnt vmcnt(15)
    buffer_load_dwordx4 v9, s[12:15], s60 offen offset:3072 nt lds
    v_mfma_f32_32x32x16_bf16 a[160:175], a[200:203], v[48:51], a[160:175]
    s_nop 0
    v_accvgpr_read_b32 v72, a128
    v_accvgpr_read_b32 v73, a129
    v_accvgpr_read_b32 v74, a130
    v_accvgpr_read_b32 v75, a131
    v_mfma_f32_32x32x16_bf16 a[160:175], a[204:207], v[52:55], a[160:175]
    v_accvgpr_read_b32 v76, a132
    v_accvgpr_read_b32 v77, a133
    v_accvgpr_read_b32 v78, a134
    v_accvgpr_read_b32 v79, a135
    v_mfma_f32_32x32x16_bf16 a[160:175], a[208:211], v[56:59], a[160:175]
    v_accvgpr_read_b32 v80, a136
    v_accvgpr_read_b32 v81, a137
    v_accvgpr_read_b32 v82, a138
    v_accvgpr_read_b32 v83, a139
    v_mfma_f32_32x32x16_bf16 a[160:175], a[212:215], v[60:63], a[160:175]
    v_accvgpr_read_b32 v84, a140
    v_accvgpr_read_b32 v85, a141
    v_accvgpr_read_b32 v86, a142
    v_accvgpr_read_b32 v87, a143
    v_mfma_f32_32x32x16_bf16 a[160:175], a[216:219], v[64:67], a[160:175]
    v_max3_f32 v32, v32, v72, v73
    v_max3_f32 v32, v32, v74, v75
    v_max3_f32 v32, v32, v76, v77
    v_max3_f32 v32, v32, v78, v79
    v_mfma_f32_32x32x16_bf16 a[160:175], a[220:223], v[68:71], a[160:175]
    v_max3_f32 v32, v32, v80, v81
    v_max3_f32 v32, v32, v82, v83
    v_max3_f32 v32, v32, v84, v85
    v_max3_f32 v32, v32, v86, v87
    v_mfma_f32_32x32x16_bf16 a[192:207], a[224:227], v[40:43], 0
    s_waitcnt vmcnt(15)
    s_add_u32 s61, s60, 16384
    s_add_u32 m0, s4, 28672
    s_nop 0
    buffer_load_dwordx4 v6, s[12:15], s61 offen nt lds
    v_mfma_f32_32x32x16_bf16 a[192:207], a[228:231], v[44:47], a[192:207]
    s_waitcnt vmcnt(15)
    buffer_load_dwordx4 v7, s[12:15], s61 offen offset:1024 nt lds
    v_mfma_f32_32x32x16_bf16 a[192:207], a[232:235], v[48:51], a[192:207]
    v_accvgpr_read_b32 v72, a160
    v_accvgpr_read_b32 v73, a161
    v_accvgpr_read_b32 v74, a162
    v_accvgpr_read_b32 v75, a163
    v_mfma_f32_32x32x16_bf16 a[192:207], a[236:239], v[52:55], a[192:207]
    v_accvgpr_read_b32 v76, a164
    v_accvgpr_read_b32 v77, a165
    v_accvgpr_read_b32 v78, a166
    v_accvgpr_read_b32 v79, a167
    v_mfma_f32_32x32x16_bf16 a[192:207], a[240:243], v[56:59], a[192:207]
    v_accvgpr_read_b32 v80, a168
    v_accvgpr_read_b32 v81, a169
    v_accvgpr_read_b32 v82, a170
    v_accvgpr_read_b32 v83, a171
    v_mfma_f32_32x32x16_bf16 a[192:207], a[244:247], v[60:63], a[192:207]
    v_accvgpr_read_b32 v84, a172
    v_accvgpr_read_b32 v85, a173
    v_accvgpr_read_b32 v86, a174
    v_accvgpr_read_b32 v87, a175
    v_mfma_f32_32x32x16_bf16 a[192:207], a[248:251], v[64:67], a[192:207]
    v_max3_f32 v32, v32, v72, v73
    v_max3_f32 v32, v32, v74, v75
    v_max3_f32 v32, v32, v76, v77
    v_max3_f32 v32, v32, v78, v79
    v_mfma_f32_32x32x16_bf16 a[192:207], a[252:255], v[68:71], a[192:207]
    v_max3_f32 v32, v32, v80, v81
    v_max3_f32 v32, v32, v82, v83
    v_max3_f32 v32, v32, v84, v85
    v_max3_f32 v32, v32, v86, v87
    s_nop 7
    v_accvgpr_read_b32 v72, a192
    v_accvgpr_read_b32 v73, a193
    v_accvgpr_read_b32 v74, a194
    v_accvgpr_read_b32 v75, a195
    v_accvgpr_read_b32 v76, a196
    v_accvgpr_read_b32 v77, a197
    v_accvgpr_read_b32 v78, a198
    v_accvgpr_read_b32 v79, a199
    v_accvgpr_read_b32 v80, a200
    v_accvgpr_read_b32 v81, a201
    v_accvgpr_read_b32 v82, a202
    v_accvgpr_read_b32 v83, a203
    v_accvgpr_read_b32 v84, a204
    v_accvgpr_read_b32 v85, a205
    v_accvgpr_read_b32 v86, a206
    v_accvgpr_read_b32 v87, a207
    v_max3_f32 v32, v32, v72, v73
    v_max3_f32 v32, v32, v74, v75
    v_max3_f32 v32, v32, v76, v77
    v_max3_f32 v32, v32, v78, v79
    v_max3_f32 v32, v32, v80, v81
    v_max3_f32 v32, v32, v82, v83
    v_max3_f32 v32, v32, v84, v85
    v_max3_f32 v32, v32, v86, v87
    v_mov_b32 v33, v32
    s_nop 1
    v_permlane32_swap_b32 v32, v33
    v_max_f32 v32, v32, v33
    v_mul_f32 v32, -0.5, v32
    v_cvt_pk_bf16_f32 v33, v32, v32
    v_lshlrev_b32 v33, 16, v33
    v_sub_f32 v32, v32, v33
    v_cvt_pk_bf16_f32 v40, v33, v32
    v_and_b32 v32, 0xffff0000, v40
    v_add_f32 v32, v32, v33
    v_mul_f32 v32, -2.0, v32
    v_mov_b32 v41, 0
    v_mov_b32 v42, 0
    v_mov_b32 v43, 0
    v_mov_b32 v36, 0x3f803f80
    v_mov_b32 v37, 0x3f803f80
    v_mov_b32 v38, 0x3f803f80
    v_mov_b32 v39, 0x3f803f80
    v_lshrrev_b32 v26, 4, v1
    v_xor_b32 v26, v26, v1
    v_and_b32 v26, 1, v26
    v_add_u32 v26, -1, v26
    v_and_b32 v26, 0x3f803f80, v26
    v_mov_b32 v27, v26
    v_mov_b32 v28, v26
    v_mov_b32 v29, v26
    v_mfma_f32_32x32x16_bf16 v[112:127], v[36:39], v[40:43], v[112:127]
    v_mfma_f32_32x32x16_bf16 a[0:15], v[36:39], v[40:43], a[0:15]
    s_nop 10
    v_exp_f32 v112, v112
    v_exp_f32 v113, v113
    v_exp_f32 v114, v114
    v_exp_f32 v115, v115
    v_exp_f32 v116, v116
    v_exp_f32 v117, v117
    v_exp_f32 v118, v118
    v_exp_f32 v119, v119
    v_exp_f32 v120, v120
    v_exp_f32 v121, v121
    v_exp_f32 v122, v122
    v_exp_f32 v123, v123
    v_exp_f32 v124, v124
    v_exp_f32 v125, v125
    v_exp_f32 v126, v126
    v_exp_f32 v127, v127
    v_cvt_pk_bf16_f32 v104, v112, v113
    v_cvt_pk_bf16_f32 v105, v114, v115
    v_cvt_pk_bf16_f32 v106, v116, v117
    v_cvt_pk_bf16_f32 v107, v118, v119
    v_cvt_pk_bf16_f32 v108, v120, v121
    v_cvt_pk_bf16_f32 v109, v122, v123
    v_cvt_pk_bf16_f32 v110, v124, v125
    v_cvt_pk_bf16_f32 v111, v126, v127
    v_mfma_f32_32x32x16_bf16 a[32:47], v[36:39], v[40:43], a[32:47]
    v_mfma_f32_16x16x32_bf16 a[176:179], v[26:29], v[104:107], 0
    v_accvgpr_read_b32 v112, a0
    v_accvgpr_read_b32 v113, a1
    v_mfma_f32_16x16x32_bf16 a[176:179], v[26:29], v[108:111], a[176:179]
    v_accvgpr_read_b32 v114, a2
    v_accvgpr_read_b32 v115, a3
    v_mfma_f32_32x32x16_bf16 a[16:31], v[128:131], v[104:107], 0
    s_waitcnt vmcnt(15)
    buffer_load_dwordx4 v8, s[12:15], s61 offen offset:2048 nt lds
    v_accvgpr_read_b32 v116, a4
    v_accvgpr_read_b32 v117, a5
    v_accvgpr_read_b32 v118, a6
    v_accvgpr_read_b32 v119, a7
    v_mfma_f32_32x32x16_bf16 a[16:31], v[132:135], v[108:111], a[16:31]
    s_waitcnt vmcnt(15)
    buffer_load_dwordx4 v9, s[12:15], s61 offen offset:3072 nt lds
    s_add_u32 s60, s60, 32768
    v_accvgpr_read_b32 v120, a8
    v_accvgpr_read_b32 v121, a9
    v_accvgpr_read_b32 v122, a10
    v_accvgpr_read_b32 v123, a11
    v_mfma_f32_32x32x16_bf16 a[48:63], v[136:139], v[104:107], 0
    v_accvgpr_read_b32 v124, a12
    v_accvgpr_read_b32 v125, a13
    v_accvgpr_read_b32 v126, a14
    v_accvgpr_read_b32 v127, a15
    v_mfma_f32_32x32x16_bf16 a[48:63], v[140:143], v[108:111], a[48:63]
    v_exp_f32 v112, v112
    v_exp_f32 v113, v113
    v_exp_f32 v114, v114
    v_exp_f32 v115, v115
    v_mfma_f32_32x32x16_bf16 a[80:95], v[144:147], v[104:107], 0
    v_exp_f32 v116, v116
    v_exp_f32 v117, v117
    v_exp_f32 v118, v118
    v_exp_f32 v119, v119
    v_mfma_f32_32x32x16_bf16 a[80:95], v[148:151], v[108:111], a[80:95]
    v_exp_f32 v120, v120
    v_exp_f32 v121, v121
    v_exp_f32 v122, v122
    v_exp_f32 v123, v123
    v_mfma_f32_32x32x16_bf16 a[144:159], v[152:155], v[104:107], 0
    v_exp_f32 v124, v124
    v_exp_f32 v125, v125
    v_exp_f32 v126, v126
    v_exp_f32 v127, v127
    v_mfma_f32_32x32x16_bf16 a[144:159], v[156:159], v[108:111], a[144:159]
    v_cvt_pk_bf16_f32 v104, v112, v113
    v_cvt_pk_bf16_f32 v105, v114, v115
    v_cvt_pk_bf16_f32 v106, v116, v117
    v_cvt_pk_bf16_f32 v107, v118, v119
    v_cvt_pk_bf16_f32 v108, v120, v121
    v_cvt_pk_bf16_f32 v109, v122, v123
    v_cvt_pk_bf16_f32 v110, v124, v125
    v_cvt_pk_bf16_f32 v111, v126, v127
    v_mfma_f32_32x32x16_bf16 a[64:79], v[36:39], v[40:43], a[64:79]
    v_mfma_f32_16x16x32_bf16 a[176:179], v[26:29], v[104:107], a[176:179]
    v_accvgpr_read_b32 v112, a32
    v_accvgpr_read_b32 v113, a33
    v_mfma_f32_16x16x32_bf16 a[176:179], v[26:29], v[108:111], a[176:179]
    v_accvgpr_read_b32 v114, a34
    v_accvgpr_read_b32 v115, a35
    v_mfma_f32_32x32x16_bf16 a[16:31], v[160:163], v[104:107], a[16:31]
    v_accvgpr_read_b32 v116, a36
    v_accvgpr_read_b32 v117, a37
    v_accvgpr_read_b32 v118, a38
    v_accvgpr_read_b32 v119, a39
    v_mfma_f32_32x32x16_bf16 a[16:31], v[164:167], v[108:111], a[16:31]
    v_accvgpr_read_b32 v120, a40
    v_accvgpr_read_b32 v121, a41
    v_accvgpr_read_b32 v122, a42
    v_accvgpr_read_b32 v123, a43
    v_mfma_f32_32x32x16_bf16 a[48:63], v[168:171], v[104:107], a[48:63]
    v_accvgpr_read_b32 v124, a44
    v_accvgpr_read_b32 v125, a45
    v_accvgpr_read_b32 v126, a46
    v_accvgpr_read_b32 v127, a47
    v_mfma_f32_32x32x16_bf16 a[48:63], v[172:175], v[108:111], a[48:63]
    v_exp_f32 v112, v112
    v_exp_f32 v113, v113
    v_exp_f32 v114, v114
    v_exp_f32 v115, v115
    v_mfma_f32_32x32x16_bf16 a[80:95], v[176:179], v[104:107], a[80:95]
    v_exp_f32 v116, v116
    v_exp_f32 v117, v117
    v_exp_f32 v118, v118
    v_exp_f32 v119, v119
    v_mfma_f32_32x32x16_bf16 a[80:95], v[180:183], v[108:111], a[80:95]
    v_exp_f32 v120, v120
    v_exp_f32 v121, v121
    v_exp_f32 v122, v122
    v_exp_f32 v123, v123
    v_mfma_f32_32x32x16_bf16 a[144:159], v[184:187], v[104:107], a[144:159]
    v_exp_f32 v124, v124
    v_exp_f32 v125, v125
    v_exp_f32 v126, v126
    v_exp_f32 v127, v127
    v_mfma_f32_32x32x16_bf16 a[144:159], v[188:191], v[108:111], a[144:159]
    v_cvt_pk_bf16_f32 v104, v112, v113
    v_cvt_pk_bf16_f32 v105, v114, v115
    v_cvt_pk_bf16_f32 v106, v116, v117
    v_cvt_pk_bf16_f32 v107, v118, v119
    v_cvt_pk_bf16_f32 v108, v120, v121
    v_cvt_pk_bf16_f32 v109, v122, v123
    v_cvt_pk_bf16_f32 v110, v124, v125
    v_cvt_pk_bf16_f32 v111, v126, v127
    v_and_b32 v35, 1, v1
    v_lshlrev_b32 v35, 6, v35
    v_mov_b32 v34, 1
    s_mov_b64 exec, 3
    v_mov_b32 v34, 0
    buffer_atomic_or v34, v35, s[44:47], s99 offen sc0 sc1
    s_mov_b64 exec, -1
    v_mfma_f32_32x32x16_bf16 a[96:111], v[36:39], v[40:43], a[96:111]
    v_mfma_f32_16x16x32_bf16 a[176:179], v[26:29], v[104:107], a[176:179]
    v_accvgpr_read_b32 v112, a64
    v_accvgpr_read_b32 v113, a65
    v_mfma_f32_16x16x32_bf16 a[176:179], v[26:29], v[108:111], a[176:179]
    v_accvgpr_read_b32 v114, a66
    v_accvgpr_read_b32 v115, a67
    v_mfma_f32_32x32x16_bf16 a[16:31], v[192:195], v[104:107], a[16:31]
    v_accvgpr_read_b32 v116, a68
    v_accvgpr_read_b32 v117, a69
    v_accvgpr_read_b32 v118, a70
    v_accvgpr_read_b32 v119, a71
    v_mfma_f32_32x32x16_bf16 a[16:31], v[196:199], v[108:111], a[16:31]
    v_accvgpr_read_b32 v120, a72
    v_accvgpr_read_b32 v121, a73
    v_accvgpr_read_b32 v122, a74
    v_accvgpr_read_b32 v123, a75
    v_mfma_f32_32x32x16_bf16 a[48:63], v[200:203], v[104:107], a[48:63]
    v_accvgpr_read_b32 v124, a76
    v_accvgpr_read_b32 v125, a77
    v_accvgpr_read_b32 v126, a78
    v_accvgpr_read_b32 v127, a79
    v_mfma_f32_32x32x16_bf16 a[48:63], v[204:207], v[108:111], a[48:63]
    v_exp_f32 v112, v112
    v_exp_f32 v113, v113
    v_exp_f32 v114, v114
    v_exp_f32 v115, v115
    v_mfma_f32_32x32x16_bf16 a[80:95], v[208:211], v[104:107], a[80:95]
    v_exp_f32 v116, v116
    v_exp_f32 v117, v117
    v_exp_f32 v118, v118
    v_exp_f32 v119, v119
    v_mfma_f32_32x32x16_bf16 a[80:95], v[212:215], v[108:111], a[80:95]
    v_exp_f32 v120, v120
    v_exp_f32 v121, v121
    v_exp_f32 v122, v122
    v_exp_f32 v123, v123
    v_mfma_f32_32x32x16_bf16 a[144:159], v[216:219], v[104:107], a[144:159]
    v_exp_f32 v124, v124
    v_exp_f32 v125, v125
    v_exp_f32 v126, v126
    v_exp_f32 v127, v127
    v_mfma_f32_32x32x16_bf16 a[144:159], v[220:223], v[108:111], a[144:159]
    v_cvt_pk_bf16_f32 v104, v112, v113
    v_cvt_pk_bf16_f32 v105, v114, v115
    v_cvt_pk_bf16_f32 v106, v116, v117
    v_cvt_pk_bf16_f32 v107, v118, v119
    v_cvt_pk_bf16_f32 v108, v120, v121
    v_cvt_pk_bf16_f32 v109, v122, v123
    v_cvt_pk_bf16_f32 v110, v124, v125
    v_cvt_pk_bf16_f32 v111, v126, v127
    v_mfma_f32_32x32x16_bf16 a[128:143], v[36:39], v[40:43], a[128:143]
    v_mfma_f32_16x16x32_bf16 a[176:179], v[26:29], v[104:107], a[176:179]
    v_accvgpr_read_b32 v112, a96
    v_accvgpr_read_b32 v113, a97
    v_mfma_f32_16x16x32_bf16 a[176:179], v[26:29], v[108:111], a[176:179]
    v_accvgpr_read_b32 v114, a98
    v_accvgpr_read_b32 v115, a99
    v_mfma_f32_32x32x16_bf16 a[16:31], v[224:227], v[104:107], a[16:31]
    v_accvgpr_read_b32 v116, a100
    v_accvgpr_read_b32 v117, a101
    v_accvgpr_read_b32 v118, a102
    v_accvgpr_read_b32 v119, a103
    v_mfma_f32_32x32x16_bf16 a[16:31], v[228:231], v[108:111], a[16:31]
    v_accvgpr_read_b32 v120, a104
    v_accvgpr_read_b32 v121, a105
    v_accvgpr_read_b32 v122, a106
    v_accvgpr_read_b32 v123, a107
    v_mfma_f32_32x32x16_bf16 a[48:63], v[232:235], v[104:107], a[48:63]
    v_accvgpr_read_b32 v124, a108
    v_accvgpr_read_b32 v125, a109
    v_accvgpr_read_b32 v126, a110
    v_accvgpr_read_b32 v127, a111
    v_mfma_f32_32x32x16_bf16 a[48:63], v[236:239], v[108:111], a[48:63]
    v_exp_f32 v112, v112
    v_exp_f32 v113, v113
    v_exp_f32 v114, v114
    v_exp_f32 v115, v115
    v_mfma_f32_32x32x16_bf16 a[80:95], v[240:243], v[104:107], a[80:95]
    v_exp_f32 v116, v116
    v_exp_f32 v117, v117
    v_exp_f32 v118, v118
    v_exp_f32 v119, v119
    v_mfma_f32_32x32x16_bf16 a[80:95], v[244:247], v[108:111], a[80:95]
    v_exp_f32 v120, v120
    v_exp_f32 v121, v121
    v_exp_f32 v122, v122
    v_exp_f32 v123, v123
    v_mfma_f32_32x32x16_bf16 a[144:159], v[248:251], v[104:107], a[144:159]
    v_exp_f32 v124, v124
    v_exp_f32 v125, v125
    v_exp_f32 v126, v126
    v_exp_f32 v127, v127
    v_mfma_f32_32x32x16_bf16 a[144:159], v[252:255], v[108:111], a[144:159]
    v_cvt_pk_bf16_f32 v104, v112, v113
    v_cvt_pk_bf16_f32 v105, v114, v115
    v_cvt_pk_bf16_f32 v106, v116, v117
    v_cvt_pk_bf16_f32 v107, v118, v119
    v_cvt_pk_bf16_f32 v108, v120, v121
    v_cvt_pk_bf16_f32 v109, v122, v123
    v_cvt_pk_bf16_f32 v110, v124, v125
    v_cvt_pk_bf16_f32 v111, v126, v127
    s_waitcnt vmcnt(0)
    s_mov_b32 s68, 262144
L_g2qa:
    v_cmp_ne_u32 vcc, 1, v34
    s_cbranch_vccz L_g2qa_x
    v_mov_b32 v34, 1
    s_mov_b64 exec, 3
    v_mov_b32 v34, 0
    buffer_atomic_or v34, v35, s[44:47], s99 offen sc0 sc1
    s_mov_b64 exec, -1
    s_sub_u32 s68, s68, 1
    s_waitcnt vmcnt(0)
    s_cbranch_scc0 L_g2qa
L_g2qa_x:
    s_lshl_b32 s5, s3, 13
    s_add_u32 m0, s5, 131072
    s_lshl_b32 s5, s3, 11
    s_add_u32 s5, s5, s98
    buffer_load_dwordx4 v30, s[44:47], s5 offen offset:0 sc1 lds
    buffer_load_dwordx4 v30, s[44:47], s5 offen offset:1024 sc1 lds
    s_add_u32 s99, s98, 8192
    s_lshl_b32 s5, s3, 13
    s_add_u32 m0, s5, 133120
    s_lshl_b32 s5, s3, 11
    s_add_u32 s5, s5, s99
    buffer_load_dwordx4 v30, s[44:47], s5 offen offset:0 sc1 lds
    buffer_load_dwordx4 v30, s[44:47], s5 offen offset:1024 sc1 lds
    v_mfma_f32_32x32x16_bf16 a[160:175], v[36:39], v[40:43], a[160:175]
    ds_read_b64_tr_b16 v[72:73], v18 offset:0
    ds_read_b64_tr_b16 v[74:75], v18 offset:2048
    ds_read_b64_tr_b16 v[76:77], v18 offset:4096
    ds_read_b64_tr_b16 v[78:79], v18 offset:6144
    ds_read_b64_tr_b16 v[80:81], v19 offset:0
    ds_read_b64_tr_b16 v[82:83], v19 offset:2048
    ds_read_b64_tr_b16 v[84:85], v19 offset:4096
    ds_read_b64_tr_b16 v[86:87], v19 offset:6144
    ds_read_b64_tr_b16 v[88:89], v20 offset:0
    ds_read_b64_tr_b16 v[90:91], v20 offset:2048
    ds_read_b64_tr_b16 v[92:93], v20 offset:4096
    ds_read_b64_tr_b16 v[94:95], v20 offset:6144
    ds_read_b64_tr_b16 v[96:97], v21 offset:0
    ds_read_b64_tr_b16 v[98:99], v21 offset:2048
    ds_read_b64_tr_b16 v[100:101], v21 offset:4096
    ds_read_b64_tr_b16 v[102:103], v21 offset:6144
    v_mfma_f32_16x16x32_bf16 a[176:179], v[26:29], v[104:107], a[176:179]
    v_accvgpr_read_b32 v112, a128
    v_accvgpr_read_b32 v113, a129
    v_mfma_f32_16x16x32_bf16 a[176:179], v[26:29], v[108:111], a[176:179]
    v_accvgpr_read_b32 v114, a130
    v_accvgpr_read_b32 v115, a131
    s_waitcnt lgkmcnt(12)
    v_mfma_f32_32x32x16_bf16 a[16:31], v[72:75], v[104:107], a[16:31]
    v_accvgpr_read_b32 v116, a132
    v_accvgpr_read_b32 v117, a133
    v_accvgpr_read_b32 v118, a134
    v_accvgpr_read_b32 v119, a135
    v_mfma_f32_32x32x16_bf16 a[16:31], v[76:79], v[108:111], a[16:31]
    v_accvgpr_read_b32 v120, a136
    v_accvgpr_read_b32 v121, a137
    v_accvgpr_read_b32 v122, a138
    v_accvgpr_read_b32 v123, a139
    s_waitcnt lgkmcnt(8)
    v_mfma_f32_32x32x16_bf16 a[48:63], v[80:83], v[104:107], a[48:63]
    v_accvgpr_read_b32 v124, a140
    v_accvgpr_read_b32 v125, a141
    v_accvgpr_read_b32 v126, a142
    v_accvgpr_read_b32 v127, a143
    v_mfma_f32_32x32x16_bf16 a[48:63], v[84:87], v[108:111], a[48:63]
    v_exp_f32 v112, v112
    v_exp_f32 v113, v113
    v_exp_f32 v114, v114
    v_exp_f32 v115, v115
    s_waitcnt lgkmcnt(4)
    v_mfma_f32_32x32x16_bf16 a[80:95], v[88:91], v[104:107], a[80:95]
    v_exp_f32 v116, v116
    v_exp_f32 v117, v117
    v_exp_f32 v118, v118
    v_exp_f32 v119, v119
    v_mfma_f32_32x32x16_bf16 a[80:95], v[92:95], v[108:111], a[80:95]
    v_exp_f32 v120, v120
    v_exp_f32 v121, v121
    v_exp_f32 v122, v122
    v_exp_f32 v123, v123
    s_waitcnt lgkmcnt(0)
    v_mfma_f32_32x32x16_bf16 a[144:159], v[96:99], v[104:107], a[144:159]
    v_exp_f32 v124, v124
    v_exp_f32 v125, v125
    v_exp_f32 v126, v126
    v_exp_f32 v127, v127
    v_mfma_f32_32x32x16_bf16 a[144:159], v[100:103], v[108:111], a[144:159]
    v_cvt_pk_bf16_f32 v104, v112, v113
    v_cvt_pk_bf16_f32 v105, v114, v115
    v_cvt_pk_bf16_f32 v106, v116, v117
    v_cvt_pk_bf16_f32 v107, v118, v119
    v_cvt_pk_bf16_f32 v108, v120, v121
    v_cvt_pk_bf16_f32 v109, v122, v123
    v_cvt_pk_bf16_f32 v110, v124, v125
    v_cvt_pk_bf16_f32 v111, v126, v127
    v_mfma_f32_32x32x16_bf16 a[192:207], v[36:39], v[40:43], a[192:207]
    ds_read_b64_tr_b16 v[72:73], v18 offset:8192
    ds_read_b64_tr_b16 v[74:75], v18 offset:10240
    ds_read_b64_tr_b16 v[76:77], v18 offset:12288
    ds_read_b64_tr_b16 v[78:79], v18 offset:14336
    ds_read_b64_tr_b16 v[80:81], v19 offset:8192
    ds_read_b64_tr_b16 v[82:83], v19 offset:10240
    ds_read_b64_tr_b16 v[84:85], v19 offset:12288
    ds_read_b64_tr_b16 v[86:87], v19 offset:14336
    ds_read_b64_tr_b16 v[88:89], v20 offset:8192
    ds_read_b64_tr_b16 v[90:91], v20 offset:10240
    ds_read_b64_tr_b16 v[92:93], v20 offset:12288
    ds_read_b64_tr_b16 v[94:95], v20 offset:14336
    ds_read_b64_tr_b16 v[96:97], v21 offset:8192
    ds_read_b64_tr_b16 v[98:99], v21 offset:10240
    ds_read_b64_tr_b16 v[100:101], v21 offset:12288
    ds_read_b64_tr_b16 v[102:103], v21 offset:14336
    v_mfma_f32_16x16x32_bf16 a[176:179], v[26:29], v[104:107], a[176:179]
    v_accvgpr_read_b32 v112, a160
    v_accvgpr_read_b32 v113, a161
    v_mfma_f32_16x16x32_bf16 a[176:179], v[26:29], v[108:111], a[176:179]
    v_accvgpr_read_b32 v114, a162
    v_accvgpr_read_b32 v115, a163
    s_waitcnt lgkmcnt(12)
    v_mfma_f32_32x32x16_bf16 a[16:31], v[72:75], v[104:107], a[16:31]
    v_accvgpr_read_b32 v116, a164
    v_accvgpr_read_b32 v117, a165
    v_accvgpr_read_b32 v118, a166
    v_accvgpr_read_b32 v119, a167
    v_mfma_f32_32x32x16_bf16 a[16:31], v[76:79], v[108:111], a[16:31]
    v_accvgpr_read_b32 v120, a168
    v_accvgpr_read_b32 v121, a169
    v_accvgpr_read_b32 v122, a170
    v_accvgpr_read_b32 v123, a171
    s_waitcnt lgkmcnt(8)
    v_mfma_f32_32x32x16_bf16 a[48:63], v[80:83], v[104:107], a[48:63]
    v_accvgpr_read_b32 v124, a172
    v_accvgpr_read_b32 v125, a173
    v_accvgpr_read_b32 v126, a174
    v_accvgpr_read_b32 v127, a175
    v_mfma_f32_32x32x16_bf16 a[48:63], v[84:87], v[108:111], a[48:63]
    v_exp_f32 v112, v112
    v_exp_f32 v113, v113
    v_exp_f32 v114, v114
    v_exp_f32 v115, v115
    s_waitcnt lgkmcnt(4)
    v_mfma_f32_32x32x16_bf16 a[80:95], v[88:91], v[104:107], a[80:95]
    v_exp_f32 v116, v116
    v_exp_f32 v117, v117
    v_exp_f32 v118, v118
    v_exp_f32 v119, v119
    v_mfma_f32_32x32x16_bf16 a[80:95], v[92:95], v[108:111], a[80:95]
    v_exp_f32 v120, v120
    v_exp_f32 v121, v121
    v_exp_f32 v122, v122
    v_exp_f32 v123, v123
    s_waitcnt lgkmcnt(0)
    v_mfma_f32_32x32x16_bf16 a[144:159], v[96:99], v[104:107], a[144:159]
    v_exp_f32 v124, v124
    v_exp_f32 v125, v125
    v_exp_f32 v126, v126
    v_exp_f32 v127, v127
    v_mfma_f32_32x32x16_bf16 a[144:159], v[100:103], v[108:111], a[144:159]
    v_cvt_pk_bf16_f32 v104, v112, v113
    v_cvt_pk_bf16_f32 v105, v114, v115
    v_cvt_pk_bf16_f32 v106, v116, v117
    v_cvt_pk_bf16_f32 v107, v118, v119
    v_cvt_pk_bf16_f32 v108, v120, v121
    v_cvt_pk_bf16_f32 v109, v122, v123
    v_cvt_pk_bf16_f32 v110, v124, v125
    v_cvt_pk_bf16_f32 v111, v126, v127
    s_mov_b32 s8, s18
    s_mov_b32 s9, s19
    s_mov_b32 s10, 8388608
    s_mov_b32 s11, 0x20000
    s_lshl_b32 s59, s50, 2
    s_lshr_b32 s7, s52, 2
    s_add_u32 s59, s59, s7
    s_lshl_b32 s59, s59, 18
    s_lshl_b32 s7, s3, 10
    s_add_u32 s59, s59, s7
    s_and_b32 s58, s52, 3
    s_lshl_b32 s58, s58, 15
    s_add_u32 s56, s59, s58
    ds_read_b64_tr_b16 v[72:73], v18 offset:16384
    ds_read_b64_tr_b16 v[74:75], v18 offset:18432
    ds_read_b64_tr_b16 v[76:77], v18 offset:20480
    ds_read_b64_tr_b16 v[78:79], v18 offset:22528
    ds_read_b64_tr_b16 v[80:81], v19 offset:16384
    ds_read_b64_tr_b16 v[82:83], v19 offset:18432
    ds_read_b64_tr_b16 v[84:85], v19 offset:20480
    ds_read_b64_tr_b16 v[86:87], v19 offset:22528
    ds_read_b64_tr_b16 v[88:89], v20 offset:16384
    ds_read_b64_tr_b16 v[90:91], v20 offset:18432
    ds_read_b64_tr_b16 v[92:93], v20 offset:20480
    ds_read_b64_tr_b16 v[94:95], v20 offset:22528
    ds_read_b64_tr_b16 v[96:97], v21 offset:16384
    ds_read_b64_tr_b16 v[98:99], v21 offset:18432
    ds_read_b64_tr_b16 v[100:101], v21 offset:20480
    ds_read_b64_tr_b16 v[102:103], v21 offset:22528
    v_mfma_f32_16x16x32_bf16 a[176:179], v[26:29], v[104:107], a[176:179]
    v_accvgpr_read_b32 v112, a192
    v_accvgpr_read_b32 v113, a193
    v_mfma_f32_16x16x32_bf16 a[176:179], v[26:29], v[108:111], a[176:179]
    v_accvgpr_read_b32 v114, a194
    v_accvgpr_read_b32 v115, a195
    s_waitcnt lgkmcnt(12)
    v_mfma_f32_32x32x16_bf16 a[16:31], v[72:75], v[104:107], a[16:31]
    s_add_u32 m0, s4, 0
    s_nop 0
    buffer_load_dwordx4 v2, s[8:11], s56 offen lds
    v_accvgpr_read_b32 v116, a196
    v_accvgpr_read_b32 v117, a197
    v_accvgpr_read_b32 v118, a198
    v_accvgpr_read_b32 v119, a199
    v_mfma_f32_32x32x16_bf16 a[16:31], v[76:79], v[108:111], a[16:31]
    buffer_load_dwordx4 v3, s[8:11], s56 offen offset:1024 lds
    v_accvgpr_read_b32 v120, a200
    v_accvgpr_read_b32 v121, a201
    v_accvgpr_read_b32 v122, a202
    v_accvgpr_read_b32 v123, a203
    s_waitcnt lgkmcnt(8)
    v_mfma_f32_32x32x16_bf16 a[48:63], v[80:83], v[104:107], a[48:63]
    buffer_load_dwordx4 v4, s[8:11], s56 offen offset:2048 lds
    v_accvgpr_read_b32 v124, a204
    v_accvgpr_read_b32 v125, a205
    v_accvgpr_read_b32 v126, a206
    v_accvgpr_read_b32 v127, a207
    v_mfma_f32_32x32x16_bf16 a[48:63], v[84:87], v[108:111], a[48:63]
    buffer_load_dwordx4 v5, s[8:11], s56 offen offset:3072 lds
    v_exp_f32 v112, v112
    v_exp_f32 v113, v113
    v_exp_f32 v114, v114
    v_exp_f32 v115, v115
    s_waitcnt lgkmcnt(4)
    v_mfma_f32_32x32x16_bf16 a[80:95], v[88:91], v[104:107], a[80:95]
    s_add_u32 s57, s56, 16384
    s_add_u32 m0, s4, 4096
    s_nop 0
    buffer_load_dwordx4 v2, s[8:11], s57 offen lds
    v_exp_f32 v116, v116
    v_exp_f32 v117, v117
    v_exp_f32 v118, v118
    v_exp_f32 v119, v119
    v_mfma_f32_32x32x16_bf16 a[80:95], v[92:95], v[108:111], a[80:95]
    buffer_load_dwordx4 v3, s[8:11], s57 offen offset:1024 lds
    v_exp_f32 v120, v120
    v_exp_f32 v121, v121
    v_exp_f32 v122, v122
    v_exp_f32 v123, v123
    s_waitcnt lgkmcnt(0)
    v_mfma_f32_32x32x16_bf16 a[144:159], v[96:99], v[104:107], a[144:159]
    buffer_load_dwordx4 v4, s[8:11], s57 offen offset:2048 lds
    v_exp_f32 v124, v124
    v_exp_f32 v125, v125
    v_exp_f32 v126, v126
    v_exp_f32 v127, v127
    v_mfma_f32_32x32x16_bf16 a[144:159], v[100:103], v[108:111], a[144:159]
    buffer_load_dwordx4 v5, s[8:11], s57 offen offset:3072 lds
    s_add_u32 s58, s58, 32768
    s_and_b32 s58, s58, 131071
    s_add_u32 s56, s59, s58
    v_cvt_pk_bf16_f32 v104, v112, v113
    v_cvt_pk_bf16_f32 v105, v114, v115
    v_cvt_pk_bf16_f32 v106, v116, v117
    v_cvt_pk_bf16_f32 v107, v118, v119
    v_cvt_pk_bf16_f32 v108, v120, v121
    v_cvt_pk_bf16_f32 v109, v122, v123
    v_cvt_pk_bf16_f32 v110, v124, v125
    v_cvt_pk_bf16_f32 v111, v126, v127
    ds_read_b64_tr_b16 v[72:73], v18 offset:24576
    ds_read_b64_tr_b16 v[74:75], v18 offset:26624
    ds_read_b64_tr_b16 v[76:77], v18 offset:28672
    ds_read_b64_tr_b16 v[78:79], v18 offset:30720
    ds_read_b64_tr_b16 v[80:81], v19 offset:24576
    ds_read_b64_tr_b16 v[82:83], v19 offset:26624
    ds_read_b64_tr_b16 v[84:85], v19 offset:28672
    ds_read_b64_tr_b16 v[86:87], v19 offset:30720
    ds_read_b64_tr_b16 v[88:89], v20 offset:24576
    ds_read_b64_tr_b16 v[90:91], v20 offset:26624
    ds_read_b64_tr_b16 v[92:93], v20 offset:28672
    ds_read_b64_tr_b16 v[94:95], v20 offset:30720
    ds_read_b64_tr_b16 v[96:97], v21 offset:24576
    ds_read_b64_tr_b16 v[98:99], v21 offset:26624
    ds_read_b64_tr_b16 v[100:101], v21 offset:28672
    ds_read_b64_tr_b16 v[102:103], v21 offset:30720
    v_mfma_f32_16x16x32_bf16 a[176:179], v[26:29], v[104:107], a[176:179]
    v_mfma_f32_16x16x32_bf16 a[176:179], v[26:29], v[108:111], a[176:179]
    s_waitcnt lgkmcnt(12)
    v_mfma_f32_32x32x16_bf16 a[16:31], v[72:75], v[104:107], a[16:31]
    s_add_u32 m0, s4, 8192
    s_nop 0
    buffer_load_dwordx4 v2, s[8:11], s56 offen lds
    v_mfma_f32_32x32x16_bf16 a[16:31], v[76:79], v[108:111], a[16:31]
    buffer_load_dwordx4 v3, s[8:11], s56 offen offset:1024 lds
    s_waitcnt lgkmcnt(8)
    v_mfma_f32_32x32x16_bf16 a[48:63], v[80:83], v[104:107], a[48:63]
    buffer_load_dwordx4 v4, s[8:11], s56 offen offset:2048 lds
    v_mfma_f32_32x32x16_bf16 a[48:63], v[84:87], v[108:111], a[48:63]
    buffer_load_dwordx4 v5, s[8:11], s56 offen offset:3072 lds
    s_waitcnt lgkmcnt(4)
    v_mfma_f32_32x32x16_bf16 a[80:95], v[88:91], v[104:107], a[80:95]
    s_add_u32 s57, s56, 16384
    s_add_u32 m0, s4, 12288
    s_nop 0
    buffer_load_dwordx4 v2, s[8:11], s57 offen lds
    v_mfma_f32_32x32x16_bf16 a[80:95], v[92:95], v[108:111], a[80:95]
    buffer_load_dwordx4 v3, s[8:11], s57 offen offset:1024 lds
    s_waitcnt lgkmcnt(0)
    v_mfma_f32_32x32x16_bf16 a[144:159], v[96:99], v[104:107], a[144:159]
    buffer_load_dwordx4 v4, s[8:11], s57 offen offset:2048 lds
    v_mfma_f32_32x32x16_bf16 a[144:159], v[100:103], v[108:111], a[144:159]
    buffer_load_dwordx4 v5, s[8:11], s57 offen offset:3072 lds
    s_add_u32 s58, s58, 32768
    s_and_b32 s58, s58, 131071
    s_add_u32 s56, s59, s58
    s_waitcnt vmcnt(16)
    s_barrier
    v_add_u32 v35, 131072, v30
    ds_read_b128 v[40:43], v35 offset:0
    ds_read_b128 v[44:47], v35 offset:1024
    ds_read_b128 v[48:51], v35 offset:8192
    ds_read_b128 v[52:55], v35 offset:9216
    ds_read_b128 v[56:59], v35 offset:16384
    ds_read_b128 v[60:63], v35 offset:17408
    ds_read_b128 v[64:67], v35 offset:24576
    ds_read_b128 v[68:71], v35 offset:25600
    s_waitcnt lgkmcnt(4)
    v_add_u32 v35, 131072, v30
    ds_read_b128 a[96:99], v35 offset:2048
    ds_read_b128 a[100:103], v35 offset:3072
    ds_read_b128 a[104:107], v35 offset:10240
    ds_read_b128 a[108:111], v35 offset:11264
    ds_read_b128 a[112:115], v35 offset:18432
    ds_read_b128 a[116:119], v35 offset:19456
    ds_read_b128 a[120:123], v35 offset:26624
    ds_read_b128 a[124:127], v35 offset:27648
    s_waitcnt lgkmcnt(0)
    s_barrier
    s_lshl_b32 s5, s3, 13
    s_add_u32 s5, s5, 131072
    v_add_u32 v96, s4, v30
    v_add_u32 v97, s5, v30
    s_sub_u32 s5, s3, 1
    s_and_b32 s5, s5, 3
    s_lshl_b32 s7, s5, 13
    s_add_u32 s7, s7, 131072
    s_lshl_b32 s5, s5, 15
    v_add_u32 v98, s5, v30
    v_add_u32 v99, s7, v30
    s_sub_u32 s5, s3, 2
    s_and_b32 s5, s5, 3
    s_lshl_b32 s7, s5, 13
    s_add_u32 s7, s7, 131072
    s_lshl_b32 s5, s5, 15
    v_add_u32 v100, s5, v30
    v_add_u32 v101, s7, v30
    s_sub_u32 s5, s3, 3
    s_and_b32 s5, s5, 3
    s_lshl_b32 s7, s5, 13
    s_add_u32 s7, s7, 131072
    s_lshl_b32 s5, s5, 15
    v_add_u32 v102, s5, v30
    v_add_u32 v103, s7, v30
    s_mov_b32 vcc_lo, 0xffff0000
    s_mov_b32 vcc_hi, 0xffff0000
    v_accvgpr_read_b32 v72, a176
    v_accvgpr_read_b32 v73, a177
    v_cndmask_b32 v73, v72, v73, vcc
    v_mov_b32 v72, v32
    ds_write_b64 v97, v[72:73] offset:4096
    ds_write_b128 v96, a[48:51] offset:24576
    ds_write_b128 v96, a[52:55] offset:25600
    ds_write_b128 v96, a[56:59] offset:26624
    ds_write_b128 v96, a[60:63] offset:27648
    ds_write_b128 v96, a[80:83] offset:28672
    ds_write_b128 v96, a[84:87] offset:29696
    ds_write_b128 v96, a[88:91] offset:30720
    ds_write_b128 v96, a[92:95] offset:31744
    ds_write_b128 v97, a[144:147] offset:0
    ds_write_b128 v97, a[148:151] offset:1024
    ds_write_b128 v97, a[152:155] offset:2048
    ds_write_b128 v97, a[156:159] offset:3072
    v_accvgpr_read_b32 v128, a16
    v_accvgpr_read_b32 v129, a17
    v_accvgpr_read_b32 v130, a18
    v_accvgpr_read_b32 v131, a19
    v_accvgpr_read_b32 v132, a20
    v_accvgpr_read_b32 v133, a21
    v_accvgpr_read_b32 v134, a22
    v_accvgpr_read_b32 v135, a23
    v_accvgpr_read_b32 v136, a24
    v_accvgpr_read_b32 v137, a25
    v_accvgpr_read_b32 v138, a26
    v_accvgpr_read_b32 v139, a27
    v_accvgpr_read_b32 v140, a28
    v_accvgpr_read_b32 v141, a29
    v_accvgpr_read_b32 v142, a30
    v_accvgpr_read_b32 v143, a31
    s_waitcnt lgkmcnt(0)
    s_barrier
    ds_read_b64 v[74:75], v99 offset:4096
    ds_read_b64 v[76:77], v101 offset:4096
    ds_read_b64 v[78:79], v103 offset:4096
    ds_read_b128 v[144:147], v98 offset:24576
    ds_read_b128 v[148:151], v98 offset:25600
    ds_read_b128 v[152:155], v98 offset:26624
    ds_read_b128 v[156:159], v98 offset:27648
    ds_read_b128 v[160:163], v100 offset:28672
    ds_read_b128 v[164:167], v100 offset:29696
    ds_read_b128 v[168:171], v100 offset:30720
    ds_read_b128 v[172:175], v100 offset:31744
    s_add_u32 m0, s4, 16384
    s_nop 0
    buffer_load_dwordx4 v2, s[8:11], s56 offen lds
    buffer_load_dwordx4 v3, s[8:11], s56 offen offset:1024 lds
    buffer_load_dwordx4 v4, s[8:11], s56 offen offset:2048 lds
    buffer_load_dwordx4 v5, s[8:11], s56 offen offset:3072 lds
    s_add_u32 s57, s56, 16384
    s_add_u32 m0, s4, 20480
    s_nop 0
    buffer_load_dwordx4 v2, s[8:11], s57 offen lds
    buffer_load_dwordx4 v3, s[8:11], s57 offen offset:1024 lds
    buffer_load_dwordx4 v4, s[8:11], s57 offen offset:2048 lds
    buffer_load_dwordx4 v5, s[8:11], s57 offen offset:3072 lds
    s_add_u32 s58, s58, 32768
    s_and_b32 s58, s58, 131071
    s_add_u32 s56, s59, s58
    s_waitcnt lgkmcnt(8)
    ds_read_b128 v[176:179], v103 offset:0
    ds_read_b128 v[180:183], v103 offset:1024
    ds_read_b128 v[184:187], v103 offset:2048
    ds_read_b128 v[188:191], v103 offset:3072
    v_max3_f32 v88, v72, v74, v76
    v_max_f32 v88, v88, v78
    v_sub_f32 v90, v72, v88
    v_sub_f32 v91, v74, v88
    v_sub_f32 v92, v76, v88
    v_sub_f32 v93, v78, v88
    v_exp_f32 v90, v90
    v_exp_f32 v91, v91
    v_exp_f32 v92, v92
    v_exp_f32 v93, v93
    v_mul_f32 v89, v90, v73
    v_fmac_f32 v89, v91, v75
    v_fmac_f32 v89, v92, v77
    v_fmac_f32 v89, v93, v79
    v_rcp_f32 v89, v89
    s_nop 0
    v_mul_f32 v90, v90, v89
    v_mul_f32 v91, v91, v89
    v_mul_f32 v92, v92, v89
    v_mul_f32 v93, v93, v89
    v_pk_mul_f32 v[128:129], v[128:129], v[90:91] op_sel_hi:[1,0]
    v_pk_mul_f32 v[130:131], v[130:131], v[90:91] op_sel_hi:[1,0]
    v_pk_mul_f32 v[132:133], v[132:133], v[90:91] op_sel_hi:[1,0]
    v_pk_mul_f32 v[134:135], v[134:135], v[90:91] op_sel_hi:[1,0]
    v_pk_mul_f32 v[136:137], v[136:137], v[90:91] op_sel_hi:[1,0]
    v_pk_mul_f32 v[138:139], v[138:139], v[90:91] op_sel_hi:[1,0]
    v_pk_mul_f32 v[140:141], v[140:141], v[90:91] op_sel_hi:[1,0]
    v_pk_mul_f32 v[142:143], v[142:143], v[90:91] op_sel_hi:[1,0]
    s_waitcnt lgkmcnt(8)
    v_pk_fma_f32 v[128:129], v[144:145], v[90:91], v[128:129] op_sel:[0,1,0]
    v_pk_fma_f32 v[130:131], v[146:147], v[90:91], v[130:131] op_sel:[0,1,0]
    v_pk_fma_f32 v[132:133], v[148:149], v[90:91], v[132:133] op_sel:[0,1,0]
    v_pk_fma_f32 v[134:135], v[150:151], v[90:91], v[134:135] op_sel:[0,1,0]
    v_pk_fma_f32 v[136:137], v[152:153], v[90:91], v[136:137] op_sel:[0,1,0]
    v_pk_fma_f32 v[138:139], v[154:155], v[90:91], v[138:139] op_sel:[0,1,0]
    v_pk_fma_f32 v[140:141], v[156:157], v[90:91], v[140:141] op_sel:[0,1,0]
    v_pk_fma_f32 v[142:143], v[158:159], v[90:91], v[142:143] op_sel:[0,1,0]
    s_waitcnt lgkmcnt(4)
    v_pk_fma_f32 v[128:129], v[160:161], v[92:93], v[128:129] op_sel_hi:[1,0,1]
    v_pk_fma_f32 v[130:131], v[162:163], v[92:93], v[130:131] op_sel_hi:[1,0,1]
    v_pk_fma_f32 v[132:133], v[164:165], v[92:93], v[132:133] op_sel_hi:[1,0,1]
    v_pk_fma_f32 v[134:135], v[166:167], v[92:93], v[134:135] op_sel_hi:[1,0,1]
    v_pk_fma_f32 v[136:137], v[168:169], v[92:93], v[136:137] op_sel_hi:[1,0,1]
    v_pk_fma_f32 v[138:139], v[170:171], v[92:93], v[138:139] op_sel_hi:[1,0,1]
    v_pk_fma_f32 v[140:141], v[172:173], v[92:93], v[140:141] op_sel_hi:[1,0,1]
    v_pk_fma_f32 v[142:143], v[174:175], v[92:93], v[142:143] op_sel_hi:[1,0,1]
    s_waitcnt lgkmcnt(0)
    v_pk_fma_f32 v[128:129], v[176:177], v[92:93], v[128:129] op_sel:[0,1,0]
    v_pk_fma_f32 v[130:131], v[178:179], v[92:93], v[130:131] op_sel:[0,1,0]
    v_pk_fma_f32 v[132:133], v[180:181], v[92:93], v[132:133] op_sel:[0,1,0]
    v_pk_fma_f32 v[134:135], v[182:183], v[92:93], v[134:135] op_sel:[0,1,0]
    v_pk_fma_f32 v[136:137], v[184:185], v[92:93], v[136:137] op_sel:[0,1,0]
    v_pk_fma_f32 v[138:139], v[186:187], v[92:93], v[138:139] op_sel:[0,1,0]
    v_pk_fma_f32 v[140:141], v[188:189], v[92:93], v[140:141] op_sel:[0,1,0]
    v_pk_fma_f32 v[142:143], v[190:191], v[92:93], v[142:143] op_sel:[0,1,0]
    s_barrier
    v_cvt_pk_bf16_f32 v128, v128, v129
    v_cvt_pk_bf16_f32 v129, v130, v131
    v_cvt_pk_bf16_f32 v130, v132, v133
    v_cvt_pk_bf16_f32 v131, v134, v135
    v_cvt_pk_bf16_f32 v132, v136, v137
    v_cvt_pk_bf16_f32 v133, v138, v139
    v_cvt_pk_bf16_f32 v134, v140, v141
    v_cvt_pk_bf16_f32 v135, v142, v143
    s_lshl_b32 s5, s3, 11
    s_add_u32 s5, s5, s65
    buffer_store_dwordx4 v[128:131], v30, s[44:47], s5 offen sc1
    buffer_store_dwordx4 v[132:135], v30, s[44:47], s5 offen offset:1024 sc1
    s_getpc_b64 s[48:49]
L_g2pf2:
    s_add_u32 s48, s48, L_g2tail2-L_g2pf2
    s_addc_u32 s49, s49, 0
    s_lshl_b32 s7, s52, 2
    s_add_u32 s7, s7, s3
    s_mul_i32 s7, s7, 256
    v_lshl_add_u32 v101, v1, 7, s7
    v_min_u32 v101, L_end-L_g2tail2-4, v101
    s_mov_b64 exec, 3
    global_load_dword v31, v101, s[48:49]
    s_mov_b64 exec, -1
L_g2pf2_x:
    s_sub_u32 s49, s69, s4
    s_waitcnt vmcnt(18)
    ds_read_b128 v[72:75], v10 offset:0
    ds_read_b128 v[76:79], v11 offset:0
    ds_read_b128 v[80:83], v12 offset:0
    ds_read_b128 v[84:87], v13 offset:0
    ds_read_b128 v[88:91], v14 offset:0
    ds_read_b128 v[92:95], v15 offset:0
    ds_read_b128 v[96:99], v16 offset:0
    ds_read_b128 v[100:103], v17 offset:0
    s_waitcnt vmcnt(10)
    s_waitcnt lgkmcnt(7)
    v_mfma_f32_32x32x16_bf16 v[128:143], v[72:75], v[40:43], 0
    v_mfma_f32_32x32x16_bf16 a[128:143], v[72:75], a[96:99], 0
    ds_read_b128 v[72:75], v10 offset:8192
    s_add_u32 m0, s4, 24576
    s_nop 0
    buffer_load_dwordx4 v2, s[8:11], s56 offen lds
    buffer_load_dwordx4 v3, s[8:11], s56 offen offset:1024 lds
    s_waitcnt lgkmcnt(7)
    v_mfma_f32_32x32x16_bf16 v[128:143], v[76:79], v[44:47], v[128:143]
    v_mfma_f32_32x32x16_bf16 a[128:143], v[76:79], a[100:103], a[128:143]
    ds_read_b128 v[76:79], v11 offset:8192
    buffer_load_dwordx4 v4, s[8:11], s56 offen offset:2048 lds
    buffer_load_dwordx4 v5, s[8:11], s56 offen offset:3072 lds
    s_waitcnt lgkmcnt(7)
    v_mfma_f32_32x32x16_bf16 v[128:143], v[80:83], v[48:51], v[128:143]
    v_mfma_f32_32x32x16_bf16 a[128:143], v[80:83], a[104:107], a[128:143]
    ds_read_b128 v[80:83], v12 offset:8192
    s_add_u32 s57, s56, 16384
    s_add_u32 m0, s4, 28672
    s_nop 0
    buffer_load_dwordx4 v2, s[8:11], s57 offen lds
    buffer_load_dwordx4 v3, s[8:11], s57 offen offset:1024 lds
    s_waitcnt lgkmcnt(7)
    v_mfma_f32_32x32x16_bf16 v[128:143], v[84:87], v[52:55], v[128:143]
    v_mfma_f32_32x32x16_bf16 a[128:143], v[84:87], a[108:111], a[128:143]
    ds_read_b128 v[84:87], v13 offset:8192
    buffer_load_dwordx4 v4, s[8:11], s57 offen offset:2048 lds
    buffer_load_dwordx4 v5, s[8:11], s57 offen offset:3072 lds
    s_add_u32 s58, s58, 32768
    s_and_b32 s58, s58, 131071
    s_add_u32 s56, s59, s58
    s_waitcnt lgkmcnt(7)
    v_mfma_f32_32x32x16_bf16 v[128:143], v[88:91], v[56:59], v[128:143]
    v_mfma_f32_32x32x16_bf16 a[128:143], v[88:91], a[112:115], a[128:143]
    ds_read_b128 v[88:91], v14 offset:8192
    s_waitcnt lgkmcnt(7)
    v_mfma_f32_32x32x16_bf16 v[128:143], v[92:95], v[60:63], v[128:143]
    v_mfma_f32_32x32x16_bf16 a[128:143], v[92:95], a[116:119], a[128:143]
    ds_read_b128 v[92:95], v15 offset:8192
    s_waitcnt lgkmcnt(7)
    v_mfma_f32_32x32x16_bf16 v[128:143], v[96:99], v[64:67], v[128:143]
    v_mfma_f32_32x32x16_bf16 a[128:143], v[96:99], a[120:123], a[128:143]
    ds_read_b128 v[96:99], v16 offset:8192
    s_waitcnt lgkmcnt(7)
    v_mfma_f32_32x32x16_bf16 v[128:143], v[100:103], v[68:71], v[128:143]
    v_mfma_f32_32x32x16_bf16 a[128:143], v[100:103], a[124:127], a[128:143]
    ds_read_b128 v[100:103], v17 offset:8192
    s_add_u32 s59, s59, 131072
    s_add_u32 s56, s56, 131072
    s_add_u32 m0, s4, 0
    s_nop 0
    buffer_load_dwordx4 v2, s[8:11], s56 offen lds
    buffer_load_dwordx4 v3, s[8:11], s56 offen offset:1024 lds
    s_waitcnt vmcnt(12)
    s_waitcnt lgkmcnt(6)
    v_mfma_f32_32x32x16_bf16 v[144:159], v[72:75], v[40:43], 0
    v_mfma_f32_32x32x16_bf16 a[144:159], v[72:75], a[96:99], 0
    ds_read_b128 v[72:75], v10 offset:16384
    buffer_load_dwordx4 v4, s[8:11], s56 offen offset:2048 lds
    buffer_load_dwordx4 v5, s[8:11], s56 offen offset:3072 lds
    v_mfma_f32_32x32x16_bf16 v[144:159], v[76:79], v[44:47], v[144:159]
    v_mfma_f32_32x32x16_bf16 a[144:159], v[76:79], a[100:103], a[144:159]
    ds_read_b128 v[76:79], v11 offset:16384
    s_add_u32 s57, s56, 16384
    s_add_u32 m0, s4, 4096
    s_nop 0
    buffer_load_dwordx4 v2, s[8:11], s57 offen lds
    buffer_load_dwordx4 v3, s[8:11], s57 offen offset:1024 lds
    s_waitcnt lgkmcnt(6)
    v_mfma_f32_32x32x16_bf16 v[144:159], v[80:83], v[48:51], v[144:159]
    v_max3_f32 v32, v128, v129, v130
    v_max3_f32 v32, v32, v131, v132
    v_max3_f32 v32, v32, v133, v134
    v_mfma_f32_32x32x16_bf16 a[144:159], v[80:83], a[104:107], a[144:159]
    ds_read_b128 v[80:83], v12 offset:16384
    v_max3_f32 v32, v32, v135, v136
    v_max3_f32 v32, v32, v137, v138
    v_max3_f32 v32, v32, v139, v140
    buffer_load_dwordx4 v4, s[8:11], s57 offen offset:2048 lds
    buffer_load_dwordx4 v5, s[8:11], s57 offen offset:3072 lds
    s_add_u32 s58, s58, 32768
    s_and_b32 s58, s58, 131071
    s_add_u32 s56, s59, s58
    v_mfma_f32_32x32x16_bf16 v[144:159], v[84:87], v[52:55], v[144:159]
    v_max3_f32 v32, v32, v141, v142
    v_max_f32 v32, v32, v143
    v_accvgpr_read_b32 v104, a128
    v_mfma_f32_32x32x16_bf16 a[144:159], v[84:87], a[108:111], a[144:159]
    ds_read_b128 v[84:87], v13 offset:16384
    v_accvgpr_read_b32 v105, a129
    v_accvgpr_read_b32 v106, a130
    v_accvgpr_read_b32 v107, a131
    s_waitcnt lgkmcnt(6)
    v_mfma_f32_32x32x16_bf16 v[144:159], v[88:91], v[56:59], v[144:159]
    v_accvgpr_read_b32 v108, a132
    v_accvgpr_read_b32 v109, a133
    v_accvgpr_read_b32 v110, a134
    v_mfma_f32_32x32x16_bf16 a[144:159], v[88:91], a[112:115], a[144:159]
    ds_read_b128 v[88:91], v14 offset:16384
    v_accvgpr_read_b32 v111, a135
    v_accvgpr_read_b32 v112, a136
    v_accvgpr_read_b32 v113, a137
    v_mfma_f32_32x32x16_bf16 v[144:159], v[92:95], v[60:63], v[144:159]
    v_accvgpr_read_b32 v114, a138
    v_accvgpr_read_b32 v115, a139
    v_accvgpr_read_b32 v116, a140
    v_mfma_f32_32x32x16_bf16 a[144:159], v[92:95], a[116:119], a[144:159]
    ds_read_b128 v[92:95], v15 offset:16384
    v_accvgpr_read_b32 v117, a141
    v_accvgpr_read_b32 v118, a142
    v_accvgpr_read_b32 v119, a143
    s_waitcnt lgkmcnt(6)
    v_mfma_f32_32x32x16_bf16 v[144:159], v[96:99], v[64:67], v[144:159]
    v_max3_f32 v34, v104, v105, v106
    v_max3_f32 v34, v34, v107, v108
    v_max3_f32 v34, v34, v109, v110
    v_mfma_f32_32x32x16_bf16 a[144:159], v[96:99], a[120:123], a[144:159]
    ds_read_b128 v[96:99], v16 offset:16384
    v_max3_f32 v34, v34, v111, v112
    v_max3_f32 v34, v34, v113, v114
    v_max3_f32 v34, v34, v115, v116
    v_mfma_f32_32x32x16_bf16 v[144:159], v[100:103], v[68:71], v[144:159]
    v_max3_f32 v34, v34, v117, v118
    v_max_f32 v34, v34, v119
    v_mfma_f32_32x32x16_bf16 a[144:159], v[100:103], a[124:127], a[144:159]
    ds_read_b128 v[100:103], v17 offset:16384
    s_add_u32 m0, s4, 8192
    s_nop 0
    buffer_load_dwordx4 v2, s[8:11], s56 offen lds
    buffer_load_dwordx4 v3, s[8:11], s56 offen offset:1024 lds
    s_waitcnt vmcnt(10)
    s_waitcnt lgkmcnt(6)
    v_mfma_f32_32x32x16_bf16 v[160:175], v[72:75], v[40:43], 0
    v_mfma_f32_32x32x16_bf16 a[160:175], v[72:75], a[96:99], 0
    ds_read_b128 v[72:75], v10 offset:24576
    buffer_load_dwordx4 v4, s[8:11], s56 offen offset:2048 lds
    buffer_load_dwordx4 v5, s[8:11], s56 offen offset:3072 lds
    v_mfma_f32_32x32x16_bf16 v[160:175], v[76:79], v[44:47], v[160:175]
    v_mfma_f32_32x32x16_bf16 a[160:175], v[76:79], a[100:103], a[160:175]
    ds_read_b128 v[76:79], v11 offset:24576
    s_add_u32 s57, s56, 16384
    s_add_u32 m0, s4, 12288
    s_nop 0
    buffer_load_dwordx4 v2, s[8:11], s57 offen lds
    buffer_load_dwordx4 v3, s[8:11], s57 offen offset:1024 lds
    s_waitcnt lgkmcnt(6)
    v_mfma_f32_32x32x16_bf16 v[160:175], v[80:83], v[48:51], v[160:175]
    v_max3_f32 v32, v32, v144, v145
    v_max3_f32 v32, v32, v146, v147
    v_max3_f32 v32, v32, v148, v149
    v_mfma_f32_32x32x16_bf16 a[160:175], v[80:83], a[104:107], a[160:175]
    ds_read_b128 v[80:83], v12 offset:24576
    v_max3_f32 v32, v32, v150, v151
    v_max3_f32 v32, v32, v152, v153
    v_max3_f32 v32, v32, v154, v155
    buffer_load_dwordx4 v4, s[8:11], s57 offen offset:2048 lds
    buffer_load_dwordx4 v5, s[8:11], s57 offen offset:3072 lds
    s_add_u32 s58, s58, 32768
    s_and_b32 s58, s58, 131071
    s_add_u32 s56, s59, s58
    v_mfma_f32_32x32x16_bf16 v[160:175], v[84:87], v[52:55], v[160:175]
    v_max3_f32 v32, v32, v156, v157
    v_max3_f32 v32, v32, v158, v159
    v_accvgpr_read_b32 v104, a144
    v_mfma_f32_32x32x16_bf16 a[160:175], v[84:87], a[108:111], a[160:175]
    ds_read_b128 v[84:87], v13 offset:24576
    v_accvgpr_read_b32 v105, a145
    v_accvgpr_read_b32 v106, a146
    v_accvgpr_read_b32 v107, a147
    s_waitcnt lgkmcnt(6)
    v_mfma_f32_32x32x16_bf16 v[160:175], v[88:91], v[56:59], v[160:175]
    v_accvgpr_read_b32 v108, a148
    v_accvgpr_read_b32 v109, a149
    v_accvgpr_read_b32 v110, a150
    v_mfma_f32_32x32x16_bf16 a[160:175], v[88:91], a[112:115], a[160:175]
    ds_read_b128 v[88:91], v14 offset:24576
    v_accvgpr_read_b32 v111, a151
    v_accvgpr_read_b32 v112, a152
    v_accvgpr_read_b32 v113, a153
    v_mfma_f32_32x32x16_bf16 v[160:175], v[92:95], v[60:63], v[160:175]
    v_accvgpr_read_b32 v114, a154
    v_accvgpr_read_b32 v115, a155
    v_accvgpr_read_b32 v116, a156
    v_mfma_f32_32x32x16_bf16 a[160:175], v[92:95], a[116:119], a[160:175]
    ds_read_b128 v[92:95], v15 offset:24576
    v_accvgpr_read_b32 v117, a157
    v_accvgpr_read_b32 v118, a158
    v_accvgpr_read_b32 v119, a159
    s_waitcnt lgkmcnt(6)
    v_mfma_f32_32x32x16_bf16 v[160:175], v[96:99], v[64:67], v[160:175]
    v_max3_f32 v34, v34, v104, v105
    v_max3_f32 v34, v34, v106, v107
    v_max3_f32 v34, v34, v108, v109
    v_mfma_f32_32x32x16_bf16 a[160:175], v[96:99], a[120:123], a[160:175]
    ds_read_b128 v[96:99], v16 offset:24576
    v_max3_f32 v34, v34, v110, v111
    v_max3_f32 v34, v34, v112, v113
    v_max3_f32 v34, v34, v114, v115
    v_mfma_f32_32x32x16_bf16 v[160:175], v[100:103], v[68:71], v[160:175]
    v_max3_f32 v34, v34, v116, v117
    v_max3_f32 v34, v34, v118, v119
    v_mfma_f32_32x32x16_bf16 a[160:175], v[100:103], a[124:127], a[160:175]
    ds_read_b128 v[100:103], v17 offset:24576
    s_add_u32 m0, s4, 16384
    s_nop 0
    buffer_load_dwordx4 v2, s[8:11], s56 offen lds
    buffer_load_dwordx4 v3, s[8:11], s56 offen offset:1024 lds
    s_barrier
    s_cmp_lg_u32 s3, 0
    s_cbranch_scc1 L_g2eb
    v_mov_b32 v31, 1
    v_mov_b32 v35, 0
    s_mov_b64 exec, 1
    buffer_store_dword v31, v35, s[44:47], s67 offen sc1
    s_mov_b64 exec, -1
L_g2eb:
    s_waitcnt vmcnt(10)
    s_waitcnt lgkmcnt(6)
    v_mfma_f32_32x32x16_bf16 v[176:191], v[72:75], v[40:43], 0
    v_mfma_f32_32x32x16_bf16 a[176:191], v[72:75], a[96:99], 0
    ds_read_b128 v[72:75], v10 offset:0
    buffer_load_dwordx4 v4, s[8:11], s56 offen offset:2048 lds
    v_mfma_f32_32x32x16_bf16 v[176:191], v[76:79], v[44:47], v[176:191]
    v_mfma_f32_32x32x16_bf16 a[176:191], v[76:79], a[100:103], a[176:191]
    ds_read_b128 v[76:79], v11 offset:0
    buffer_load_dwordx4 v5, s[8:11], s56 offen offset:3072 lds
    s_waitcnt lgkmcnt(6)
    v_mfma_f32_32x32x16_bf16 v[176:191], v[80:83], v[48:51], v[176:191]
    v_max3_f32 v32, v32, v160, v161
    v_max3_f32 v32, v32, v162, v163
    v_max3_f32 v32, v32, v164, v165
    v_mfma_f32_32x32x16_bf16 a[176:191], v[80:83], a[104:107], a[176:191]
    ds_read_b128 v[80:83], v12 offset:0
    v_max3_f32 v32, v32, v166, v167
    v_max3_f32 v32, v32, v168, v169
    v_max3_f32 v32, v32, v170, v171
    s_add_u32 s57, s56, 16384
    s_add_u32 m0, s4, 20480
    s_nop 0
    buffer_load_dwordx4 v2, s[8:11], s57 offen lds
    v_mfma_f32_32x32x16_bf16 v[176:191], v[84:87], v[52:55], v[176:191]
    v_max3_f32 v32, v32, v172, v173
    v_max3_f32 v32, v32, v174, v175
    v_accvgpr_read_b32 v104, a160
    v_mfma_f32_32x32x16_bf16 a[176:191], v[84:87], a[108:111], a[176:191]
    ds_read_b128 v[84:87], v13 offset:0
    v_accvgpr_read_b32 v105, a161
    v_accvgpr_read_b32 v106, a162
    v_accvgpr_read_b32 v107, a163
    buffer_load_dwordx4 v3, s[8:11], s57 offen offset:1024 lds
    s_waitcnt lgkmcnt(6)
    v_mfma_f32_32x32x16_bf16 v[176:191], v[88:91], v[56:59], v[176:191]
    v_accvgpr_read_b32 v108, a164
    v_accvgpr_read_b32 v109, a165
    v_accvgpr_read_b32 v110, a166
    v_mfma_f32_32x32x16_bf16 a[176:191], v[88:91], a[112:115], a[176:191]
    ds_read_b128 v[88:91], v14 offset:0
    v_accvgpr_read_b32 v111, a167
    v_accvgpr_read_b32 v112, a168
    v_accvgpr_read_b32 v113, a169
    buffer_load_dwordx4 v4, s[8:11], s57 offen offset:2048 lds
    v_mfma_f32_32x32x16_bf16 v[176:191], v[92:95], v[60:63], v[176:191]
    v_accvgpr_read_b32 v114, a170
    v_accvgpr_read_b32 v115, a171
    v_accvgpr_read_b32 v116, a172
    v_mfma_f32_32x32x16_bf16 a[176:191], v[92:95], a[116:119], a[176:191]
    ds_read_b128 v[92:95], v15 offset:0
    v_accvgpr_read_b32 v117, a173
    v_accvgpr_read_b32 v118, a174
    v_accvgpr_read_b32 v119, a175
    buffer_load_dwordx4 v5, s[8:11], s57 offen offset:3072 lds
    s_add_u32 s58, s58, 32768
    s_and_b32 s58, s58, 131071
    s_add_u32 s56, s59, s58
    s_waitcnt lgkmcnt(6)
    v_mfma_f32_32x32x16_bf16 v[176:191], v[96:99], v[64:67], v[176:191]
    v_max3_f32 v34, v34, v104, v105
    v_max3_f32 v34, v34, v106, v107
    v_max3_f32 v34, v34, v108, v109
    v_mfma_f32_32x32x16_bf16 a[176:191], v[96:99], a[120:123], a[176:191]
    ds_read_b128 v[96:99], v16 offset:0
    v_max3_f32 v34, v34, v110, v111
    v_max3_f32 v34, v34, v112, v113
    v_max3_f32 v34, v34, v114, v115
    v_mfma_f32_32x32x16_bf16 v[176:191], v[100:103], v[68:71], v[176:191]
    v_max3_f32 v34, v34, v116, v117
    v_max3_f32 v34, v34, v118, v119
    v_mfma_f32_32x32x16_bf16 a[176:191], v[100:103], a[124:127], a[176:191]
    ds_read_b128 v[100:103], v17 offset:0
    s_add_u32 m0, s4, 24576
    s_nop 0
    buffer_load_dwordx4 v2, s[8:11], s56 offen lds
    s_waitcnt vmcnt(9)
    s_waitcnt lgkmcnt(6)
    v_mfma_f32_32x32x16_bf16 v[192:207], v[72:75], v[40:43], 0
    v_mfma_f32_32x32x16_bf16 a[192:207], v[72:75], a[96:99], 0
    ds_read_b128 v[72:75], v10 offset:8192
    buffer_load_dwordx4 v3, s[8:11], s56 offen offset:1024 lds
    v_mfma_f32_32x32x16_bf16 v[192:207], v[76:79], v[44:47], v[192:207]
    v_mfma_f32_32x32x16_bf16 a[192:207], v[76:79], a[100:103], a[192:207]
    ds_read_b128 v[76:79], v11 offset:8192
    buffer_load_dwordx4 v4, s[8:11], s56 offen offset:2048 lds
    s_waitcnt lgkmcnt(6)
    v_mfma_f32_32x32x16_bf16 v[192:207], v[80:83], v[48:51], v[192:207]
    v_max3_f32 v32, v32, v176, v177
    v_max3_f32 v32, v32, v178, v179
    v_max3_f32 v32, v32, v180, v181
    v_mfma_f32_32x32x16_bf16 a[192:207], v[80:83], a[104:107], a[192:207]
    ds_read_b128 v[80:83], v12 offset:8192
    v_max3_f32 v32, v32, v182, v183
    v_max3_f32 v32, v32, v184, v185
    v_max3_f32 v32, v32, v186, v187
    buffer_load_dwordx4 v5, s[8:11], s56 offen offset:3072 lds
    v_mfma_f32_32x32x16_bf16 v[192:207], v[84:87], v[52:55], v[192:207]
    v_max3_f32 v32, v32, v188, v189
    v_max3_f32 v32, v32, v190, v191
    v_accvgpr_read_b32 v104, a176
    v_mfma_f32_32x32x16_bf16 a[192:207], v[84:87], a[108:111], a[192:207]
    ds_read_b128 v[84:87], v13 offset:8192
    v_accvgpr_read_b32 v105, a177
    v_accvgpr_read_b32 v106, a178
    v_accvgpr_read_b32 v107, a179
    s_add_u32 s57, s56, 16384
    s_add_u32 m0, s4, 28672
    s_nop 0
    buffer_load_dwordx4 v2, s[8:11], s57 offen lds
    s_waitcnt lgkmcnt(6)
    v_mfma_f32_32x32x16_bf16 v[192:207], v[88:91], v[56:59], v[192:207]
    v_accvgpr_read_b32 v108, a180
    v_accvgpr_read_b32 v109, a181
    v_accvgpr_read_b32 v110, a182
    v_mfma_f32_32x32x16_bf16 a[192:207], v[88:91], a[112:115], a[192:207]
    ds_read_b128 v[88:91], v14 offset:8192
    v_accvgpr_read_b32 v111, a183
    v_accvgpr_read_b32 v112, a184
    v_accvgpr_read_b32 v113, a185
    buffer_load_dwordx4 v3, s[8:11], s57 offen offset:1024 lds
    v_mfma_f32_32x32x16_bf16 v[192:207], v[92:95], v[60:63], v[192:207]
    v_accvgpr_read_b32 v114, a186
    v_accvgpr_read_b32 v115, a187
    v_accvgpr_read_b32 v116, a188
    v_mfma_f32_32x32x16_bf16 a[192:207], v[92:95], a[116:119], a[192:207]
    ds_read_b128 v[92:95], v15 offset:8192
    v_accvgpr_read_b32 v117, a189
    v_accvgpr_read_b32 v118, a190
    v_accvgpr_read_b32 v119, a191
    buffer_load_dwordx4 v4, s[8:11], s57 offen offset:2048 lds
    s_waitcnt lgkmcnt(6)
    v_mfma_f32_32x32x16_bf16 v[192:207], v[96:99], v[64:67], v[192:207]
    v_max3_f32 v34, v34, v104, v105
    v_max3_f32 v34, v34, v106, v107
    v_max3_f32 v34, v34, v108, v109
    v_mfma_f32_32x32x16_bf16 a[192:207], v[96:99], a[120:123], a[192:207]
    ds_read_b128 v[96:99], v16 offset:8192
    v_max3_f32 v34, v34, v110, v111
    v_max3_f32 v34, v34, v112, v113
    v_max3_f32 v34, v34, v114, v115
    buffer_load_dwordx4 v5, s[8:11], s57 offen offset:3072 lds
    s_add_u32 s58, s58, 32768
    s_and_b32 s58, s58, 131071
    s_add_u32 s56, s59, s58
    v_mfma_f32_32x32x16_bf16 v[192:207], v[100:103], v[68:71], v[192:207]
    v_max3_f32 v34, v34, v116, v117
    v_max3_f32 v34, v34, v118, v119
    v_mfma_f32_32x32x16_bf16 a[192:207], v[100:103], a[124:127], a[192:207]
    ds_read_b128 v[100:103], v17 offset:8192
    s_mov_b32 s12, s20
    s_mov_b32 s13, s21
    s_mov_b32 s14, 8388608
    s_mov_b32 s15, 0x20000
    s_lshl_b32 s63, s50, 2
    s_lshr_b32 s7, s52, 2
    s_add_u32 s63, s63, s7
    s_lshl_b32 s63, s63, 18
    s_lshl_b32 s7, s3, 10
    s_add_u32 s63, s63, s7
    s_and_b32 s62, s52, 3
    s_lshl_b32 s62, s62, 15
    s_add_u32 s60, s63, s62
    s_add_u32 m0, s4, 0
    s_nop 0
    buffer_load_dwordx4 v6, s[12:15], s60 offen lds
    s_waitcnt vmcnt(9)
    s_waitcnt lgkmcnt(6)
    v_mfma_f32_32x32x16_bf16 v[208:223], v[72:75], v[40:43], 0
    v_mfma_f32_32x32x16_bf16 a[208:223], v[72:75], a[96:99], 0
    ds_read_b128 v[72:75], v10 offset:16384
    buffer_load_dwordx4 v7, s[12:15], s60 offen offset:1024 lds
    v_mfma_f32_32x32x16_bf16 v[208:223], v[76:79], v[44:47], v[208:223]
    v_mfma_f32_32x32x16_bf16 a[208:223], v[76:79], a[100:103], a[208:223]
    ds_read_b128 v[76:79], v11 offset:16384
    buffer_load_dwordx4 v8, s[12:15], s60 offen offset:2048 lds
    s_waitcnt lgkmcnt(6)
    v_mfma_f32_32x32x16_bf16 v[208:223], v[80:83], v[48:51], v[208:223]
    v_max3_f32 v32, v32, v192, v193
    v_max3_f32 v32, v32, v194, v195
    v_max3_f32 v32, v32, v196, v197
    v_mfma_f32_32x32x16_bf16 a[208:223], v[80:83], a[104:107], a[208:223]
    ds_read_b128 v[80:83], v12 offset:16384
    v_max3_f32 v32, v32, v198, v199
    v_max3_f32 v32, v32, v200, v201
    v_max3_f32 v32, v32, v202, v203
    buffer_load_dwordx4 v9, s[12:15], s60 offen offset:3072 lds
    v_mfma_f32_32x32x16_bf16 v[208:223], v[84:87], v[52:55], v[208:223]
    v_max3_f32 v32, v32, v204, v205
    v_max3_f32 v32, v32, v206, v207
    v_accvgpr_read_b32 v104, a192
    v_mfma_f32_32x32x16_bf16 a[208:223], v[84:87], a[108:111], a[208:223]
    ds_read_b128 v[84:87], v13 offset:16384
    v_accvgpr_read_b32 v105, a193
    v_accvgpr_read_b32 v106, a194
    v_accvgpr_read_b32 v107, a195
    s_add_u32 s61, s60, 16384
    s_add_u32 m0, s4, 4096
    s_nop 0
    buffer_load_dwordx4 v6, s[12:15], s61 offen lds
    s_waitcnt lgkmcnt(6)
    v_mfma_f32_32x32x16_bf16 v[208:223], v[88:91], v[56:59], v[208:223]
    v_accvgpr_read_b32 v108, a196
    v_accvgpr_read_b32 v109, a197
    v_accvgpr_read_b32 v110, a198
    v_mfma_f32_32x32x16_bf16 a[208:223], v[88:91], a[112:115], a[208:223]
    ds_read_b128 v[88:91], v14 offset:16384
    v_accvgpr_read_b32 v111, a199
    v_accvgpr_read_b32 v112, a200
    v_accvgpr_read_b32 v113, a201
    buffer_load_dwordx4 v7, s[12:15], s61 offen offset:1024 lds
    v_mfma_f32_32x32x16_bf16 v[208:223], v[92:95], v[60:63], v[208:223]
    v_accvgpr_read_b32 v114, a202
    v_accvgpr_read_b32 v115, a203
    v_accvgpr_read_b32 v116, a204
    v_mfma_f32_32x32x16_bf16 a[208:223], v[92:95], a[116:119], a[208:223]
    ds_read_b128 v[92:95], v15 offset:16384
    v_accvgpr_read_b32 v117, a205
    v_accvgpr_read_b32 v118, a206
    v_accvgpr_read_b32 v119, a207
    buffer_load_dwordx4 v8, s[12:15], s61 offen offset:2048 lds
    s_waitcnt lgkmcnt(6)
    v_mfma_f32_32x32x16_bf16 v[208:223], v[96:99], v[64:67], v[208:223]
    v_max3_f32 v34, v34, v104, v105
    v_max3_f32 v34, v34, v106, v107
    v_max3_f32 v34, v34, v108, v109
    v_mfma_f32_32x32x16_bf16 a[208:223], v[96:99], a[120:123], a[208:223]
    ds_read_b128 v[96:99], v16 offset:16384
    v_max3_f32 v34, v34, v110, v111
    v_max3_f32 v34, v34, v112, v113
    v_max3_f32 v34, v34, v114, v115
    buffer_load_dwordx4 v9, s[12:15], s61 offen offset:3072 lds
    s_add_u32 s62, s62, 32768
    s_and_b32 s62, s62, 131071
    s_add_u32 s60, s63, s62
    v_mfma_f32_32x32x16_bf16 v[208:223], v[100:103], v[68:71], v[208:223]
    v_max3_f32 v34, v34, v116, v117
    v_max3_f32 v34, v34, v118, v119
    v_mfma_f32_32x32x16_bf16 a[208:223], v[100:103], a[124:127], a[208:223]
    ds_read_b128 v[100:103], v17 offset:16384
    s_add_u32 m0, s4, 8192
    s_nop 0
    buffer_load_dwordx4 v6, s[12:15], s60 offen lds
    s_waitcnt vmcnt(9)
    s_waitcnt lgkmcnt(6)
    v_mfma_f32_32x32x16_bf16 v[224:239], v[72:75], v[40:43], 0
    v_mfma_f32_32x32x16_bf16 a[224:239], v[72:75], a[96:99], 0
    ds_read_b128 v[72:75], v10 offset:24576
    buffer_load_dwordx4 v7, s[12:15], s60 offen offset:1024 lds
    v_mfma_f32_32x32x16_bf16 v[224:239], v[76:79], v[44:47], v[224:239]
    v_mfma_f32_32x32x16_bf16 a[224:239], v[76:79], a[100:103], a[224:239]
    ds_read_b128 v[76:79], v11 offset:24576
    buffer_load_dwordx4 v8, s[12:15], s60 offen offset:2048 lds
    s_waitcnt lgkmcnt(6)
    v_mfma_f32_32x32x16_bf16 v[224:239], v[80:83], v[48:51], v[224:239]
    v_max3_f32 v32, v32, v208, v209
    v_max3_f32 v32, v32, v210, v211
    v_max3_f32 v32, v32, v212, v213
    v_mfma_f32_32x32x16_bf16 a[224:239], v[80:83], a[104:107], a[224:239]
    ds_read_b128 v[80:83], v12 offset:24576
    v_max3_f32 v32, v32, v214, v215
    v_max3_f32 v32, v32, v216, v217
    v_max3_f32 v32, v32, v218, v219
    buffer_load_dwordx4 v9, s[12:15], s60 offen offset:3072 lds
    v_mfma_f32_32x32x16_bf16 v[224:239], v[84:87], v[52:55], v[224:239]
    v_max3_f32 v32, v32, v220, v221
    v_max3_f32 v32, v32, v222, v223
    v_accvgpr_read_b32 v104, a208
    v_mfma_f32_32x32x16_bf16 a[224:239], v[84:87], a[108:111], a[224:239]
    ds_read_b128 v[84:87], v13 offset:24576
    v_accvgpr_read_b32 v105, a209
    v_accvgpr_read_b32 v106, a210
    v_accvgpr_read_b32 v107, a211
    s_add_u32 s61, s60, 16384
    s_add_u32 m0, s4, 12288
    s_nop 0
    buffer_load_dwordx4 v6, s[12:15], s61 offen lds
    s_waitcnt lgkmcnt(6)
    v_mfma_f32_32x32x16_bf16 v[224:239], v[88:91], v[56:59], v[224:239]
    v_accvgpr_read_b32 v108, a212
    v_accvgpr_read_b32 v109, a213
    v_accvgpr_read_b32 v110, a214
    v_mfma_f32_32x32x16_bf16 a[224:239], v[88:91], a[112:115], a[224:239]
    ds_read_b128 v[88:91], v14 offset:24576
    v_accvgpr_read_b32 v111, a215
    v_accvgpr_read_b32 v112, a216
    v_accvgpr_read_b32 v113, a217
    buffer_load_dwordx4 v7, s[12:15], s61 offen offset:1024 lds
    v_mfma_f32_32x32x16_bf16 v[224:239], v[92:95], v[60:63], v[224:239]
    v_accvgpr_read_b32 v114, a218
    v_accvgpr_read_b32 v115, a219
    v_accvgpr_read_b32 v116, a220
    v_mfma_f32_32x32x16_bf16 a[224:239], v[92:95], a[116:119], a[224:239]
    ds_read_b128 v[92:95], v15 offset:24576
    v_accvgpr_read_b32 v117, a221
    v_accvgpr_read_b32 v118, a222
    v_accvgpr_read_b32 v119, a223
    buffer_load_dwordx4 v8, s[12:15], s61 offen offset:2048 lds
    s_waitcnt lgkmcnt(6)
    v_mfma_f32_32x32x16_bf16 v[224:239], v[96:99], v[64:67], v[224:239]
    v_max3_f32 v34, v34, v104, v105
    v_max3_f32 v34, v34, v106, v107
    v_max3_f32 v34, v34, v108, v109
    v_mfma_f32_32x32x16_bf16 a[224:239], v[96:99], a[120:123], a[224:239]
    ds_read_b128 v[96:99], v16 offset:24576
    v_max3_f32 v34, v34, v110, v111
    v_max3_f32 v34, v34, v112, v113
    v_max3_f32 v34, v34, v114, v115
    buffer_load_dwordx4 v9, s[12:15], s61 offen offset:3072 lds
    s_add_u32 s62, s62, 32768
    s_and_b32 s62, s62, 131071
    s_add_u32 s60, s63, s62
    v_mfma_f32_32x32x16_bf16 v[224:239], v[100:103], v[68:71], v[224:239]
    v_max3_f32 v34, v34, v116, v117
    v_max3_f32 v34, v34, v118, v119
    v_mfma_f32_32x32x16_bf16 a[224:239], v[100:103], a[124:127], a[224:239]
    ds_read_b128 v[100:103], v17 offset:24576
    s_add_u32 m0, s4, 16384
    s_nop 0
    buffer_load_dwordx4 v6, s[12:15], s60 offen lds
    s_waitcnt lgkmcnt(6)
    v_mfma_f32_32x32x16_bf16 v[240:255], v[72:75], v[40:43], 0
    v_mfma_f32_32x32x16_bf16 a[240:255], v[72:75], a[96:99], 0
    buffer_load_dwordx4 v7, s[12:15], s60 offen offset:1024 lds
    v_mfma_f32_32x32x16_bf16 v[240:255], v[76:79], v[44:47], v[240:255]
    v_mfma_f32_32x32x16_bf16 a[240:255], v[76:79], a[100:103], a[240:255]
    buffer_load_dwordx4 v8, s[12:15], s60 offen offset:2048 lds
    s_waitcnt lgkmcnt(4)
    v_mfma_f32_32x32x16_bf16 v[240:255], v[80:83], v[48:51], v[240:255]
    v_max3_f32 v32, v32, v224, v225
    v_max3_f32 v32, v32, v226, v227
    v_max3_f32 v32, v32, v228, v229
    v_mfma_f32_32x32x16_bf16 a[240:255], v[80:83], a[104:107], a[240:255]
    v_max3_f32 v32, v32, v230, v231
    v_max3_f32 v32, v32, v232, v233
    v_max3_f32 v32, v32, v234, v235
    buffer_load_dwordx4 v9, s[12:15], s60 offen offset:3072 lds
    v_mfma_f32_32x32x16_bf16 v[240:255], v[84:87], v[52:55], v[240:255]
    v_max3_f32 v32, v32, v236, v237
    v_max3_f32 v32, v32, v238, v239
    v_accvgpr_read_b32 v104, a224
    v_mfma_f32_32x32x16_bf16 a[240:255], v[84:87], a[108:111], a[240:255]
    v_accvgpr_read_b32 v105, a225
    v_accvgpr_read_b32 v106, a226
    v_accvgpr_read_b32 v107, a227
    s_add_u32 s61, s60, 16384
    s_add_u32 m0, s4, 20480
    s_nop 0
    buffer_load_dwordx4 v6, s[12:15], s61 offen lds
    s_waitcnt lgkmcnt(2)
    v_mfma_f32_32x32x16_bf16 v[240:255], v[88:91], v[56:59], v[240:255]
    v_accvgpr_read_b32 v108, a228
    v_accvgpr_read_b32 v109, a229
    v_accvgpr_read_b32 v110, a230
    v_mfma_f32_32x32x16_bf16 a[240:255], v[88:91], a[112:115], a[240:255]
    v_accvgpr_read_b32 v111, a231
    v_accvgpr_read_b32 v112, a232
    v_accvgpr_read_b32 v113, a233
    buffer_load_dwordx4 v7, s[12:15], s61 offen offset:1024 lds
    v_mfma_f32_32x32x16_bf16 v[240:255], v[92:95], v[60:63], v[240:255]
    v_accvgpr_read_b32 v114, a234
    v_accvgpr_read_b32 v115, a235
    v_accvgpr_read_b32 v116, a236
    v_mfma_f32_32x32x16_bf16 a[240:255], v[92:95], a[116:119], a[240:255]
    v_accvgpr_read_b32 v117, a237
    v_accvgpr_read_b32 v118, a238
    v_accvgpr_read_b32 v119, a239
    buffer_load_dwordx4 v8, s[12:15], s61 offen offset:2048 lds
    s_waitcnt lgkmcnt(0)
    v_mfma_f32_32x32x16_bf16 v[240:255], v[96:99], v[64:67], v[240:255]
    v_max3_f32 v34, v34, v104, v105
    v_max3_f32 v34, v34, v106, v107
    v_max3_f32 v34, v34, v108, v109
    v_mfma_f32_32x32x16_bf16 a[240:255], v[96:99], a[120:123], a[240:255]
    v_max3_f32 v34, v34, v110, v111
    v_max3_f32 v34, v34, v112, v113
    v_max3_f32 v34, v34, v114, v115
    buffer_load_dwordx4 v9, s[12:15], s61 offen offset:3072 lds
    s_add_u32 s62, s62, 32768
    s_and_b32 s62, s62, 131071
    s_add_u32 s60, s63, s62
    v_mfma_f32_32x32x16_bf16 v[240:255], v[100:103], v[68:71], v[240:255]
    v_max3_f32 v34, v34, v116, v117
    v_max3_f32 v34, v34, v118, v119
    v_mfma_f32_32x32x16_bf16 a[240:255], v[100:103], a[124:127], a[240:255]
    s_add_u32 m0, s4, 24576
    s_nop 0
    buffer_load_dwordx4 v6, s[12:15], s60 offen lds
    s_nop 5
    v_max3_f32 v32, v32, v240, v241
    v_max3_f32 v32, v32, v242, v243
    v_max3_f32 v32, v32, v244, v245
    v_max3_f32 v32, v32, v246, v247
    v_max3_f32 v32, v32, v248, v249
    v_max3_f32 v32, v32, v250, v251
    v_max3_f32 v32, v32, v252, v253
    v_max3_f32 v32, v32, v254, v255
    v_accvgpr_read_b32 v104, a240
    v_accvgpr_read_b32 v105, a241
    v_accvgpr_read_b32 v106, a242
    v_accvgpr_read_b32 v107, a243
    v_accvgpr_read_b32 v108, a244
    v_accvgpr_read_b32 v109, a245
    v_accvgpr_read_b32 v110, a246
    v_accvgpr_read_b32 v111, a247
    v_accvgpr_read_b32 v112, a248
    v_accvgpr_read_b32 v113, a249
    v_accvgpr_read_b32 v114, a250
    v_accvgpr_read_b32 v115, a251
    v_accvgpr_read_b32 v116, a252
    v_accvgpr_read_b32 v117, a253
    v_accvgpr_read_b32 v118, a254
    v_accvgpr_read_b32 v119, a255
    v_max3_f32 v34, v34, v104, v105
    v_max3_f32 v34, v34, v106, v107
    v_max3_f32 v34, v34, v108, v109
    v_max3_f32 v34, v34, v110, v111
    v_max3_f32 v34, v34, v112, v113
    v_max3_f32 v34, v34, v114, v115
    v_max3_f32 v34, v34, v116, v117
    v_max3_f32 v34, v34, v118, v119
    v_mov_b32 v33, v32
    s_nop 1
    v_permlane32_swap_b32 v32, v33
    v_max_f32 v32, v32, v33
    v_mul_f32 v32, -0.5, v32
    v_cvt_pk_bf16_f32 v33, v32, v32
    v_lshlrev_b32 v33, 16, v33
    v_sub_f32 v32, v32, v33
    v_cvt_pk_bf16_f32 v10, v33, v32
    v_and_b32 v32, 0xffff0000, v10
    v_add_f32 v32, v32, v33
    v_mul_f32 v32, -2.0, v32
    v_mov_b32 v11, 0
    v_mov_b32 v12, 0
    v_mov_b32 v13, 0
    v_mov_b32 v35, v34
    s_nop 1
    v_permlane32_swap_b32 v34, v35
    v_max_f32 v34, v34, v35
    v_mul_f32 v34, -0.5, v34
    v_cvt_pk_bf16_f32 v35, v34, v34
    v_lshlrev_b32 v35, 16, v35
    v_sub_f32 v34, v34, v35
    v_cvt_pk_bf16_f32 v14, v35, v34
    v_and_b32 v34, 0xffff0000, v14
    v_add_f32 v34, v34, v35
    v_mul_f32 v34, -2.0, v34
    v_mov_b32 v15, 0
    v_mov_b32 v16, 0
    v_mov_b32 v17, 0
L_gv:
    v_mfma_f32_32x32x16_bf16 v[128:143], v[36:39], v[10:13], v[128:143]
    s_nop 0
    v_mfma_f32_32x32x16_bf16 a[128:143], v[36:39], v[14:17], a[128:143]
    v_mfma_f32_32x32x16_bf16 v[144:159], v[36:39], v[10:13], v[144:159]
    v_mfma_f32_32x32x16_bf16 a[144:159], v[36:39], v[14:17], a[144:159]
    s_waitcnt vmcnt(17)
    ds_read_b64_tr_b16 v[72:73], v18 offset:0
    ds_read_b64_tr_b16 v[74:75], v18 offset:2048
    ds_read_b64_tr_b16 v[76:77], v18 offset:4096
    ds_read_b64_tr_b16 v[78:79], v18 offset:6144
    ds_read_b64_tr_b16 v[80:81], v19 offset:0
    ds_read_b64_tr_b16 v[82:83], v19 offset:2048
    ds_read_b64_tr_b16 v[84:85], v19 offset:4096
    ds_read_b64_tr_b16 v[86:87], v19 offset:6144
    ds_read_b64_tr_b16 v[88:89], v20 offset:0
    ds_read_b64_tr_b16 v[90:91], v20 offset:2048
    ds_read_b64_tr_b16 v[92:93], v20 offset:4096
    ds_read_b64_tr_b16 v[94:95], v20 offset:6144
    ds_read_b64_tr_b16 v[96:97], v21 offset:0
    ds_read_b64_tr_b16 v[98:99], v21 offset:2048
    ds_read_b64_tr_b16 v[100:101], v21 offset:4096
    ds_read_b64_tr_b16 v[102:103], v21 offset:6144
    v_accvgpr_read_b32 v104, a128
    v_accvgpr_read_b32 v105, a129
    v_accvgpr_read_b32 v106, a130
    v_accvgpr_read_b32 v107, a131
    v_accvgpr_read_b32 v108, a132
    v_accvgpr_read_b32 v109, a133
    v_accvgpr_read_b32 v110, a134
    v_accvgpr_read_b32 v111, a135
    v_accvgpr_read_b32 v120, a136
    v_accvgpr_read_b32 v121, a137
    v_accvgpr_read_b32 v122, a138
    v_accvgpr_read_b32 v123, a139
    v_accvgpr_read_b32 v124, a140
    v_accvgpr_read_b32 v125, a141
    v_accvgpr_read_b32 v126, a142
    v_accvgpr_read_b32 v127, a143
    v_exp_f32 v128, v128
    v_exp_f32 v129, v129
    v_exp_f32 v130, v130
    v_exp_f32 v131, v131
    v_exp_f32 v132, v132
    v_exp_f32 v133, v133
    v_exp_f32 v134, v134
    v_exp_f32 v135, v135
    v_exp_f32 v136, v136
    v_exp_f32 v137, v137
    v_exp_f32 v138, v138
    v_exp_f32 v139, v139
    v_exp_f32 v140, v140
    v_exp_f32 v141, v141
    v_exp_f32 v142, v142
    v_exp_f32 v143, v143
    v_cvt_pk_bf16_f32 v128, v128, v129
    v_cvt_pk_bf16_f32 v129, v130, v131
    v_cvt_pk_bf16_f32 v130, v132, v133
    v_cvt_pk_bf16_f32 v131, v134, v135
    v_cvt_pk_bf16_f32 v132, v136, v137
    v_cvt_pk_bf16_f32 v133, v138, v139
    v_cvt_pk_bf16_f32 v134, v140, v141
    v_cvt_pk_bf16_f32 v135, v142, v143
    v_exp_f32 v104, v104
    v_exp_f32 v105, v105
    v_exp_f32 v106, v106
    v_exp_f32 v107, v107
    v_exp_f32 v108, v108
    v_exp_f32 v109, v109
    v_exp_f32 v110, v110
    v_exp_f32 v111, v111
    v_exp_f32 v120, v120
    v_exp_f32 v121, v121
    v_exp_f32 v122, v122
    v_exp_f32 v123, v123
    v_exp_f32 v124, v124
    v_exp_f32 v125, v125
    v_exp_f32 v126, v126
    v_exp_f32 v127, v127
    v_cvt_pk_bf16_f32 v104, v104, v105
    v_cvt_pk_bf16_f32 v105, v106, v107
    v_cvt_pk_bf16_f32 v106, v108, v109
    v_cvt_pk_bf16_f32 v107, v110, v111
    v_cvt_pk_bf16_f32 v108, v120, v121
    v_cvt_pk_bf16_f32 v109, v122, v123
    v_cvt_pk_bf16_f32 v110, v124, v125
    v_cvt_pk_bf16_f32 v111, v126, v127
    s_waitcnt vmcnt(9)
    s_waitcnt lgkmcnt(12)
    v_mfma_f32_32x32x16_bf16 a[0:15], v[72:75], v[128:131], 0
    buffer_load_dwordx4 v7, s[12:15], s60 offen offset:1024 lds
    buffer_load_dwordx4 v8, s[12:15], s60 offen offset:2048 lds
    v_accvgpr_read_b32 v112, a144
    v_accvgpr_read_b32 v113, a145
    v_accvgpr_read_b32 v114, a146
    v_accvgpr_read_b32 v115, a147
    v_accvgpr_read_b32 v116, a148
    v_mfma_f32_32x32x16_bf16 v[40:55], v[72:75], v[104:107], 0
    v_accvgpr_read_b32 v117, a149
    v_accvgpr_read_b32 v118, a150
    v_accvgpr_read_b32 v119, a151
    v_accvgpr_read_b32 v120, a152
    v_accvgpr_read_b32 v121, a153
    v_accvgpr_read_b32 v122, a154
    v_accvgpr_read_b32 v123, a155
    v_mfma_f32_32x32x16_bf16 a[0:15], v[76:79], v[132:135], a[0:15]
    buffer_load_dwordx4 v9, s[12:15], s60 offen offset:3072 lds
    s_add_u32 s61, s60, 16384
    s_add_u32 m0, s4, 28672
    s_nop 0
    buffer_load_dwordx4 v6, s[12:15], s61 offen lds
    v_accvgpr_read_b32 v124, a156
    v_accvgpr_read_b32 v125, a157
    v_mfma_f32_32x32x16_bf16 v[40:55], v[76:79], v[108:111], v[40:55]
    ds_read_b64_tr_b16 v[72:73], v18 offset:8192
    ds_read_b64_tr_b16 v[74:75], v18 offset:10240
    ds_read_b64_tr_b16 v[76:77], v18 offset:12288
    ds_read_b64_tr_b16 v[78:79], v18 offset:14336
    v_accvgpr_read_b32 v126, a158
    v_accvgpr_read_b32 v127, a159
    v_mfma_f32_16x16x32_bf16 a[64:67], v[26:29], v[128:131], 0
    v_exp_f32 v144, v144
    s_waitcnt lgkmcnt(12)
    v_mfma_f32_32x32x16_bf16 a[16:31], v[80:83], v[128:131], 0
    buffer_load_dwordx4 v7, s[12:15], s61 offen offset:1024 lds
    buffer_load_dwordx4 v8, s[12:15], s61 offen offset:2048 lds
    v_exp_f32 v145, v145
    v_exp_f32 v146, v146
    v_mfma_f32_32x32x16_bf16 v[56:71], v[80:83], v[104:107], 0
    v_exp_f32 v147, v147
    v_exp_f32 v148, v148
    v_exp_f32 v149, v149
    v_mfma_f32_32x32x16_bf16 a[16:31], v[84:87], v[132:135], a[16:31]
    buffer_load_dwordx4 v9, s[12:15], s61 offen offset:3072 lds
    s_add_u32 s62, s62, 32768
    s_and_b32 s62, s62, 131071
    s_add_u32 s60, s63, s62
    v_exp_f32 v150, v150
    v_mfma_f32_32x32x16_bf16 v[56:71], v[84:87], v[108:111], v[56:71]
    ds_read_b64_tr_b16 v[80:81], v19 offset:8192
    ds_read_b64_tr_b16 v[82:83], v19 offset:10240
    ds_read_b64_tr_b16 v[84:85], v19 offset:12288
    ds_read_b64_tr_b16 v[86:87], v19 offset:14336
    v_exp_f32 v151, v151
    v_mfma_f32_16x16x32_bf16 a[80:83], v[26:29], v[104:107], 0
    v_exp_f32 v152, v152
    v_mfma_f32_32x32x16_bf16 a[160:175], v[36:39], v[14:17], a[160:175]
    v_exp_f32 v153, v153
    v_exp_f32 v154, v154
    v_exp_f32 v155, v155
    s_waitcnt lgkmcnt(12)
    v_mfma_f32_32x32x16_bf16 a[32:47], v[88:91], v[128:131], 0
    v_exp_f32 v156, v156
    v_exp_f32 v157, v157
    v_exp_f32 v158, v158
    v_mfma_f32_32x32x16_bf16 a[96:111], v[88:91], v[104:107], 0
    v_exp_f32 v159, v159
    v_cvt_pk_bf16_f32 v144, v144, v145
    v_cvt_pk_bf16_f32 v145, v146, v147
    v_cvt_pk_bf16_f32 v146, v148, v149
    v_cvt_pk_bf16_f32 v147, v150, v151
    v_cvt_pk_bf16_f32 v148, v152, v153
    v_mfma_f32_32x32x16_bf16 a[32:47], v[92:95], v[132:135], a[32:47]
    v_cvt_pk_bf16_f32 v149, v154, v155
    v_cvt_pk_bf16_f32 v150, v156, v157
    v_cvt_pk_bf16_f32 v151, v158, v159
    v_exp_f32 v112, v112
    v_exp_f32 v113, v113
    v_mfma_f32_32x32x16_bf16 a[96:111], v[92:95], v[108:111], a[96:111]
    ds_read_b64_tr_b16 v[88:89], v20 offset:8192
    ds_read_b64_tr_b16 v[90:91], v20 offset:10240
    ds_read_b64_tr_b16 v[92:93], v20 offset:12288
    ds_read_b64_tr_b16 v[94:95], v20 offset:14336
    v_exp_f32 v114, v114
    v_mfma_f32_16x16x32_bf16 a[64:67], v[26:29], v[132:135], a[64:67]
    v_exp_f32 v115, v115
    s_waitcnt lgkmcnt(12)
    v_mfma_f32_32x32x16_bf16 a[48:63], v[96:99], v[128:131], 0
    s_add_u32 s63, s63, 131072
    s_add_u32 s60, s60, 131072
    s_add_u32 m0, s4, 0
    s_nop 0
    buffer_load_dwordx4 v6, s[12:15], s60 offen lds
    buffer_load_dwordx4 v7, s[12:15], s60 offen offset:1024 lds
    v_mfma_f32_32x32x16_bf16 a[112:127], v[96:99], v[104:107], 0
    v_exp_f32 v116, v116
    v_exp_f32 v117, v117
    v_exp_f32 v118, v118
    v_mfma_f32_32x32x16_bf16 a[48:63], v[100:103], v[132:135], a[48:63]
    buffer_load_dwordx4 v8, s[12:15], s60 offen offset:2048 lds
    buffer_load_dwordx4 v9, s[12:15], s60 offen offset:3072 lds
    v_exp_f32 v119, v119
    v_exp_f32 v120, v120
    v_mfma_f32_32x32x16_bf16 a[112:127], v[100:103], v[108:111], a[112:127]
    ds_read_b64_tr_b16 v[96:97], v21 offset:8192
    ds_read_b64_tr_b16 v[98:99], v21 offset:10240
    ds_read_b64_tr_b16 v[100:101], v21 offset:12288
    ds_read_b64_tr_b16 v[102:103], v21 offset:14336
    v_exp_f32 v121, v121
    v_mfma_f32_16x16x32_bf16 a[80:83], v[26:29], v[108:111], a[80:83]
    v_exp_f32 v122, v122
    v_mfma_f32_32x32x16_bf16 v[160:175], v[36:39], v[10:13], v[160:175]
    v_exp_f32 v123, v123
    v_exp_f32 v124, v124
    v_exp_f32 v125, v125
    v_exp_f32 v126, v126
    v_exp_f32 v127, v127
    v_cvt_pk_bf16_f32 v112, v112, v113
    v_cvt_pk_bf16_f32 v113, v114, v115
    v_cvt_pk_bf16_f32 v114, v116, v117
    v_cvt_pk_bf16_f32 v115, v118, v119
    v_cvt_pk_bf16_f32 v116, v120, v121
    v_cvt_pk_bf16_f32 v117, v122, v123
    v_cvt_pk_bf16_f32 v118, v124, v125
    v_cvt_pk_bf16_f32 v119, v126, v127
    s_waitcnt vmcnt(12)
    s_waitcnt lgkmcnt(12)
    v_mfma_f32_32x32x16_bf16 a[0:15], v[72:75], v[144:147], a[0:15]
    s_add_u32 s61, s60, 16384
    s_add_u32 m0, s4, 4096
    s_nop 0
    buffer_load_dwordx4 v6, s[12:15], s61 offen lds
    buffer_load_dwordx4 v7, s[12:15], s61 offen offset:1024 lds
    v_accvgpr_read_b32 v104, a160
    v_accvgpr_read_b32 v105, a161
    v_mfma_f32_32x32x16_bf16 v[40:55], v[72:75], v[112:115], v[40:55]
    v_accvgpr_read_b32 v106, a162
    v_accvgpr_read_b32 v107, a163
    v_accvgpr_read_b32 v108, a164
    v_accvgpr_read_b32 v109, a165
    v_accvgpr_read_b32 v110, a166
    v_accvgpr_read_b32 v111, a167
    v_accvgpr_read_b32 v120, a168
    v_mfma_f32_32x32x16_bf16 a[0:15], v[76:79], v[148:151], a[0:15]
    buffer_load_dwordx4 v8, s[12:15], s61 offen offset:2048 lds
    buffer_load_dwordx4 v9, s[12:15], s61 offen offset:3072 lds
    s_add_u32 s62, s62, 32768
    s_and_b32 s62, s62, 131071
    s_add_u32 s60, s63, s62
    v_accvgpr_read_b32 v121, a169
    v_mfma_f32_32x32x16_bf16 v[40:55], v[76:79], v[116:119], v[40:55]
    ds_read_b64_tr_b16 v[72:73], v18 offset:16384
    ds_read_b64_tr_b16 v[74:75], v18 offset:18432
    ds_read_b64_tr_b16 v[76:77], v18 offset:20480
    ds_read_b64_tr_b16 v[78:79], v18 offset:22528
    v_accvgpr_read_b32 v122, a170
    v_accvgpr_read_b32 v123, a171
    v_accvgpr_read_b32 v124, a172
    v_mfma_f32_16x16x32_bf16 a[64:67], v[26:29], v[144:147], a[64:67]
    v_accvgpr_read_b32 v125, a173
    v_accvgpr_read_b32 v126, a174
    s_waitcnt lgkmcnt(12)
    v_mfma_f32_32x32x16_bf16 a[16:31], v[80:83], v[144:147], a[16:31]
    v_accvgpr_read_b32 v127, a175
    v_exp_f32 v160, v160
    v_exp_f32 v161, v161
    v_exp_f32 v162, v162
    v_mfma_f32_32x32x16_bf16 v[56:71], v[80:83], v[112:115], v[56:71]
    v_exp_f32 v163, v163
    v_exp_f32 v164, v164
    v_exp_f32 v165, v165
    v_mfma_f32_32x32x16_bf16 a[16:31], v[84:87], v[148:151], a[16:31]
    v_exp_f32 v166, v166
    v_exp_f32 v167, v167
    v_exp_f32 v168, v168
    v_mfma_f32_32x32x16_bf16 v[56:71], v[84:87], v[116:119], v[56:71]
    ds_read_b64_tr_b16 v[80:81], v19 offset:16384
    ds_read_b64_tr_b16 v[82:83], v19 offset:18432
    ds_read_b64_tr_b16 v[84:85], v19 offset:20480
    ds_read_b64_tr_b16 v[86:87], v19 offset:22528
    v_exp_f32 v169, v169
    v_mfma_f32_16x16x32_bf16 a[80:83], v[26:29], v[112:115], a[80:83]
    v_exp_f32 v170, v170
    v_mfma_f32_32x32x16_bf16 a[176:191], v[36:39], v[14:17], a[176:191]
    v_exp_f32 v171, v171
    v_exp_f32 v172, v172
    v_exp_f32 v173, v173
    s_waitcnt lgkmcnt(12)
    v_mfma_f32_32x32x16_bf16 a[32:47], v[88:91], v[144:147], a[32:47]
    v_exp_f32 v174, v174
    v_exp_f32 v175, v175
    v_cvt_pk_bf16_f32 v160, v160, v161
    v_cvt_pk_bf16_f32 v161, v162, v163
    v_cvt_pk_bf16_f32 v162, v164, v165
    v_mfma_f32_32x32x16_bf16 a[96:111], v[88:91], v[112:115], a[96:111]
    v_cvt_pk_bf16_f32 v163, v166, v167
    v_cvt_pk_bf16_f32 v164, v168, v169
    v_cvt_pk_bf16_f32 v165, v170, v171
    v_cvt_pk_bf16_f32 v166, v172, v173
    v_cvt_pk_bf16_f32 v167, v174, v175
    v_exp_f32 v104, v104
    v_mfma_f32_32x32x16_bf16 a[32:47], v[92:95], v[148:151], a[32:47]
    v_exp_f32 v105, v105
    v_exp_f32 v106, v106
    v_exp_f32 v107, v107
    v_mfma_f32_32x32x16_bf16 a[96:111], v[92:95], v[116:119], a[96:111]
    ds_read_b64_tr_b16 v[88:89], v20 offset:16384
    ds_read_b64_tr_b16 v[90:91], v20 offset:18432
    ds_read_b64_tr_b16 v[92:93], v20 offset:20480
    ds_read_b64_tr_b16 v[94:95], v20 offset:22528
    v_exp_f32 v108, v108
    v_mfma_f32_16x16x32_bf16 a[64:67], v[26:29], v[148:151], a[64:67]
    v_exp_f32 v109, v109
    s_waitcnt lgkmcnt(12)
    v_mfma_f32_32x32x16_bf16 a[48:63], v[96:99], v[144:147], a[48:63]
    s_add_u32 m0, s4, 8192
    s_nop 0
    buffer_load_dwordx4 v6, s[12:15], s60 offen lds
    buffer_load_dwordx4 v7, s[12:15], s60 offen offset:1024 lds
    v_exp_f32 v110, v110
    v_mfma_f32_32x32x16_bf16 a[112:127], v[96:99], v[112:115], a[112:127]
    v_exp_f32 v111, v111
    v_exp_f32 v120, v120
    v_exp_f32 v121, v121
    v_mfma_f32_32x32x16_bf16 a[48:63], v[100:103], v[148:151], a[48:63]
    buffer_load_dwordx4 v8, s[12:15], s60 offen offset:2048 lds
    buffer_load_dwordx4 v9, s[12:15], s60 offen offset:3072 lds
    v_exp_f32 v122, v122
    v_exp_f32 v123, v123
    v_mfma_f32_32x32x16_bf16 a[112:127], v[100:103], v[116:119], a[112:127]
    ds_read_b64_tr_b16 v[96:97], v21 offset:16384
    ds_read_b64_tr_b16 v[98:99], v21 offset:18432
    ds_read_b64_tr_b16 v[100:101], v21 offset:20480
    ds_read_b64_tr_b16 v[102:103], v21 offset:22528
    v_exp_f32 v124, v124
    v_mfma_f32_16x16x32_bf16 a[80:83], v[26:29], v[116:119], a[80:83]
    v_exp_f32 v125, v125
    v_mfma_f32_32x32x16_bf16 v[176:191], v[36:39], v[10:13], v[176:191]
    v_exp_f32 v126, v126
    v_exp_f32 v127, v127
    v_cvt_pk_bf16_f32 v104, v104, v105
    v_cvt_pk_bf16_f32 v105, v106, v107
    v_cvt_pk_bf16_f32 v106, v108, v109
    v_cvt_pk_bf16_f32 v107, v110, v111
    v_cvt_pk_bf16_f32 v108, v120, v121
    v_cvt_pk_bf16_f32 v109, v122, v123
    v_cvt_pk_bf16_f32 v110, v124, v125
    v_cvt_pk_bf16_f32 v111, v126, v127
    s_waitcnt vmcnt(12)
    s_waitcnt lgkmcnt(12)
    v_mfma_f32_32x32x16_bf16 a[0:15], v[72:75], v[160:163], a[0:15]
    s_add_u32 s61, s60, 16384
    s_add_u32 m0, s4, 12288
    s_nop 0
    buffer_load_dwordx4 v6, s[12:15], s61 offen lds
    buffer_load_dwordx4 v7, s[12:15], s61 offen offset:1024 lds
    v_accvgpr_read_b32 v112, a176
    v_accvgpr_read_b32 v113, a177
    v_mfma_f32_32x32x16_bf16 v[40:55], v[72:75], v[104:107], v[40:55]
    v_accvgpr_read_b32 v114, a178
    v_accvgpr_read_b32 v115, a179
    v_accvgpr_read_b32 v116, a180
    v_accvgpr_read_b32 v117, a181
    v_accvgpr_read_b32 v118, a182
    v_accvgpr_read_b32 v119, a183
    v_accvgpr_read_b32 v120, a184
    v_mfma_f32_32x32x16_bf16 a[0:15], v[76:79], v[164:167], a[0:15]
    buffer_load_dwordx4 v8, s[12:15], s61 offen offset:2048 lds
    buffer_load_dwordx4 v9, s[12:15], s61 offen offset:3072 lds
    s_add_u32 s62, s62, 32768
    s_and_b32 s62, s62, 131071
    s_add_u32 s60, s63, s62
    v_accvgpr_read_b32 v121, a185
    v_mfma_f32_32x32x16_bf16 v[40:55], v[76:79], v[108:111], v[40:55]
    ds_read_b64_tr_b16 v[72:73], v18 offset:24576
    ds_read_b64_tr_b16 v[74:75], v18 offset:26624
    ds_read_b64_tr_b16 v[76:77], v18 offset:28672
    ds_read_b64_tr_b16 v[78:79], v18 offset:30720
    v_accvgpr_read_b32 v122, a186
    v_accvgpr_read_b32 v123, a187
    v_accvgpr_read_b32 v124, a188
    v_mfma_f32_16x16x32_bf16 a[64:67], v[26:29], v[160:163], a[64:67]
    v_accvgpr_read_b32 v125, a189
    v_accvgpr_read_b32 v126, a190
    s_waitcnt lgkmcnt(12)
    v_mfma_f32_32x32x16_bf16 a[16:31], v[80:83], v[160:163], a[16:31]
    v_accvgpr_read_b32 v127, a191
    v_exp_f32 v176, v176
    v_exp_f32 v177, v177
    v_exp_f32 v178, v178
    v_mfma_f32_32x32x16_bf16 v[56:71], v[80:83], v[104:107], v[56:71]
    v_exp_f32 v179, v179
    v_exp_f32 v180, v180
    v_exp_f32 v181, v181
    v_mfma_f32_32x32x16_bf16 a[16:31], v[84:87], v[164:167], a[16:31]
    v_exp_f32 v182, v182
    v_exp_f32 v183, v183
    v_exp_f32 v184, v184
    v_mfma_f32_32x32x16_bf16 v[56:71], v[84:87], v[108:111], v[56:71]
    ds_read_b64_tr_b16 v[80:81], v19 offset:24576
    ds_read_b64_tr_b16 v[82:83], v19 offset:26624
    ds_read_b64_tr_b16 v[84:85], v19 offset:28672
    ds_read_b64_tr_b16 v[86:87], v19 offset:30720
    v_exp_f32 v185, v185
    v_mfma_f32_16x16x32_bf16 a[80:83], v[26:29], v[104:107], a[80:83]
    v_exp_f32 v186, v186
    v_mfma_f32_32x32x16_bf16 a[192:207], v[36:39], v[14:17], a[192:207]
    v_exp_f32 v187, v187
    v_exp_f32 v188, v188
    v_exp_f32 v189, v189
    s_waitcnt lgkmcnt(12)
    v_mfma_f32_32x32x16_bf16 a[32:47], v[88:91], v[160:163], a[32:47]
    v_exp_f32 v190, v190
    v_exp_f32 v191, v191
    v_cvt_pk_bf16_f32 v176, v176, v177
    v_cvt_pk_bf16_f32 v177, v178, v179
    v_cvt_pk_bf16_f32 v178, v180, v181
    v_mfma_f32_32x32x16_bf16 a[96:111], v[88:91], v[104:107], a[96:111]
    v_cvt_pk_bf16_f32 v179, v182, v183
    v_cvt_pk_bf16_f32 v180, v184, v185
    v_cvt_pk_bf16_f32 v181, v186, v187
    v_cvt_pk_bf16_f32 v182, v188, v189
    v_cvt_pk_bf16_f32 v183, v190, v191
    v_exp_f32 v112, v112
    v_mfma_f32_32x32x16_bf16 a[32:47], v[92:95], v[164:167], a[32:47]
    v_exp_f32 v113, v113
    v_exp_f32 v114, v114
    v_exp_f32 v115, v115
    v_mfma_f32_32x32x16_bf16 a[96:111], v[92:95], v[108:111], a[96:111]
    ds_read_b64_tr_b16 v[88:89], v20 offset:24576
    ds_read_b64_tr_b16 v[90:91], v20 offset:26624
    ds_read_b64_tr_b16 v[92:93], v20 offset:28672
    ds_read_b64_tr_b16 v[94:95], v20 offset:30720
    v_exp_f32 v116, v116
    v_mfma_f32_16x16x32_bf16 a[64:67], v[26:29], v[164:167], a[64:67]
    v_exp_f32 v117, v117
    s_waitcnt lgkmcnt(12)
    v_mfma_f32_32x32x16_bf16 a[48:63], v[96:99], v[160:163], a[48:63]
    s_add_u32 m0, s4, 16384
    s_nop 0
    buffer_load_dwordx4 v6, s[12:15], s60 offen lds
    buffer_load_dwordx4 v7, s[12:15], s60 offen offset:1024 lds
    v_exp_f32 v118, v118
    v_mfma_f32_32x32x16_bf16 a[112:127], v[96:99], v[104:107], a[112:127]
    v_exp_f32 v119, v119
    v_exp_f32 v120, v120
    v_exp_f32 v121, v121
    v_mfma_f32_32x32x16_bf16 a[48:63], v[100:103], v[164:167], a[48:63]
    buffer_load_dwordx4 v8, s[12:15], s60 offen offset:2048 lds
    buffer_load_dwordx4 v9, s[12:15], s60 offen offset:3072 lds
    v_exp_f32 v122, v122
    v_exp_f32 v123, v123
    v_mfma_f32_32x32x16_bf16 a[112:127], v[100:103], v[108:111], a[112:127]
    ds_read_b64_tr_b16 v[96:97], v21 offset:24576
    ds_read_b64_tr_b16 v[98:99], v21 offset:26624
    ds_read_b64_tr_b16 v[100:101], v21 offset:28672
    ds_read_b64_tr_b16 v[102:103], v21 offset:30720
    v_exp_f32 v124, v124
    v_mfma_f32_16x16x32_bf16 a[80:83], v[26:29], v[108:111], a[80:83]
    v_exp_f32 v125, v125
    v_mfma_f32_32x32x16_bf16 v[192:207], v[36:39], v[10:13], v[192:207]
    v_exp_f32 v126, v126
    v_exp_f32 v127, v127
    v_cvt_pk_bf16_f32 v112, v112, v113
    v_cvt_pk_bf16_f32 v113, v114, v115
    v_cvt_pk_bf16_f32 v114, v116, v117
    v_cvt_pk_bf16_f32 v115, v118, v119
    v_cvt_pk_bf16_f32 v116, v120, v121
    v_cvt_pk_bf16_f32 v117, v122, v123
    v_cvt_pk_bf16_f32 v118, v124, v125
    v_cvt_pk_bf16_f32 v119, v126, v127
    s_waitcnt vmcnt(12)
    s_waitcnt lgkmcnt(12)
    v_mfma_f32_32x32x16_bf16 a[0:15], v[72:75], v[176:179], a[0:15]
    s_add_u32 s61, s60, 16384
    s_add_u32 m0, s4, 20480
    s_nop 0
    buffer_load_dwordx4 v6, s[12:15], s61 offen lds
    buffer_load_dwordx4 v7, s[12:15], s61 offen offset:1024 lds
    v_accvgpr_read_b32 v104, a192
    v_accvgpr_read_b32 v105, a193
    v_mfma_f32_32x32x16_bf16 v[40:55], v[72:75], v[112:115], v[40:55]
    v_accvgpr_read_b32 v106, a194
    v_accvgpr_read_b32 v107, a195
    v_accvgpr_read_b32 v108, a196
    v_accvgpr_read_b32 v109, a197
    v_accvgpr_read_b32 v110, a198
    v_accvgpr_read_b32 v111, a199
    v_accvgpr_read_b32 v120, a200
    v_mfma_f32_32x32x16_bf16 a[0:15], v[76:79], v[180:183], a[0:15]
    buffer_load_dwordx4 v8, s[12:15], s61 offen offset:2048 lds
    buffer_load_dwordx4 v9, s[12:15], s61 offen offset:3072 lds
    s_add_u32 s62, s62, 32768
    s_and_b32 s62, s62, 131071
    s_add_u32 s60, s63, s62
    v_accvgpr_read_b32 v121, a201
    v_mfma_f32_32x32x16_bf16 v[40:55], v[76:79], v[116:119], v[40:55]
    ds_read_b64_tr_b16 v[72:73], v18 offset:0
    ds_read_b64_tr_b16 v[74:75], v18 offset:2048
    ds_read_b64_tr_b16 v[76:77], v18 offset:4096
    ds_read_b64_tr_b16 v[78:79], v18 offset:6144
    v_accvgpr_read_b32 v122, a202
    v_accvgpr_read_b32 v123, a203
    v_accvgpr_read_b32 v124, a204
    v_mfma_f32_16x16x32_bf16 a[64:67], v[26:29], v[176:179], a[64:67]
    v_accvgpr_read_b32 v125, a205
    v_accvgpr_read_b32 v126, a206
    s_waitcnt lgkmcnt(12)
    v_mfma_f32_32x32x16_bf16 a[16:31], v[80:83], v[176:179], a[16:31]
    v_accvgpr_read_b32 v127, a207
    v_exp_f32 v192, v192
    v_exp_f32 v193, v193
    v_exp_f32 v194, v194
    v_mfma_f32_32x32x16_bf16 v[56:71], v[80:83], v[112:115], v[56:71]
    v_exp_f32 v195, v195
    v_exp_f32 v196, v196
    v_exp_f32 v197, v197
    v_mfma_f32_32x32x16_bf16 a[16:31], v[84:87], v[180:183], a[16:31]
    v_exp_f32 v198, v198
    v_exp_f32 v199, v199
    v_exp_f32 v200, v200
    v_mfma_f32_32x32x16_bf16 v[56:71], v[84:87], v[116:119], v[56:71]
    ds_read_b64_tr_b16 v[80:81], v19 offset:0
    ds_read_b64_tr_b16 v[82:83], v19 offset:2048
    ds_read_b64_tr_b16 v[84:85], v19 offset:4096
    ds_read_b64_tr_b16 v[86:87], v19 offset:6144
    v_exp_f32 v201, v201
    v_mfma_f32_16x16x32_bf16 a[80:83], v[26:29], v[112:115], a[80:83]
    v_exp_f32 v202, v202
    v_mfma_f32_32x32x16_bf16 a[208:223], v[36:39], v[14:17], a[208:223]
    v_exp_f32 v203, v203
    v_exp_f32 v204, v204
    v_exp_f32 v205, v205
    s_waitcnt lgkmcnt(12)
    v_mfma_f32_32x32x16_bf16 a[32:47], v[88:91], v[176:179], a[32:47]
    v_exp_f32 v206, v206
    v_exp_f32 v207, v207
    v_cvt_pk_bf16_f32 v192, v192, v193
    v_cvt_pk_bf16_f32 v193, v194, v195
    v_cvt_pk_bf16_f32 v194, v196, v197
    v_mfma_f32_32x32x16_bf16 a[96:111], v[88:91], v[112:115], a[96:111]
    v_cvt_pk_bf16_f32 v195, v198, v199
    v_cvt_pk_bf16_f32 v196, v200, v201
    v_cvt_pk_bf16_f32 v197, v202, v203
    v_cvt_pk_bf16_f32 v198, v204, v205
    v_cvt_pk_bf16_f32 v199, v206, v207
    v_exp_f32 v104, v104
    v_mfma_f32_32x32x16_bf16 a[32:47], v[92:95], v[180:183], a[32:47]
    v_exp_f32 v105, v105
    v_exp_f32 v106, v106
    v_exp_f32 v107, v107
    v_mfma_f32_32x32x16_bf16 a[96:111], v[92:95], v[116:119], a[96:111]
    ds_read_b64_tr_b16 v[88:89], v20 offset:0
    ds_read_b64_tr_b16 v[90:91], v20 offset:2048
    ds_read_b64_tr_b16 v[92:93], v20 offset:4096
    ds_read_b64_tr_b16 v[94:95], v20 offset:6144
    v_exp_f32 v108, v108
    v_mfma_f32_16x16x32_bf16 a[64:67], v[26:29], v[180:183], a[64:67]
    v_exp_f32 v109, v109
    s_waitcnt lgkmcnt(12)
    v_mfma_f32_32x32x16_bf16 a[48:63], v[96:99], v[176:179], a[48:63]
    s_add_u32 m0, s4, 24576
    s_nop 0
    buffer_load_dwordx4 v6, s[12:15], s60 offen lds
    buffer_load_dwordx4 v7, s[12:15], s60 offen offset:1024 lds
    v_exp_f32 v110, v110
    v_mfma_f32_32x32x16_bf16 a[112:127], v[96:99], v[112:115], a[112:127]
    v_exp_f32 v111, v111
    v_exp_f32 v120, v120
    v_exp_f32 v121, v121
    v_mfma_f32_32x32x16_bf16 a[48:63], v[100:103], v[180:183], a[48:63]
    buffer_load_dwordx4 v8, s[12:15], s60 offen offset:2048 lds
    buffer_load_dwordx4 v9, s[12:15], s60 offen offset:3072 lds
    v_exp_f32 v122, v122
    v_exp_f32 v123, v123
    v_mfma_f32_32x32x16_bf16 a[112:127], v[100:103], v[116:119], a[112:127]
    ds_read_b64_tr_b16 v[96:97], v21 offset:0
    ds_read_b64_tr_b16 v[98:99], v21 offset:2048
    ds_read_b64_tr_b16 v[100:101], v21 offset:4096
    ds_read_b64_tr_b16 v[102:103], v21 offset:6144
    v_exp_f32 v124, v124
    v_mfma_f32_16x16x32_bf16 a[80:83], v[26:29], v[116:119], a[80:83]
    v_exp_f32 v125, v125
    v_mfma_f32_32x32x16_bf16 v[208:223], v[36:39], v[10:13], v[208:223]
    v_exp_f32 v126, v126
    v_exp_f32 v127, v127
    v_cvt_pk_bf16_f32 v104, v104, v105
    v_cvt_pk_bf16_f32 v105, v106, v107
    v_cvt_pk_bf16_f32 v106, v108, v109
    v_cvt_pk_bf16_f32 v107, v110, v111
    v_cvt_pk_bf16_f32 v108, v120, v121
    v_cvt_pk_bf16_f32 v109, v122, v123
    v_cvt_pk_bf16_f32 v110, v124, v125
    v_cvt_pk_bf16_f32 v111, v126, v127
    s_waitcnt vmcnt(12)
    s_waitcnt lgkmcnt(12)
    v_mfma_f32_32x32x16_bf16 a[0:15], v[72:75], v[192:195], a[0:15]
    s_add_u32 s61, s60, 16384
    s_add_u32 m0, s4, 28672
    s_nop 0
    buffer_load_dwordx4 v6, s[12:15], s61 offen lds
    buffer_load_dwordx4 v7, s[12:15], s61 offen offset:1024 lds
    v_accvgpr_read_b32 v112, a208
    v_accvgpr_read_b32 v113, a209
    v_mfma_f32_32x32x16_bf16 v[40:55], v[72:75], v[104:107], v[40:55]
    v_accvgpr_read_b32 v114, a210
    v_accvgpr_read_b32 v115, a211
    v_accvgpr_read_b32 v116, a212
    v_accvgpr_read_b32 v117, a213
    v_accvgpr_read_b32 v118, a214
    v_accvgpr_read_b32 v119, a215
    v_accvgpr_read_b32 v120, a216
    v_mfma_f32_32x32x16_bf16 a[0:15], v[76:79], v[196:199], a[0:15]
    buffer_load_dwordx4 v8, s[12:15], s61 offen offset:2048 lds
    buffer_load_dwordx4 v9, s[12:15], s61 offen offset:3072 lds
    s_add_u32 s62, s62, 32768
    s_and_b32 s62, s62, 131071
    s_add_u32 s60, s63, s62
    v_accvgpr_read_b32 v121, a217
    v_mfma_f32_32x32x16_bf16 v[40:55], v[76:79], v[108:111], v[40:55]
    ds_read_b64_tr_b16 v[72:73], v18 offset:8192
    ds_read_b64_tr_b16 v[74:75], v18 offset:10240
    ds_read_b64_tr_b16 v[76:77], v18 offset:12288
    ds_read_b64_tr_b16 v[78:79], v18 offset:14336
    v_accvgpr_read_b32 v122, a218
    v_accvgpr_read_b32 v123, a219
    v_accvgpr_read_b32 v124, a220
    v_mfma_f32_16x16x32_bf16 a[64:67], v[26:29], v[192:195], a[64:67]
    v_accvgpr_read_b32 v125, a221
    v_accvgpr_read_b32 v126, a222
    s_waitcnt lgkmcnt(12)
    v_mfma_f32_32x32x16_bf16 a[16:31], v[80:83], v[192:195], a[16:31]
    v_accvgpr_read_b32 v127, a223
    v_exp_f32 v208, v208
    v_exp_f32 v209, v209
    v_exp_f32 v210, v210
    v_mfma_f32_32x32x16_bf16 v[56:71], v[80:83], v[104:107], v[56:71]
    v_exp_f32 v211, v211
    v_exp_f32 v212, v212
    v_exp_f32 v213, v213
    v_mfma_f32_32x32x16_bf16 a[16:31], v[84:87], v[196:199], a[16:31]
    v_exp_f32 v214, v214
    v_exp_f32 v215, v215
    v_exp_f32 v216, v216
    v_mfma_f32_32x32x16_bf16 v[56:71], v[84:87], v[108:111], v[56:71]
    ds_read_b64_tr_b16 v[80:81], v19 offset:8192
    ds_read_b64_tr_b16 v[82:83], v19 offset:10240
    ds_read_b64_tr_b16 v[84:85], v19 offset:12288
    ds_read_b64_tr_b16 v[86:87], v19 offset:14336
    v_exp_f32 v217, v217
    v_mfma_f32_16x16x32_bf16 a[80:83], v[26:29], v[104:107], a[80:83]
    v_exp_f32 v218, v218
    v_mfma_f32_32x32x16_bf16 a[224:239], v[36:39], v[14:17], a[224:239]
    v_exp_f32 v219, v219
    v_exp_f32 v220, v220
    v_exp_f32 v221, v221
    s_waitcnt lgkmcnt(12)
    v_mfma_f32_32x32x16_bf16 a[32:47], v[88:91], v[192:195], a[32:47]
    v_exp_f32 v222, v222
    v_exp_f32 v223, v223
    v_cvt_pk_bf16_f32 v208, v208, v209
    v_cvt_pk_bf16_f32 v209, v210, v211
    v_cvt_pk_bf16_f32 v210, v212, v213
    v_mfma_f32_32x32x16_bf16 a[96:111], v[88:91], v[104:107], a[96:111]
    v_cvt_pk_bf16_f32 v211, v214, v215
    v_cvt_pk_bf16_f32 v212, v216, v217
    v_cvt_pk_bf16_f32 v213, v218, v219
    v_cvt_pk_bf16_f32 v214, v220, v221
    v_cvt_pk_bf16_f32 v215, v222, v223
    v_exp_f32 v112, v112
    v_mfma_f32_32x32x16_bf16 a[32:47], v[92:95], v[196:199], a[32:47]
    v_exp_f32 v113, v113
    v_exp_f32 v114, v114
    v_exp_f32 v115, v115
    v_mfma_f32_32x32x16_bf16 a[96:111], v[92:95], v[108:111], a[96:111]
    ds_read_b64_tr_b16 v[88:89], v20 offset:8192
    ds_read_b64_tr_b16 v[90:91], v20 offset:10240
    ds_read_b64_tr_b16 v[92:93], v20 offset:12288
    ds_read_b64_tr_b16 v[94:95], v20 offset:14336
    v_exp_f32 v116, v116
    v_mfma_f32_16x16x32_bf16 a[64:67], v[26:29], v[196:199], a[64:67]
    v_exp_f32 v117, v117
    s_waitcnt lgkmcnt(12)
    v_mfma_f32_32x32x16_bf16 a[48:63], v[96:99], v[192:195], a[48:63]
    v_exp_f32 v118, v118
    v_exp_f32 v119, v119
    v_exp_f32 v120, v120
    v_mfma_f32_32x32x16_bf16 a[112:127], v[96:99], v[104:107], a[112:127]
    v_exp_f32 v121, v121
    v_exp_f32 v122, v122
    v_exp_f32 v123, v123
    v_mfma_f32_32x32x16_bf16 a[48:63], v[100:103], v[196:199], a[48:63]
    v_exp_f32 v124, v124
    v_exp_f32 v125, v125
    v_exp_f32 v126, v126
    v_mfma_f32_32x32x16_bf16 a[112:127], v[100:103], v[108:111], a[112:127]
    ds_read_b64_tr_b16 v[96:97], v21 offset:8192
    ds_read_b64_tr_b16 v[98:99], v21 offset:10240
    ds_read_b64_tr_b16 v[100:101], v21 offset:12288
    ds_read_b64_tr_b16 v[102:103], v21 offset:14336
    v_exp_f32 v127, v127
    v_cvt_pk_bf16_f32 v112, v112, v113
    v_mfma_f32_16x16x32_bf16 a[80:83], v[26:29], v[108:111], a[80:83]
    v_cvt_pk_bf16_f32 v113, v114, v115
    v_cvt_pk_bf16_f32 v114, v116, v117
    v_mfma_f32_32x32x16_bf16 v[224:239], v[36:39], v[10:13], v[224:239]
    v_cvt_pk_bf16_f32 v115, v118, v119
    v_cvt_pk_bf16_f32 v116, v120, v121
    v_cvt_pk_bf16_f32 v117, v122, v123
    v_cvt_pk_bf16_f32 v118, v124, v125
    v_cvt_pk_bf16_f32 v119, v126, v127
    s_waitcnt vmcnt(8)
    s_waitcnt lgkmcnt(12)
    v_mfma_f32_32x32x16_bf16 a[0:15], v[72:75], v[208:211], a[0:15]
    v_accvgpr_read_b32 v104, a224
    v_accvgpr_read_b32 v105, a225
    v_accvgpr_read_b32 v106, a226
    v_accvgpr_read_b32 v107, a227
    v_accvgpr_read_b32 v108, a228
    v_accvgpr_read_b32 v109, a229
    v_accvgpr_read_b32 v110, a230
    v_mfma_f32_32x32x16_bf16 v[40:55], v[72:75], v[112:115], v[40:55]
    v_accvgpr_read_b32 v111, a231
    v_accvgpr_read_b32 v120, a232
    v_accvgpr_read_b32 v121, a233
    v_accvgpr_read_b32 v122, a234
    v_accvgpr_read_b32 v123, a235
    v_accvgpr_read_b32 v124, a236
    v_accvgpr_read_b32 v125, a237
    v_mfma_f32_32x32x16_bf16 a[0:15], v[76:79], v[212:215], a[0:15]
    v_accvgpr_read_b32 v126, a238
    v_accvgpr_read_b32 v127, a239
    v_exp_f32 v224, v224
    v_exp_f32 v225, v225
    v_mfma_f32_32x32x16_bf16 v[40:55], v[76:79], v[116:119], v[40:55]
    ds_read_b64_tr_b16 v[72:73], v18 offset:16384
    ds_read_b64_tr_b16 v[74:75], v18 offset:18432
    ds_read_b64_tr_b16 v[76:77], v18 offset:20480
    ds_read_b64_tr_b16 v[78:79], v18 offset:22528
    v_exp_f32 v226, v226
    v_mfma_f32_16x16x32_bf16 a[64:67], v[26:29], v[208:211], a[64:67]
    v_exp_f32 v227, v227
    s_waitcnt lgkmcnt(12)
    v_mfma_f32_32x32x16_bf16 a[16:31], v[80:83], v[208:211], a[16:31]
    v_exp_f32 v228, v228
    v_exp_f32 v229, v229
    v_exp_f32 v230, v230
    v_mfma_f32_32x32x16_bf16 v[56:71], v[80:83], v[112:115], v[56:71]
    v_exp_f32 v231, v231
    v_exp_f32 v232, v232
    v_exp_f32 v233, v233
    v_mfma_f32_32x32x16_bf16 a[16:31], v[84:87], v[212:215], a[16:31]
    v_exp_f32 v234, v234
    v_exp_f32 v235, v235
    v_exp_f32 v236, v236
    v_mfma_f32_32x32x16_bf16 v[56:71], v[84:87], v[116:119], v[56:71]
    ds_read_b64_tr_b16 v[80:81], v19 offset:16384
    ds_read_b64_tr_b16 v[82:83], v19 offset:18432
    ds_read_b64_tr_b16 v[84:85], v19 offset:20480
    ds_read_b64_tr_b16 v[86:87], v19 offset:22528
    v_exp_f32 v237, v237
    v_mfma_f32_16x16x32_bf16 a[80:83], v[26:29], v[112:115], a[80:83]
    v_exp_f32 v238, v238
    v_mfma_f32_32x32x16_bf16 a[240:255], v[36:39], v[14:17], a[240:255]
    v_exp_f32 v239, v239
    v_cvt_pk_bf16_f32 v224, v224, v225
    v_cvt_pk_bf16_f32 v225, v226, v227
    v_cvt_pk_bf16_f32 v226, v228, v229
    v_cvt_pk_bf16_f32 v227, v230, v231
    v_cvt_pk_bf16_f32 v228, v232, v233
    s_waitcnt lgkmcnt(12)
    v_mfma_f32_32x32x16_bf16 a[32:47], v[88:91], v[208:211], a[32:47]
    v_cvt_pk_bf16_f32 v229, v234, v235
    v_cvt_pk_bf16_f32 v230, v236, v237
    v_cvt_pk_bf16_f32 v231, v238, v239
    v_exp_f32 v104, v104
    v_exp_f32 v105, v105
    v_mfma_f32_32x32x16_bf16 a[96:111], v[88:91], v[112:115], a[96:111]
    v_exp_f32 v106, v106
    v_exp_f32 v107, v107
    v_exp_f32 v108, v108
    v_mfma_f32_32x32x16_bf16 a[32:47], v[92:95], v[212:215], a[32:47]
    v_exp_f32 v109, v109
    v_exp_f32 v110, v110
    v_exp_f32 v111, v111
    v_mfma_f32_32x32x16_bf16 a[96:111], v[92:95], v[116:119], a[96:111]
    ds_read_b64_tr_b16 v[88:89], v20 offset:16384
    ds_read_b64_tr_b16 v[90:91], v20 offset:18432
    ds_read_b64_tr_b16 v[92:93], v20 offset:20480
    ds_read_b64_tr_b16 v[94:95], v20 offset:22528
    v_exp_f32 v120, v120
    v_mfma_f32_16x16x32_bf16 a[64:67], v[26:29], v[212:215], a[64:67]
    v_exp_f32 v121, v121
    s_waitcnt lgkmcnt(12)
    v_mfma_f32_32x32x16_bf16 a[48:63], v[96:99], v[208:211], a[48:63]
    v_exp_f32 v122, v122
    v_exp_f32 v123, v123
    v_exp_f32 v124, v124
    v_mfma_f32_32x32x16_bf16 a[112:127], v[96:99], v[112:115], a[112:127]
    v_exp_f32 v125, v125
    v_exp_f32 v126, v126
    v_exp_f32 v127, v127
    v_cvt_pk_bf16_f32 v104, v104, v105
    v_mfma_f32_32x32x16_bf16 a[48:63], v[100:103], v[212:215], a[48:63]
    v_cvt_pk_bf16_f32 v105, v106, v107
    v_cvt_pk_bf16_f32 v106, v108, v109
    v_cvt_pk_bf16_f32 v107, v110, v111
    v_cvt_pk_bf16_f32 v108, v120, v121
    v_cvt_pk_bf16_f32 v109, v122, v123
    v_cvt_pk_bf16_f32 v110, v124, v125
    v_cvt_pk_bf16_f32 v111, v126, v127
    v_mfma_f32_32x32x16_bf16 a[112:127], v[100:103], v[116:119], a[112:127]
    ds_read_b64_tr_b16 v[96:97], v21 offset:16384
    ds_read_b64_tr_b16 v[98:99], v21 offset:18432
    ds_read_b64_tr_b16 v[100:101], v21 offset:20480
    ds_read_b64_tr_b16 v[102:103], v21 offset:22528
    v_mfma_f32_16x16x32_bf16 a[80:83], v[26:29], v[116:119], a[80:83]
    v_mfma_f32_32x32x16_bf16 v[240:255], v[36:39], v[10:13], v[240:255]
    s_waitcnt vmcnt(0)
    s_waitcnt lgkmcnt(12)
    v_mfma_f32_32x32x16_bf16 a[0:15], v[72:75], v[224:227], a[0:15]
    v_lshrrev_b32 v7, 4, v1
    v_and_b32 v8, 15, v1
    v_lshlrev_b32 v9, 2, v7
    v_xor_b32 v8, v8, v9
    v_lshlrev_b32 v8, 4, v8
    v_lshl_add_u32 v6, v7, 11, v8
    v_add_u32 v7, 7168, v6
    v_add_u32 v8, 14336, v6
    v_add_u32 v9, 21504, v6
    s_mov_b32 s12, s24
    s_mov_b32 s13, s25
    s_mov_b32 s14, 8388608
    s_mov_b32 s15, 0x20000
    s_add_u32 s7, s3, s52
    s_and_b32 s7, s7, 3
    s_lshl_b32 s63, s50, 2
    s_add_u32 s63, s63, s7
    s_lshl_b32 s63, s63, 18
    s_and_b32 s7, s52, 7
    s_lshl_b32 s7, s7, 8
    s_add_u32 s63, s63, s7
    s_lshr_b32 s62, s52, 3
    s_lshl_b32 s62, s62, 17
    s_add_u32 s60, s63, s62
    s_add_u32 m0, s4, 0
    s_nop 0
    buffer_load_dwordx4 v6, s[12:15], s60 offen lds
    v_mfma_f32_32x32x16_bf16 v[40:55], v[72:75], v[104:107], v[40:55]
    v_accvgpr_read_b32 v112, a240
    v_accvgpr_read_b32 v113, a241
    v_accvgpr_read_b32 v114, a242
    v_accvgpr_read_b32 v115, a243
    v_accvgpr_read_b32 v116, a244
    v_accvgpr_read_b32 v117, a245
    v_accvgpr_read_b32 v118, a246
    v_mfma_f32_32x32x16_bf16 a[0:15], v[76:79], v[228:231], a[0:15]
    buffer_load_dwordx4 v7, s[12:15], s60 offen offset:1024 lds
    v_accvgpr_read_b32 v119, a247
    v_accvgpr_read_b32 v120, a248
    v_accvgpr_read_b32 v121, a249
    v_accvgpr_read_b32 v122, a250
    v_accvgpr_read_b32 v123, a251
    v_accvgpr_read_b32 v124, a252
    v_mfma_f32_32x32x16_bf16 v[40:55], v[76:79], v[108:111], v[40:55]
    ds_read_b64_tr_b16 v[72:73], v18 offset:24576
    ds_read_b64_tr_b16 v[74:75], v18 offset:26624
    ds_read_b64_tr_b16 v[76:77], v18 offset:28672
    ds_read_b64_tr_b16 v[78:79], v18 offset:30720
    v_accvgpr_read_b32 v125, a253
    v_accvgpr_read_b32 v126, a254
    v_accvgpr_read_b32 v127, a255
    v_mfma_f32_16x16x32_bf16 a[64:67], v[26:29], v[224:227], a[64:67]
    v_exp_f32 v240, v240
    s_waitcnt lgkmcnt(12)
    v_mfma_f32_32x32x16_bf16 a[16:31], v[80:83], v[224:227], a[16:31]
    buffer_load_dwordx4 v8, s[12:15], s60 offen offset:2048 lds
    v_exp_f32 v241, v241
    v_exp_f32 v242, v242
    v_exp_f32 v243, v243
    v_mfma_f32_32x32x16_bf16 v[56:71], v[80:83], v[104:107], v[56:71]
    v_exp_f32 v244, v244
    v_exp_f32 v245, v245
    v_exp_f32 v246, v246
    v_mfma_f32_32x32x16_bf16 a[16:31], v[84:87], v[228:231], a[16:31]
    buffer_load_dwordx4 v9, s[12:15], s60 offen offset:3072 lds
    v_exp_f32 v247, v247
    v_exp_f32 v248, v248
    v_exp_f32 v249, v249
    v_mfma_f32_32x32x16_bf16 v[56:71], v[84:87], v[108:111], v[56:71]
    ds_read_b64_tr_b16 v[80:81], v19 offset:24576
    ds_read_b64_tr_b16 v[82:83], v19 offset:26624
    ds_read_b64_tr_b16 v[84:85], v19 offset:28672
    ds_read_b64_tr_b16 v[86:87], v19 offset:30720
    v_exp_f32 v250, v250
    v_mfma_f32_16x16x32_bf16 a[80:83], v[26:29], v[104:107], a[80:83]
    v_exp_f32 v251, v251
    s_waitcnt lgkmcnt(12)
    v_mfma_f32_32x32x16_bf16 a[32:47], v[88:91], v[224:227], a[32:47]
    s_add_u32 s61, s60, 32768
    s_add_u32 m0, s4, 4096
    s_nop 0
    buffer_load_dwordx4 v6, s[12:15], s61 offen lds
    v_exp_f32 v252, v252
    v_mfma_f32_32x32x16_bf16 a[96:111], v[88:91], v[104:107], a[96:111]
    v_exp_f32 v253, v253
    v_exp_f32 v254, v254
    v_exp_f32 v255, v255
    v_cvt_pk_bf16_f32 v240, v240, v241
    v_mfma_f32_32x32x16_bf16 a[32:47], v[92:95], v[228:231], a[32:47]
    buffer_load_dwordx4 v7, s[12:15], s61 offen offset:1024 lds
    v_cvt_pk_bf16_f32 v241, v242, v243
    v_cvt_pk_bf16_f32 v242, v244, v245
    v_cvt_pk_bf16_f32 v243, v246, v247
    v_cvt_pk_bf16_f32 v244, v248, v249
    v_cvt_pk_bf16_f32 v245, v250, v251
    v_cvt_pk_bf16_f32 v246, v252, v253
    v_mfma_f32_32x32x16_bf16 a[96:111], v[92:95], v[108:111], a[96:111]
    ds_read_b64_tr_b16 v[88:89], v20 offset:24576
    ds_read_b64_tr_b16 v[90:91], v20 offset:26624
    ds_read_b64_tr_b16 v[92:93], v20 offset:28672
    ds_read_b64_tr_b16 v[94:95], v20 offset:30720
    v_cvt_pk_bf16_f32 v247, v254, v255
    v_exp_f32 v112, v112
    v_mfma_f32_16x16x32_bf16 a[64:67], v[26:29], v[228:231], a[64:67]
    v_exp_f32 v113, v113
    s_waitcnt lgkmcnt(12)
    v_mfma_f32_32x32x16_bf16 a[48:63], v[96:99], v[224:227], a[48:63]
    buffer_load_dwordx4 v8, s[12:15], s61 offen offset:2048 lds
    v_exp_f32 v114, v114
    v_exp_f32 v115, v115
    v_exp_f32 v116, v116
    v_mfma_f32_32x32x16_bf16 a[112:127], v[96:99], v[104:107], a[112:127]
    v_exp_f32 v117, v117
    v_exp_f32 v118, v118
    v_exp_f32 v119, v119
    v_mfma_f32_32x32x16_bf16 a[48:63], v[100:103], v[228:231], a[48:63]
    buffer_load_dwordx4 v9, s[12:15], s61 offen offset:3072 lds
    s_xor_b32 s7, s62, 65536
    s_add_u32 s60, s63, s7
    v_exp_f32 v120, v120
    v_mfma_f32_32x32x16_bf16 a[112:127], v[100:103], v[108:111], a[112:127]
    ds_read_b64_tr_b16 v[96:97], v21 offset:24576
    ds_read_b64_tr_b16 v[98:99], v21 offset:26624
    ds_read_b64_tr_b16 v[100:101], v21 offset:28672
    ds_read_b64_tr_b16 v[102:103], v21 offset:30720
    v_exp_f32 v121, v121
    v_mfma_f32_16x16x32_bf16 a[80:83], v[26:29], v[108:111], a[80:83]
    v_exp_f32 v122, v122
    v_exp_f32 v123, v123
    v_exp_f32 v124, v124
    v_exp_f32 v125, v125
    v_exp_f32 v126, v126
    v_exp_f32 v127, v127
    v_cvt_pk_bf16_f32 v112, v112, v113
    v_cvt_pk_bf16_f32 v113, v114, v115
    v_cvt_pk_bf16_f32 v114, v116, v117
    v_cvt_pk_bf16_f32 v115, v118, v119
    v_cvt_pk_bf16_f32 v116, v120, v121
    v_cvt_pk_bf16_f32 v117, v122, v123
    v_cvt_pk_bf16_f32 v118, v124, v125
    v_cvt_pk_bf16_f32 v119, v126, v127
    v_mfma_f32_16x16x32_bf16 a[64:67], v[26:29], v[240:243], a[64:67]
    v_mfma_f32_16x16x32_bf16 a[80:83], v[26:29], v[112:115], a[80:83]
    v_mfma_f32_16x16x32_bf16 a[64:67], v[26:29], v[244:247], a[64:67]
    v_mfma_f32_16x16x32_bf16 a[80:83], v[26:29], v[116:119], a[80:83]
    s_lshl_b32 s5, s3, 13
    s_add_u32 s5, s5, 131072
    v_add_u32 v104, s4, v30
    v_add_u32 v105, s5, v30
    s_sub_u32 s5, s3, 1
    s_and_b32 s5, s5, 3
    s_lshl_b32 s7, s5, 13
    s_add_u32 s7, s7, 131072
    s_lshl_b32 s5, s5, 15
    v_add_u32 v106, s5, v30
    v_add_u32 v107, s7, v30
    s_sub_u32 s5, s3, 2
    s_and_b32 s5, s5, 3
    s_lshl_b32 s7, s5, 13
    s_add_u32 s7, s7, 131072
    s_lshl_b32 s5, s5, 15
    v_add_u32 v108, s5, v30
    v_add_u32 v109, s7, v30
    s_sub_u32 s5, s3, 3
    s_and_b32 s5, s5, 3
    s_lshl_b32 s7, s5, 13
    s_add_u32 s7, s7, 131072
    s_lshl_b32 s5, s5, 15
    v_add_u32 v110, s5, v30
    v_add_u32 v111, s7, v30
    s_waitcnt lgkmcnt(0)
    v_mfma_f32_32x32x16_bf16 a[16:31], v[80:83], v[240:243], a[16:31]
    s_add_u32 m0, s4, 8192
    s_nop 0
    buffer_load_dwordx4 v6, s[12:15], s60 offen lds
    v_mfma_f32_32x32x16_bf16 v[56:71], v[80:83], v[112:115], v[56:71]
    v_mfma_f32_32x32x16_bf16 a[16:31], v[84:87], v[244:247], a[16:31]
    buffer_load_dwordx4 v7, s[12:15], s60 offen offset:1024 lds
    v_mfma_f32_32x32x16_bf16 v[56:71], v[84:87], v[116:119], v[56:71]
    s_mov_b32 vcc_lo, 0xffff0000
    s_mov_b32 vcc_hi, 0xffff0000
    v_accvgpr_read_b32 v2, a64
    v_accvgpr_read_b32 v3, a65
    v_cndmask_b32 v3, v2, v3, vcc
    v_mov_b32 v2, v32
    ds_write_b64 v104, v[2:3] offset:15360
    v_accvgpr_read_b32 v4, a80
    v_accvgpr_read_b32 v5, a81
    v_cndmask_b32 v5, v4, v5, vcc
    v_mov_b32 v4, v34
    ds_write_b64 v104, v[4:5] offset:15368
    v_mfma_f32_32x32x16_bf16 a[32:47], v[88:91], v[240:243], a[32:47]
    buffer_load_dwordx4 v8, s[12:15], s60 offen offset:2048 lds
    v_mfma_f32_32x32x16_bf16 a[96:111], v[88:91], v[112:115], a[96:111]
    v_mfma_f32_32x32x16_bf16 a[32:47], v[92:95], v[244:247], a[32:47]
    buffer_load_dwordx4 v9, s[12:15], s60 offen offset:3072 lds
    v_mfma_f32_32x32x16_bf16 a[96:111], v[92:95], v[116:119], a[96:111]
    ds_write_b128 v104, a[16:19] offset:24576
    ds_write_b128 v104, a[20:23] offset:25600
    ds_write_b128 v104, a[24:27] offset:26624
    ds_write_b128 v104, a[28:31] offset:27648
    ds_write_b128 v104, v[56:59] offset:16384
    ds_write_b128 v104, v[60:63] offset:17408
    ds_write_b128 v104, v[64:67] offset:18432
    ds_write_b128 v104, v[68:71] offset:19456
    v_mfma_f32_32x32x16_bf16 a[48:63], v[96:99], v[240:243], a[48:63]
    s_add_u32 s61, s60, 32768
    s_add_u32 m0, s4, 12288
    s_nop 0
    buffer_load_dwordx4 v6, s[12:15], s61 offen lds
    v_mfma_f32_32x32x16_bf16 a[112:127], v[96:99], v[112:115], a[112:127]
    v_mfma_f32_32x32x16_bf16 a[48:63], v[100:103], v[244:247], a[48:63]
    buffer_load_dwordx4 v7, s[12:15], s61 offen offset:1024 lds
    v_mfma_f32_32x32x16_bf16 a[112:127], v[100:103], v[116:119], a[112:127]
    ds_write_b128 v104, a[32:35] offset:28672
    ds_write_b128 v104, a[36:39] offset:29696
    ds_write_b128 v104, a[40:43] offset:30720
    ds_write_b128 v104, a[44:47] offset:31744
    ds_write_b128 v104, a[96:99] offset:20480
    ds_write_b128 v104, a[100:103] offset:21504
    ds_write_b128 v104, a[104:107] offset:22528
    ds_write_b128 v104, a[108:111] offset:23552
    v_mfma_f32_32x32x16_bf16 a[0:15], v[72:75], v[240:243], a[0:15]
    buffer_load_dwordx4 v8, s[12:15], s61 offen offset:2048 lds
    v_mfma_f32_32x32x16_bf16 v[40:55], v[72:75], v[112:115], v[40:55]
    v_mfma_f32_32x32x16_bf16 a[0:15], v[76:79], v[244:247], a[0:15]
    v_mfma_f32_32x32x16_bf16 v[40:55], v[76:79], v[116:119], v[40:55]
    ds_write_b128 v105, a[48:51] offset:0
    ds_write_b128 v105, a[52:55] offset:1024
    ds_write_b128 v105, a[56:59] offset:2048
    ds_write_b128 v105, a[60:63] offset:3072
    ds_write_b128 v105, a[112:115] offset:4096
    ds_write_b128 v105, a[116:119] offset:5120
    ds_write_b128 v105, a[120:123] offset:6144
    ds_write_b128 v105, a[124:127] offset:7168
    buffer_load_dword v31, v9, s[12:15], s61 offen offset:3072
L_g2tail2:
    s_add_u32 s98, s98, 4194304
    s_add_u32 s99, s99, 4194304
    v_accvgpr_read_b32 v128, a0
    v_accvgpr_read_b32 v129, a1
    v_accvgpr_read_b32 v130, a2
    v_accvgpr_read_b32 v131, a3
    v_accvgpr_read_b32 v132, a4
    v_accvgpr_read_b32 v133, a5
    v_accvgpr_read_b32 v134, a6
    v_accvgpr_read_b32 v135, a7
    v_accvgpr_read_b32 v136, a8
    v_accvgpr_read_b32 v137, a9
    v_accvgpr_read_b32 v138, a10
    v_accvgpr_read_b32 v139, a11
    v_accvgpr_read_b32 v140, a12
    v_accvgpr_read_b32 v141, a13
    v_accvgpr_read_b32 v142, a14
    v_accvgpr_read_b32 v143, a15
    v_mov_b32 v72, v2
    v_mov_b32 v73, v3
    v_mov_b32 v192, v40
    v_mov_b32 v193, v41
    v_mov_b32 v194, v42
    v_mov_b32 v195, v43
    v_mov_b32 v196, v44
    v_mov_b32 v197, v45
    v_mov_b32 v198, v46
    v_mov_b32 v199, v47
    v_mov_b32 v200, v48
    v_mov_b32 v201, v49
    v_mov_b32 v202, v50
    v_mov_b32 v203, v51
    v_mov_b32 v204, v52
    v_mov_b32 v205, v53
    v_mov_b32 v206, v54
    v_mov_b32 v207, v55
    v_mov_b32 v80, v4
    v_mov_b32 v81, v5
    s_lshr_b32 s94, s52, 3
    s_lshl_b32 s94, s94, 2
    s_add_u32 s94, s94, s3
    s_add_u32 s94, s94, 0
    s_lshl_b32 s95, s94, 3
    s_add_u32 s95, s95, s50
    s_lshl_b32 s96, s95, 15
    s_add_u32 s96, s96, 4194304
    s_lshl_b32 s95, s95, 8
    s_add_u32 s95, s95, 18874368
    v_add_u32 v26, 0x10000, v22
    v_add_u32 v27, 0x10000, v23
    v_add_u32 v28, 0x10000, v24
    v_add_u32 v29, 0x10000, v25
    v_and_b32 v10, 15, v1
    v_lshlrev_b32 v10, 4, v10
    v_lshrrev_b32 v11, 5, v1
    v_lshl_add_u32 v10, v11, 8, v10
    v_bfe_u32 v11, v1, 4, 1
    v_lshl_add_u32 v10, v11, 15, v10
    v_and_b32 v11, 3, v1
    v_lshlrev_b32 v11, 2, v11
    s_lshl_b32 s58, s92, 3
    s_lshl_b32 s7, s3, 1
    s_add_u32 s58, s58, s7
    s_lshl_b32 s58, s58, 3
    s_add_u32 s58, s58, s50
    s_lshl_b32 s58, s58, 12
    s_add_u32 s58, s58, 8388608
    s_lshr_b32 s59, s52, 3
    s_lshl_b32 s59, s59, 12
    s_lshl_b32 s64, s92, 2
    s_lshr_b32 s7, s50, 1
    s_add_u32 s64, s64, s7
    s_lshl_b32 s64, s64, 8
    s_add_u32 s64, s64, 20971520
    v_and_b32 v15, 7, v1
    v_lshlrev_b32 v15, 2, v15
    s_lshl_b32 s53, s92, 3
    s_add_u32 s53, s53, s50
    s_lshl_b32 s53, s53, 15
    s_add_u32 s53, s53, 8388608
    s_add_u32 s54, s53, 16384
    v_lshlrev_b32 v13, 4, v0
    s_bfe_u32 s66, s92, 0x10003
    s_lshl_b32 s66, s66, 3
    s_add_u32 s66, s66, s50
    s_lshl_b32 s66, s66, 16
    s_lshr_b32 s7, s92, 4
    s_lshl_b32 s7, s7, 11
    s_add_u32 s66, s66, s7
    s_and_b32 s7, s92, 7
    s_lshl_b32 s7, s7, 8
    s_add_u32 s66, s66, s7
    v_and_b32 v14, 15, v0
    v_lshlrev_b32 v14, 12, v14
    v_lshrrev_b32 v16, 4, v0
    v_lshl_add_u32 v14, v16, 4, v14
    s_mov_b32 s8, s36
    s_mov_b32 s9, s37
    s_mov_b32 s10, 1048576
    s_mov_b32 s11, 0x20000
    s_waitcnt lgkmcnt(0)
    s_barrier
    ds_read_b64 v[74:75], v106 offset:15360
    ds_read_b64 v[76:77], v108 offset:15360
    ds_read_b64 v[78:79], v110 offset:15360
    ds_read_b64 v[82:83], v106 offset:15368
    ds_read_b64 v[84:85], v108 offset:15368
    ds_read_b64 v[86:87], v110 offset:15368
    ds_read_b128 v[144:147], v106 offset:24576
    ds_read_b128 v[148:151], v106 offset:25600
    ds_read_b128 v[152:155], v106 offset:26624
    ds_read_b128 v[156:159], v106 offset:27648
    ds_read_b128 v[160:163], v108 offset:28672
    ds_read_b128 v[164:167], v108 offset:29696
    ds_read_b128 v[168:171], v108 offset:30720
    ds_read_b128 v[172:175], v108 offset:31744
    v_mov_b32 v12, 1
    s_mov_b64 exec, 15
    v_mov_b32 v12, 0
    buffer_atomic_or v12, v11, s[44:47], s95 offen sc0 sc1
    s_mov_b64 exec, -1
    s_waitcnt lgkmcnt(8)
    ds_read_b128 v[176:179], v111 offset:0
    ds_read_b128 v[180:183], v111 offset:1024
    ds_read_b128 v[184:187], v111 offset:2048
    ds_read_b128 v[188:191], v111 offset:3072
    v_max3_f32 v88, v72, v74, v76
    v_max_f32 v88, v88, v78
    v_sub_f32 v90, v72, v88
    v_sub_f32 v91, v74, v88
    v_sub_f32 v92, v76, v88
    v_sub_f32 v93, v78, v88
    v_exp_f32 v90, v90
    v_exp_f32 v91, v91
    v_exp_f32 v92, v92
    v_exp_f32 v93, v93
    v_mul_f32 v89, v90, v73
    v_fmac_f32 v89, v91, v75
    v_fmac_f32 v89, v92, v77
    v_fmac_f32 v89, v93, v79
    v_rcp_f32 v89, v89
    s_nop 0
    v_mul_f32 v90, v90, v89
    v_mul_f32 v91, v91, v89
    v_mul_f32 v92, v92, v89
    v_mul_f32 v93, v93, v89
    v_pk_mul_f32 v[128:129], v[128:129], v[90:91] op_sel_hi:[1,0]
    v_pk_mul_f32 v[130:131], v[130:131], v[90:91] op_sel_hi:[1,0]
    v_pk_mul_f32 v[132:133], v[132:133], v[90:91] op_sel_hi:[1,0]
    v_pk_mul_f32 v[134:135], v[134:135], v[90:91] op_sel_hi:[1,0]
    v_pk_mul_f32 v[136:137], v[136:137], v[90:91] op_sel_hi:[1,0]
    v_pk_mul_f32 v[138:139], v[138:139], v[90:91] op_sel_hi:[1,0]
    v_pk_mul_f32 v[140:141], v[140:141], v[90:91] op_sel_hi:[1,0]
    v_pk_mul_f32 v[142:143], v[142:143], v[90:91] op_sel_hi:[1,0]
    s_waitcnt lgkmcnt(8)
    ds_read_b128 v[208:211], v106 offset:16384
    ds_read_b128 v[212:215], v106 offset:17408
    ds_read_b128 v[216:219], v106 offset:18432
    ds_read_b128 v[220:223], v106 offset:19456
    v_pk_fma_f32 v[128:129], v[144:145], v[90:91], v[128:129] op_sel:[0,1,0]
    v_pk_fma_f32 v[130:131], v[146:147], v[90:91], v[130:131] op_sel:[0,1,0]
    v_pk_fma_f32 v[132:133], v[148:149], v[90:91], v[132:133] op_sel:[0,1,0]
    v_pk_fma_f32 v[134:135], v[150:151], v[90:91], v[134:135] op_sel:[0,1,0]
    v_pk_fma_f32 v[136:137], v[152:153], v[90:91], v[136:137] op_sel:[0,1,0]
    v_pk_fma_f32 v[138:139], v[154:155], v[90:91], v[138:139] op_sel:[0,1,0]
    v_pk_fma_f32 v[140:141], v[156:157], v[90:91], v[140:141] op_sel:[0,1,0]
    v_pk_fma_f32 v[142:143], v[158:159], v[90:91], v[142:143] op_sel:[0,1,0]
    s_waitcnt lgkmcnt(8)
    ds_read_b128 v[224:227], v108 offset:20480
    ds_read_b128 v[228:231], v108 offset:21504
    ds_read_b128 v[232:235], v108 offset:22528
    ds_read_b128 v[236:239], v108 offset:23552
    v_pk_fma_f32 v[128:129], v[160:161], v[92:93], v[128:129] op_sel_hi:[1,0,1]
    v_pk_fma_f32 v[130:131], v[162:163], v[92:93], v[130:131] op_sel_hi:[1,0,1]
    v_pk_fma_f32 v[132:133], v[164:165], v[92:93], v[132:133] op_sel_hi:[1,0,1]
    v_pk_fma_f32 v[134:135], v[166:167], v[92:93], v[134:135] op_sel_hi:[1,0,1]
    v_pk_fma_f32 v[136:137], v[168:169], v[92:93], v[136:137] op_sel_hi:[1,0,1]
    v_pk_fma_f32 v[138:139], v[170:171], v[92:93], v[138:139] op_sel_hi:[1,0,1]
    v_pk_fma_f32 v[140:141], v[172:173], v[92:93], v[140:141] op_sel_hi:[1,0,1]
    v_pk_fma_f32 v[142:143], v[174:175], v[92:93], v[142:143] op_sel_hi:[1,0,1]
    s_waitcnt lgkmcnt(8)
    ds_read_b128 v[240:243], v111 offset:4096
    ds_read_b128 v[244:247], v111 offset:5120
    ds_read_b128 v[248:251], v111 offset:6144
    ds_read_b128 v[252:255], v111 offset:7168
    v_pk_fma_f32 v[128:129], v[176:177], v[92:93], v[128:129] op_sel:[0,1,0]
    v_pk_fma_f32 v[130:131], v[178:179], v[92:93], v[130:131] op_sel:[0,1,0]
    v_pk_fma_f32 v[132:133], v[180:181], v[92:93], v[132:133] op_sel:[0,1,0]
    v_pk_fma_f32 v[134:135], v[182:183], v[92:93], v[134:135] op_sel:[0,1,0]
    v_pk_fma_f32 v[136:137], v[184:185], v[92:93], v[136:137] op_sel:[0,1,0]
    v_pk_fma_f32 v[138:139], v[186:187], v[92:93], v[138:139] op_sel:[0,1,0]
    v_pk_fma_f32 v[140:141], v[188:189], v[92:93], v[140:141] op_sel:[0,1,0]
    v_pk_fma_f32 v[142:143], v[190:191], v[92:93], v[142:143] op_sel:[0,1,0]
    v_cvt_pk_bf16_f32 v128, v128, v129
    v_cvt_pk_bf16_f32 v129, v130, v131
    v_cvt_pk_bf16_f32 v130, v132, v133
    v_cvt_pk_bf16_f32 v131, v134, v135
    v_cvt_pk_bf16_f32 v132, v136, v137
    v_cvt_pk_bf16_f32 v133, v138, v139
    v_cvt_pk_bf16_f32 v134, v140, v141
    v_cvt_pk_bf16_f32 v135, v142, v143
    s_lshl_b32 s5, s3, 11
    s_add_u32 s5, s5, s98
    buffer_store_dwordx4 v[128:131], v30, s[44:47], s5 offen sc1
    buffer_store_dwordx4 v[132:135], v30, s[44:47], s5 offen offset:1024 sc1
    v_max3_f32 v88, v80, v82, v84
    v_max_f32 v88, v88, v86
    v_sub_f32 v90, v80, v88
    v_sub_f32 v91, v82, v88
    v_sub_f32 v92, v84, v88
    v_sub_f32 v93, v86, v88
    v_exp_f32 v90, v90
    v_exp_f32 v91, v91
    v_exp_f32 v92, v92
    v_exp_f32 v93, v93
    v_mul_f32 v89, v90, v81
    v_fmac_f32 v89, v91, v83
    v_fmac_f32 v89, v92, v85
    v_fmac_f32 v89, v93, v87
    v_rcp_f32 v89, v89
    s_nop 0
    v_mul_f32 v90, v90, v89
    v_mul_f32 v91, v91, v89
    v_mul_f32 v92, v92, v89
    v_mul_f32 v93, v93, v89
    v_pk_mul_f32 v[192:193], v[192:193], v[90:91] op_sel_hi:[1,0]
    v_pk_mul_f32 v[194:195], v[194:195], v[90:91] op_sel_hi:[1,0]
    v_pk_mul_f32 v[196:197], v[196:197], v[90:91] op_sel_hi:[1,0]
    v_pk_mul_f32 v[198:199], v[198:199], v[90:91] op_sel_hi:[1,0]
    v_pk_mul_f32 v[200:201], v[200:201], v[90:91] op_sel_hi:[1,0]
    v_pk_mul_f32 v[202:203], v[202:203], v[90:91] op_sel_hi:[1,0]
    v_pk_mul_f32 v[204:205], v[204:205], v[90:91] op_sel_hi:[1,0]
    v_pk_mul_f32 v[206:207], v[206:207], v[90:91] op_sel_hi:[1,0]
    s_waitcnt lgkmcnt(8)
    v_pk_fma_f32 v[192:193], v[208:209], v[90:91], v[192:193] op_sel:[0,1,0]
    v_pk_fma_f32 v[194:195], v[210:211], v[90:91], v[194:195] op_sel:[0,1,0]
    v_pk_fma_f32 v[196:197], v[212:213], v[90:91], v[196:197] op_sel:[0,1,0]
    v_pk_fma_f32 v[198:199], v[214:215], v[90:91], v[198:199] op_sel:[0,1,0]
    v_pk_fma_f32 v[200:201], v[216:217], v[90:91], v[200:201] op_sel:[0,1,0]
    v_pk_fma_f32 v[202:203], v[218:219], v[90:91], v[202:203] op_sel:[0,1,0]
    v_pk_fma_f32 v[204:205], v[220:221], v[90:91], v[204:205] op_sel:[0,1,0]
    v_pk_fma_f32 v[206:207], v[222:223], v[90:91], v[206:207] op_sel:[0,1,0]
    s_waitcnt lgkmcnt(4)
    v_pk_fma_f32 v[192:193], v[224:225], v[92:93], v[192:193] op_sel_hi:[1,0,1]
    v_pk_fma_f32 v[194:195], v[226:227], v[92:93], v[194:195] op_sel_hi:[1,0,1]
    v_pk_fma_f32 v[196:197], v[228:229], v[92:93], v[196:197] op_sel_hi:[1,0,1]
    v_pk_fma_f32 v[198:199], v[230:231], v[92:93], v[198:199] op_sel_hi:[1,0,1]
    v_pk_fma_f32 v[200:201], v[232:233], v[92:93], v[200:201] op_sel_hi:[1,0,1]
    v_pk_fma_f32 v[202:203], v[234:235], v[92:93], v[202:203] op_sel_hi:[1,0,1]
    v_pk_fma_f32 v[204:205], v[236:237], v[92:93], v[204:205] op_sel_hi:[1,0,1]
    v_pk_fma_f32 v[206:207], v[238:239], v[92:93], v[206:207] op_sel_hi:[1,0,1]
    s_waitcnt lgkmcnt(0)
    v_pk_fma_f32 v[192:193], v[240:241], v[92:93], v[192:193] op_sel:[0,1,0]
    v_pk_fma_f32 v[194:195], v[242:243], v[92:93], v[194:195] op_sel:[0,1,0]
    v_pk_fma_f32 v[196:197], v[244:245], v[92:93], v[196:197] op_sel:[0,1,0]
    v_pk_fma_f32 v[198:199], v[246:247], v[92:93], v[198:199] op_sel:[0,1,0]
    v_pk_fma_f32 v[200:201], v[248:249], v[92:93], v[200:201] op_sel:[0,1,0]
    v_pk_fma_f32 v[202:203], v[250:251], v[92:93], v[202:203] op_sel:[0,1,0]
    v_pk_fma_f32 v[204:205], v[252:253], v[92:93], v[204:205] op_sel:[0,1,0]
    v_pk_fma_f32 v[206:207], v[254:255], v[92:93], v[206:207] op_sel:[0,1,0]
    s_barrier
    buffer_load_dwordx4 v9, s[12:15], s61 offen offset:3072 lds
    s_xor_b32 s7, s62, 131072
    s_add_u32 s60, s63, s7
    v_cvt_pk_bf16_f32 v192, v192, v193
    v_cvt_pk_bf16_f32 v193, v194, v195
    v_cvt_pk_bf16_f32 v194, v196, v197
    v_cvt_pk_bf16_f32 v195, v198, v199
    v_cvt_pk_bf16_f32 v196, v200, v201
    v_cvt_pk_bf16_f32 v197, v202, v203
    v_cvt_pk_bf16_f32 v198, v204, v205
    v_cvt_pk_bf16_f32 v199, v206, v207
    s_lshl_b32 s5, s3, 11
    s_add_u32 s5, s5, s99
    buffer_store_dwordx4 v[192:195], v30, s[44:47], s5 offen sc1
    buffer_store_dwordx4 v[196:199], v30, s[44:47], s5 offen offset:1024 sc1
    s_waitcnt vmcnt(5)
    v_cmp_ne_u32 vcc, 1, v12
    s_cbranch_vccz L_g2early
    v_mov_b32 v12, 1
    s_mov_b64 exec, 15
    v_mov_b32 v12, 0
    buffer_atomic_or v12, v11, s[44:47], s95 offen sc0 sc1
    s_mov_b64 exec, -1
    s_waitcnt vmcnt(1)
    s_barrier
    s_cmp_lg_u32 s3, 0
    s_cbranch_scc1 L_g2pub3
    v_mov_b32 v31, 1
    v_lshlrev_b32 v103, 2, v1
    s_mov_b64 exec, 3
    buffer_store_dword v31, v103, s[44:47], s100 offen sc1
    s_mov_b64 exec, -1
    s_waitcnt vmcnt(1)
    s_branch L_g2pub3_j
L_g2pub3:
    s_waitcnt vmcnt(0)
L_g2pub3_j:
    v_cmp_ne_u32 vcc, 1, v12
    s_cbranch_vccz L_g2second
    s_add_u32 m0, s4, 16384
    s_nop 0
    buffer_load_dwordx4 v6, s[12:15], s60 offen lds
    buffer_load_dwordx4 v7, s[12:15], s60 offen offset:1024 lds
    buffer_load_dwordx4 v8, s[12:15], s60 offen offset:2048 lds
    buffer_load_dwordx4 v9, s[12:15], s60 offen offset:3072 lds
    s_add_u32 s61, s60, 32768
    s_add_u32 m0, s4, 20480
    s_nop 0
    buffer_load_dwordx4 v6, s[12:15], s61 offen lds
    buffer_load_dwordx4 v7, s[12:15], s61 offen offset:1024 lds
    buffer_load_dwordx4 v8, s[12:15], s61 offen offset:2048 lds
    buffer_load_dwordx4 v9, s[12:15], s61 offen offset:3072 lds
    s_xor_b32 s7, s62, 196608
    s_add_u32 s60, s63, s7
    s_add_u32 m0, s4, 24576
    s_nop 0
    buffer_load_dwordx4 v6, s[12:15], s60 offen lds
    buffer_load_dwordx4 v7, s[12:15], s60 offen offset:1024 lds
    buffer_load_dwordx4 v8, s[12:15], s60 offen offset:2048 lds
    buffer_load_dwordx4 v9, s[12:15], s60 offen offset:3072 lds
    s_add_u32 s61, s60, 32768
    s_add_u32 m0, s4, 28672
    s_nop 0
    buffer_load_dwordx4 v6, s[12:15], s61 offen lds
    buffer_load_dwordx4 v7, s[12:15], s61 offen offset:1024 lds
    buffer_load_dwordx4 v8, s[12:15], s61 offen offset:2048 lds
    buffer_load_dwordx4 v9, s[12:15], s61 offen offset:3072 lds
    s_mov_b32 s68, 262144
L_g2o:
    v_mov_b32 v31, 1
    s_mov_b64 exec, 15
    v_mov_b32 v31, 0
    buffer_atomic_or v31, v11, s[44:47], s95 offen sc0 sc1
    s_mov_b64 exec, -1
    s_waitcnt vmcnt(0)
    v_cmp_ne_u32 vcc, 1, v31
    s_cbranch_vccz L_g2o_x
    s_sub_u32 s68, s68, 1
    s_cbranch_scc0 L_g2o
L_g2o_x:
    s_add_u32 s7, s52, 0
    s_and_b32 s7, s7, 3
    s_lshl_b32 s7, s7, 13
    s_add_u32 s7, s7, s96
    s_add_u32 s56, s59, s7
    s_xor_b32 s57, s59, 4096
    s_add_u32 s57, s57, s7
    buffer_load_dwordx4 a[0:3], v30, s[44:47], s56 offen offset:0 sc1
    buffer_load_dwordx4 a[4:7], v30, s[44:47], s56 offen offset:1024 sc1
    buffer_load_dwordx4 a[8:11], v30, s[44:47], s56 offen offset:2048 sc1
    buffer_load_dwordx4 a[12:15], v30, s[44:47], s56 offen offset:3072 sc1
    s_add_u32 s7, s52, 1
    s_and_b32 s7, s7, 3
    s_lshl_b32 s7, s7, 13
    s_add_u32 s7, s7, s96
    s_add_u32 s56, s59, s7
    s_xor_b32 s57, s59, 4096
    s_add_u32 s57, s57, s7
    buffer_load_dwordx4 a[32:35], v30, s[44:47], s56 offen offset:0 sc1
    buffer_load_dwordx4 a[36:39], v30, s[44:47], s56 offen offset:1024 sc1
    buffer_load_dwordx4 a[40:43], v30, s[44:47], s56 offen offset:2048 sc1
    buffer_load_dwordx4 a[44:47], v30, s[44:47], s56 offen offset:3072 sc1
    ds_read_b64_tr_b16 v[72:73], v22 offset:0
    ds_read_b64_tr_b16 v[74:75], v22 offset:1024
    ds_read_b64_tr_b16 v[76:77], v23 offset:0
    ds_read_b64_tr_b16 v[78:79], v23 offset:1024
    ds_read_b64_tr_b16 v[80:81], v22 offset:4096
    ds_read_b64_tr_b16 v[82:83], v22 offset:5120
    ds_read_b64_tr_b16 v[84:85], v23 offset:4096
    ds_read_b64_tr_b16 v[86:87], v23 offset:5120
    s_waitcnt lgkmcnt(6)
    s_waitcnt vmcnt(7)
    s_add_u32 s7, s52, 2
    s_and_b32 s7, s7, 3
    s_lshl_b32 s7, s7, 13
    s_add_u32 s7, s7, s96
    s_add_u32 s56, s59, s7
    s_xor_b32 s57, s59, 4096
    s_add_u32 s57, s57, s7
    buffer_load_dwordx4 a[64:67], v30, s[44:47], s56 offen offset:0 sc1
    v_mfma_f32_32x32x16_bf16 v[128:143], v[72:75], a[0:3], 0
    ds_read_b64_tr_b16 v[88:89], v22 offset:8192
    ds_read_b64_tr_b16 v[90:91], v22 offset:9216
    s_waitcnt lgkmcnt(6)
    v_mfma_f32_32x32x16_bf16 v[144:159], v[76:79], a[0:3], 0
    ds_read_b64_tr_b16 v[92:93], v23 offset:8192
    ds_read_b64_tr_b16 v[94:95], v23 offset:9216
    s_waitcnt lgkmcnt(6)
    s_waitcnt vmcnt(7)
    buffer_load_dwordx4 a[68:71], v30, s[44:47], s56 offen offset:1024 sc1
    v_mfma_f32_32x32x16_bf16 v[128:143], v[80:83], a[4:7], v[128:143]
    ds_read_b64_tr_b16 v[96:97], v22 offset:12288
    ds_read_b64_tr_b16 v[98:99], v22 offset:13312
    s_waitcnt lgkmcnt(6)
    v_mfma_f32_32x32x16_bf16 v[144:159], v[84:87], a[4:7], v[144:159]
    ds_read_b64_tr_b16 v[100:101], v23 offset:12288
    ds_read_b64_tr_b16 v[102:103], v23 offset:13312
    s_waitcnt lgkmcnt(6)
    s_waitcnt vmcnt(7)
    buffer_load_dwordx4 a[72:75], v30, s[44:47], s56 offen offset:2048 sc1
    v_mfma_f32_32x32x16_bf16 v[128:143], v[88:91], a[8:11], v[128:143]
    ds_read_b64_tr_b16 v[72:73], v22 offset:32768
    ds_read_b64_tr_b16 v[74:75], v22 offset:33792
    s_waitcnt lgkmcnt(6)
    v_mfma_f32_32x32x16_bf16 v[144:159], v[92:95], a[8:11], v[144:159]
    ds_read_b64_tr_b16 v[76:77], v23 offset:32768
    ds_read_b64_tr_b16 v[78:79], v23 offset:33792
    s_waitcnt lgkmcnt(6)
    s_waitcnt vmcnt(7)
    buffer_load_dwordx4 a[76:79], v30, s[44:47], s56 offen offset:3072 sc1
    v_mfma_f32_32x32x16_bf16 v[128:143], v[96:99], a[12:15], v[128:143]
    ds_read_b64_tr_b16 v[80:81], v22 offset:36864
    ds_read_b64_tr_b16 v[82:83], v22 offset:37888
    s_waitcnt lgkmcnt(6)
    v_mfma_f32_32x32x16_bf16 v[144:159], v[100:103], a[12:15], v[144:159]
    ds_read_b64_tr_b16 v[84:85], v23 offset:36864
    ds_read_b64_tr_b16 v[86:87], v23 offset:37888
    s_waitcnt lgkmcnt(6)
    s_waitcnt vmcnt(7)
    s_add_u32 s7, s52, 3
    s_and_b32 s7, s7, 3
    s_lshl_b32 s7, s7, 13
    s_add_u32 s7, s7, s96
    s_add_u32 s56, s59, s7
    s_xor_b32 s57, s59, 4096
    s_add_u32 s57, s57, s7
    buffer_load_dwordx4 a[96:99], v30, s[44:47], s56 offen offset:0 sc1
    v_mfma_f32_32x32x16_bf16 v[128:143], v[72:75], a[32:35], v[128:143]
    ds_read_b64_tr_b16 v[88:89], v22 offset:40960
    ds_read_b64_tr_b16 v[90:91], v22 offset:41984
    s_waitcnt lgkmcnt(6)
    v_mfma_f32_32x32x16_bf16 v[144:159], v[76:79], a[32:35], v[144:159]
    ds_read_b64_tr_b16 v[92:93], v23 offset:40960
    ds_read_b64_tr_b16 v[94:95], v23 offset:41984
    s_waitcnt lgkmcnt(6)
    s_waitcnt vmcnt(7)
    buffer_load_dwordx4 a[100:103], v30, s[44:47], s56 offen offset:1024 sc1
    v_mfma_f32_32x32x16_bf16 v[128:143], v[80:83], a[36:39], v[128:143]
    ds_read_b64_tr_b16 v[96:97], v22 offset:45056
    ds_read_b64_tr_b16 v[98:99], v22 offset:46080
    s_waitcnt lgkmcnt(6)
    v_mfma_f32_32x32x16_bf16 v[144:159], v[84:87], a[36:39], v[144:159]
    ds_read_b64_tr_b16 v[100:101], v23 offset:45056
    ds_read_b64_tr_b16 v[102:103], v23 offset:46080
    s_waitcnt lgkmcnt(6)
    s_waitcnt vmcnt(7)
    buffer_load_dwordx4 a[104:107], v30, s[44:47], s56 offen offset:2048 sc1
    v_mfma_f32_32x32x16_bf16 v[128:143], v[88:91], a[40:43], v[128:143]
    ds_read_b64_tr_b16 v[72:73], v26 offset:0
    ds_read_b64_tr_b16 v[74:75], v26 offset:1024
    s_waitcnt lgkmcnt(6)
    v_mfma_f32_32x32x16_bf16 v[144:159], v[92:95], a[40:43], v[144:159]
    ds_read_b64_tr_b16 v[76:77], v27 offset:0
    ds_read_b64_tr_b16 v[78:79], v27 offset:1024
    s_waitcnt lgkmcnt(6)
    s_waitcnt vmcnt(7)
    buffer_load_dwordx4 a[108:111], v30, s[44:47], s56 offen offset:3072 sc1
    v_mfma_f32_32x32x16_bf16 v[128:143], v[96:99], a[44:47], v[128:143]
    ds_read_b64_tr_b16 v[80:81], v26 offset:4096
    ds_read_b64_tr_b16 v[82:83], v26 offset:5120
    s_waitcnt lgkmcnt(6)
    v_mfma_f32_32x32x16_bf16 v[144:159], v[100:103], a[44:47], v[144:159]
    ds_read_b64_tr_b16 v[84:85], v27 offset:4096
    ds_read_b64_tr_b16 v[86:87], v27 offset:5120
    s_waitcnt lgkmcnt(6)
    s_waitcnt vmcnt(7)
    s_add_u32 s7, s52, 0
    s_and_b32 s7, s7, 3
    s_lshl_b32 s7, s7, 13
    s_add_u32 s7, s7, s96
    s_add_u32 s56, s59, s7
    s_xor_b32 s57, s59, 4096
    s_add_u32 s57, s57, s7
    buffer_load_dwordx4 a[16:19], v30, s[44:47], s57 offen offset:0 sc1
    v_mfma_f32_32x32x16_bf16 v[128:143], v[72:75], a[64:67], v[128:143]
    ds_read_b64_tr_b16 v[88:89], v26 offset:8192
    ds_read_b64_tr_b16 v[90:91], v26 offset:9216
    s_waitcnt lgkmcnt(6)
    v_mfma_f32_32x32x16_bf16 v[144:159], v[76:79], a[64:67], v[144:159]
    ds_read_b64_tr_b16 v[92:93], v27 offset:8192
    ds_read_b64_tr_b16 v[94:95], v27 offset:9216
    s_waitcnt lgkmcnt(6)
    s_waitcnt vmcnt(7)
    buffer_load_dwordx4 a[20:23], v30, s[44:47], s57 offen offset:1024 sc1
    v_mfma_f32_32x32x16_bf16 v[128:143], v[80:83], a[68:71], v[128:143]
    ds_read_b64_tr_b16 v[96:97], v26 offset:12288
    ds_read_b64_tr_b16 v[98:99], v26 offset:13312
    s_waitcnt lgkmcnt(6)
    v_mfma_f32_32x32x16_bf16 v[144:159], v[84:87], a[68:71], v[144:159]
    ds_read_b64_tr_b16 v[100:101], v27 offset:12288
    ds_read_b64_tr_b16 v[102:103], v27 offset:13312
    s_waitcnt lgkmcnt(6)
    s_waitcnt vmcnt(7)
    buffer_load_dwordx4 a[24:27], v30, s[44:47], s57 offen offset:2048 sc1
    v_mfma_f32_32x32x16_bf16 v[128:143], v[88:91], a[72:75], v[128:143]
    ds_read_b64_tr_b16 v[72:73], v26 offset:32768
    ds_read_b64_tr_b16 v[74:75], v26 offset:33792
    s_waitcnt lgkmcnt(6)
    v_mfma_f32_32x32x16_bf16 v[144:159], v[92:95], a[72:75], v[144:159]
    ds_read_b64_tr_b16 v[76:77], v27 offset:32768
    ds_read_b64_tr_b16 v[78:79], v27 offset:33792
    s_waitcnt lgkmcnt(6)
    s_waitcnt vmcnt(7)
    buffer_load_dwordx4 a[28:31], v30, s[44:47], s57 offen offset:3072 sc1
    v_mfma_f32_32x32x16_bf16 v[128:143], v[96:99], a[76:79], v[128:143]
    ds_read_b64_tr_b16 v[80:81], v26 offset:36864
    ds_read_b64_tr_b16 v[82:83], v26 offset:37888
    s_waitcnt lgkmcnt(6)
    v_mfma_f32_32x32x16_bf16 v[144:159], v[100:103], a[76:79], v[144:159]
    ds_read_b64_tr_b16 v[84:85], v27 offset:36864
    ds_read_b64_tr_b16 v[86:87], v27 offset:37888
    s_waitcnt lgkmcnt(6)
    s_waitcnt vmcnt(7)
    s_add_u32 s7, s52, 1
    s_and_b32 s7, s7, 3
    s_lshl_b32 s7, s7, 13
    s_add_u32 s7, s7, s96
    s_add_u32 s56, s59, s7
    s_xor_b32 s57, s59, 4096
    s_add_u32 s57, s57, s7
    buffer_load_dwordx4 a[48:51], v30, s[44:47], s57 offen offset:0 sc1
    v_mfma_f32_32x32x16_bf16 v[128:143], v[72:75], a[96:99], v[128:143]
    ds_read_b64_tr_b16 v[88:89], v26 offset:40960
    ds_read_b64_tr_b16 v[90:91], v26 offset:41984
    s_waitcnt lgkmcnt(6)
    v_mfma_f32_32x32x16_bf16 v[144:159], v[76:79], a[96:99], v[144:159]
    ds_read_b64_tr_b16 v[92:93], v27 offset:40960
    ds_read_b64_tr_b16 v[94:95], v27 offset:41984
    s_waitcnt lgkmcnt(6)
    s_waitcnt vmcnt(7)
    buffer_load_dwordx4 a[52:55], v30, s[44:47], s57 offen offset:1024 sc1
    v_mfma_f32_32x32x16_bf16 v[128:143], v[80:83], a[100:103], v[128:143]
    ds_read_b64_tr_b16 v[96:97], v26 offset:45056
    ds_read_b64_tr_b16 v[98:99], v26 offset:46080
    s_waitcnt lgkmcnt(6)
    v_mfma_f32_32x32x16_bf16 v[144:159], v[84:87], a[100:103], v[144:159]
    ds_read_b64_tr_b16 v[100:101], v27 offset:45056
    ds_read_b64_tr_b16 v[102:103], v27 offset:46080
L_g2go:
    s_barrier
    s_waitcnt lgkmcnt(6)
    s_waitcnt vmcnt(7)
    buffer_load_dwordx4 a[56:59], v30, s[44:47], s57 offen offset:2048 sc1
    v_mfma_f32_32x32x16_bf16 v[128:143], v[88:91], a[104:107], v[128:143]
    ds_read_b64_tr_b16 v[72:73], v22 offset:16384
    ds_read_b64_tr_b16 v[74:75], v22 offset:17408
    s_waitcnt lgkmcnt(6)
    v_mfma_f32_32x32x16_bf16 v[144:159], v[92:95], a[104:107], v[144:159]
    ds_read_b64_tr_b16 v[76:77], v23 offset:16384
    ds_read_b64_tr_b16 v[78:79], v23 offset:17408
    s_waitcnt lgkmcnt(6)
    s_waitcnt vmcnt(7)
    buffer_load_dwordx4 a[60:63], v30, s[44:47], s57 offen offset:3072 sc1
    v_mfma_f32_32x32x16_bf16 v[128:143], v[96:99], a[108:111], v[128:143]
    ds_read_b64_tr_b16 v[80:81], v22 offset:20480
    ds_read_b64_tr_b16 v[82:83], v22 offset:21504
    s_waitcnt lgkmcnt(6)
    v_mfma_f32_32x32x16_bf16 v[144:159], v[100:103], a[108:111], v[144:159]
    ds_read_b64_tr_b16 v[84:85], v23 offset:20480
    ds_read_b64_tr_b16 v[86:87], v23 offset:21504
    s_waitcnt lgkmcnt(6)
    s_waitcnt vmcnt(7)
    s_add_u32 s7, s52, 2
    s_and_b32 s7, s7, 3
    s_lshl_b32 s7, s7, 13
    s_add_u32 s7, s7, s96
    s_add_u32 s56, s59, s7
    s_xor_b32 s57, s59, 4096
    s_add_u32 s57, s57, s7
    buffer_load_dwordx4 a[80:83], v30, s[44:47], s57 offen offset:0 sc1
    v_mfma_f32_32x32x16_bf16 v[128:143], v[72:75], a[16:19], v[128:143]
    ds_read_b64_tr_b16 v[88:89], v22 offset:24576
    ds_read_b64_tr_b16 v[90:91], v22 offset:25600
    s_waitcnt lgkmcnt(6)
    v_mfma_f32_32x32x16_bf16 v[144:159], v[76:79], a[16:19], v[144:159]
    ds_read_b64_tr_b16 v[92:93], v23 offset:24576
    ds_read_b64_tr_b16 v[94:95], v23 offset:25600
    s_waitcnt lgkmcnt(6)
    s_waitcnt vmcnt(7)
    buffer_load_dwordx4 a[84:87], v30, s[44:47], s57 offen offset:1024 sc1
    v_mfma_f32_32x32x16_bf16 v[128:143], v[80:83], a[20:23], v[128:143]
    ds_read_b64_tr_b16 v[96:97], v22 offset:28672
    ds_read_b64_tr_b16 v[98:99], v22 offset:29696
    s_waitcnt lgkmcnt(6)
    v_mfma_f32_32x32x16_bf16 v[144:159], v[84:87], a[20:23], v[144:159]
    ds_read_b64_tr_b16 v[100:101], v23 offset:28672
    ds_read_b64_tr_b16 v[102:103], v23 offset:29696
    s_waitcnt lgkmcnt(6)
    s_waitcnt vmcnt(7)
    buffer_load_dwordx4 a[88:91], v30, s[44:47], s57 offen offset:2048 sc1
    v_mfma_f32_32x32x16_bf16 v[128:143], v[88:91], a[24:27], v[128:143]
    ds_read_b64_tr_b16 v[72:73], v22 offset:49152
    ds_read_b64_tr_b16 v[74:75], v22 offset:50176
    s_waitcnt lgkmcnt(6)
    v_mfma_f32_32x32x16_bf16 v[144:159], v[92:95], a[24:27], v[144:159]
    ds_read_b64_tr_b16 v[76:77], v23 offset:49152
    ds_read_b64_tr_b16 v[78:79], v23 offset:50176
    s_waitcnt lgkmcnt(6)
    s_waitcnt vmcnt(7)
    buffer_load_dwordx4 a[92:95], v30, s[44:47], s57 offen offset:3072 sc1
    v_mfma_f32_32x32x16_bf16 v[128:143], v[96:99], a[28:31], v[128:143]
    ds_read_b64_tr_b16 v[80:81], v22 offset:53248
    ds_read_b64_tr_b16 v[82:83], v22 offset:54272
    s_waitcnt lgkmcnt(6)
    v_mfma_f32_32x32x16_bf16 v[144:159], v[100:103], a[28:31], v[144:159]
    ds_read_b64_tr_b16 v[84:85], v23 offset:53248
    ds_read_b64_tr_b16 v[86:87], v23 offset:54272
    s_waitcnt lgkmcnt(6)
    s_waitcnt vmcnt(7)
    s_add_u32 s7, s52, 3
    s_and_b32 s7, s7, 3
    s_lshl_b32 s7, s7, 13
    s_add_u32 s7, s7, s96
    s_add_u32 s56, s59, s7
    s_xor_b32 s57, s59, 4096
    s_add_u32 s57, s57, s7
    buffer_load_dwordx4 a[112:115], v30, s[44:47], s57 offen offset:0 sc1
    v_mfma_f32_32x32x16_bf16 v[128:143], v[72:75], a[48:51], v[128:143]
    ds_read_b64_tr_b16 v[88:89], v22 offset:57344
    ds_read_b64_tr_b16 v[90:91], v22 offset:58368
    s_waitcnt lgkmcnt(6)
    v_mfma_f32_32x32x16_bf16 v[144:159], v[76:79], a[48:51], v[144:159]
    ds_read_b64_tr_b16 v[92:93], v23 offset:57344
    ds_read_b64_tr_b16 v[94:95], v23 offset:58368
    s_waitcnt lgkmcnt(6)
    s_waitcnt vmcnt(7)
    buffer_load_dwordx4 a[116:119], v30, s[44:47], s57 offen offset:1024 sc1
    v_mfma_f32_32x32x16_bf16 v[128:143], v[80:83], a[52:55], v[128:143]
    ds_read_b64_tr_b16 v[96:97], v22 offset:61440
    ds_read_b64_tr_b16 v[98:99], v22 offset:62464
    s_waitcnt lgkmcnt(6)
    v_mfma_f32_32x32x16_bf16 v[144:159], v[84:87], a[52:55], v[144:159]
    ds_read_b64_tr_b16 v[100:101], v23 offset:61440
    ds_read_b64_tr_b16 v[102:103], v23 offset:62464
    s_waitcnt lgkmcnt(6)
    s_waitcnt vmcnt(7)
    buffer_load_dwordx4 a[120:123], v30, s[44:47], s57 offen offset:2048 sc1
    v_mfma_f32_32x32x16_bf16 v[128:143], v[88:91], a[56:59], v[128:143]
    ds_read_b64_tr_b16 v[72:73], v26 offset:16384
    ds_read_b64_tr_b16 v[74:75], v26 offset:17408
    s_waitcnt lgkmcnt(6)
    v_mfma_f32_32x32x16_bf16 v[144:159], v[92:95], a[56:59], v[144:159]
    ds_read_b64_tr_b16 v[76:77], v27 offset:16384
    ds_read_b64_tr_b16 v[78:79], v27 offset:17408
    s_waitcnt lgkmcnt(6)
    s_waitcnt vmcnt(7)
    buffer_load_dwordx4 a[124:127], v30, s[44:47], s57 offen offset:3072 sc1
    v_mfma_f32_32x32x16_bf16 v[128:143], v[96:99], a[60:63], v[128:143]
    ds_read_b64_tr_b16 v[80:81], v26 offset:20480
    ds_read_b64_tr_b16 v[82:83], v26 offset:21504
    s_waitcnt lgkmcnt(6)
    v_mfma_f32_32x32x16_bf16 v[144:159], v[100:103], a[60:63], v[144:159]
    ds_read_b64_tr_b16 v[84:85], v27 offset:20480
    ds_read_b64_tr_b16 v[86:87], v27 offset:21504
    s_waitcnt lgkmcnt(6)
    s_waitcnt vmcnt(7)
    v_mfma_f32_32x32x16_bf16 v[128:143], v[72:75], a[80:83], v[128:143]
    ds_read_b64_tr_b16 v[88:89], v26 offset:24576
    ds_read_b64_tr_b16 v[90:91], v26 offset:25600
    s_waitcnt lgkmcnt(6)
    v_mfma_f32_32x32x16_bf16 v[144:159], v[76:79], a[80:83], v[144:159]
    ds_read_b64_tr_b16 v[92:93], v27 offset:24576
    ds_read_b64_tr_b16 v[94:95], v27 offset:25600
    s_waitcnt lgkmcnt(6)
    s_waitcnt vmcnt(6)
    v_mfma_f32_32x32x16_bf16 v[128:143], v[80:83], a[84:87], v[128:143]
    ds_read_b64_tr_b16 v[96:97], v26 offset:28672
    ds_read_b64_tr_b16 v[98:99], v26 offset:29696
    s_waitcnt lgkmcnt(6)
    v_mfma_f32_32x32x16_bf16 v[144:159], v[84:87], a[84:87], v[144:159]
    ds_read_b64_tr_b16 v[100:101], v27 offset:28672
    ds_read_b64_tr_b16 v[102:103], v27 offset:29696
    s_waitcnt lgkmcnt(6)
    s_waitcnt vmcnt(5)
    v_mfma_f32_32x32x16_bf16 v[128:143], v[88:91], a[88:91], v[128:143]
    ds_read_b64_tr_b16 v[72:73], v26 offset:49152
    ds_read_b64_tr_b16 v[74:75], v26 offset:50176
    s_waitcnt lgkmcnt(6)
    v_mfma_f32_32x32x16_bf16 v[144:159], v[92:95], a[88:91], v[144:159]
    ds_read_b64_tr_b16 v[76:77], v27 offset:49152
    ds_read_b64_tr_b16 v[78:79], v27 offset:50176
    s_waitcnt lgkmcnt(6)
    s_waitcnt vmcnt(4)
    v_mfma_f32_32x32x16_bf16 v[128:143], v[96:99], a[92:95], v[128:143]
    ds_read_b64_tr_b16 v[80:81], v26 offset:53248
    ds_read_b64_tr_b16 v[82:83], v26 offset:54272
    s_waitcnt lgkmcnt(6)
    v_mfma_f32_32x32x16_bf16 v[144:159], v[100:103], a[92:95], v[144:159]
    ds_read_b64_tr_b16 v[84:85], v27 offset:53248
    ds_read_b64_tr_b16 v[86:87], v27 offset:54272
    s_waitcnt lgkmcnt(6)
    s_waitcnt vmcnt(3)
    v_mfma_f32_32x32x16_bf16 v[128:143], v[72:75], a[112:115], v[128:143]
    ds_read_b64_tr_b16 v[88:89], v26 offset:57344
    ds_read_b64_tr_b16 v[90:91], v26 offset:58368
    s_waitcnt lgkmcnt(6)
    v_mfma_f32_32x32x16_bf16 v[144:159], v[76:79], a[112:115], v[144:159]
    ds_read_b64_tr_b16 v[92:93], v27 offset:57344
    ds_read_b64_tr_b16 v[94:95], v27 offset:58368
    s_waitcnt lgkmcnt(6)
    s_waitcnt vmcnt(2)
    v_mfma_f32_32x32x16_bf16 v[128:143], v[80:83], a[116:119], v[128:143]
    ds_read_b64_tr_b16 v[96:97], v26 offset:61440
    ds_read_b64_tr_b16 v[98:99], v26 offset:62464
    s_waitcnt lgkmcnt(6)
    v_mfma_f32_32x32x16_bf16 v[144:159], v[84:87], a[116:119], v[144:159]
    ds_read_b64_tr_b16 v[100:101], v27 offset:61440
    ds_read_b64_tr_b16 v[102:103], v27 offset:62464
    s_waitcnt lgkmcnt(6)
    s_waitcnt vmcnt(1)
    v_mfma_f32_32x32x16_bf16 v[128:143], v[88:91], a[120:123], v[128:143]
    ds_read_b64_tr_b16 v[72:73], v24 offset:0
    ds_read_b64_tr_b16 v[74:75], v24 offset:1024
    s_waitcnt lgkmcnt(6)
    v_mfma_f32_32x32x16_bf16 v[144:159], v[92:95], a[120:123], v[144:159]
    ds_read_b64_tr_b16 v[76:77], v24 offset:4096
    ds_read_b64_tr_b16 v[78:79], v24 offset:5120
    s_waitcnt lgkmcnt(6)
    s_waitcnt vmcnt(0)
    v_mfma_f32_32x32x16_bf16 v[128:143], v[96:99], a[124:127], v[128:143]
    ds_read_b64_tr_b16 v[80:81], v24 offset:8192
    ds_read_b64_tr_b16 v[82:83], v24 offset:9216
    s_waitcnt lgkmcnt(6)
    v_mfma_f32_32x32x16_bf16 v[144:159], v[100:103], a[124:127], v[144:159]
    ds_read_b64_tr_b16 v[84:85], v24 offset:12288
    ds_read_b64_tr_b16 v[86:87], v24 offset:13312
    s_waitcnt lgkmcnt(6)
    v_mfma_f32_32x32x16_bf16 v[160:175], v[72:75], a[0:3], 0
    ds_read_b64_tr_b16 v[88:89], v24 offset:32768
    ds_read_b64_tr_b16 v[90:91], v24 offset:33792
    s_waitcnt lgkmcnt(6)
    v_mfma_f32_32x32x16_bf16 v[160:175], v[76:79], a[4:7], v[160:175]
    ds_read_b64_tr_b16 v[92:93], v24 offset:36864
    ds_read_b64_tr_b16 v[94:95], v24 offset:37888
    s_waitcnt lgkmcnt(6)
    v_mfma_f32_32x32x16_bf16 v[160:175], v[80:83], a[8:11], v[160:175]
    ds_read_b64_tr_b16 v[96:97], v24 offset:40960
    ds_read_b64_tr_b16 v[98:99], v24 offset:41984
    v_cvt_pk_bf16_f32 v192, v128, v129
    v_cvt_pk_bf16_f32 v193, v130, v131
    s_waitcnt lgkmcnt(6)
    v_mfma_f32_32x32x16_bf16 v[160:175], v[84:87], a[12:15], v[160:175]
    ds_read_b64_tr_b16 v[100:101], v24 offset:45056
    ds_read_b64_tr_b16 v[102:103], v24 offset:46080
    v_cvt_pk_bf16_f32 v194, v132, v133
    v_cvt_pk_bf16_f32 v195, v134, v135
    s_waitcnt lgkmcnt(6)
    v_mfma_f32_32x32x16_bf16 v[160:175], v[88:91], a[32:35], v[160:175]
    ds_read_b64_tr_b16 v[72:73], v28 offset:0
    ds_read_b64_tr_b16 v[74:75], v28 offset:1024
    v_cvt_pk_bf16_f32 v196, v136, v137
    v_cvt_pk_bf16_f32 v197, v138, v139
    s_waitcnt lgkmcnt(6)
    v_mfma_f32_32x32x16_bf16 v[160:175], v[92:95], a[36:39], v[160:175]
    ds_read_b64_tr_b16 v[76:77], v28 offset:4096
    ds_read_b64_tr_b16 v[78:79], v28 offset:5120
    v_cvt_pk_bf16_f32 v198, v140, v141
    v_cvt_pk_bf16_f32 v199, v142, v143
    s_waitcnt lgkmcnt(6)
    v_mfma_f32_32x32x16_bf16 v[160:175], v[96:99], a[40:43], v[160:175]
    ds_read_b64_tr_b16 v[80:81], v28 offset:8192
    ds_read_b64_tr_b16 v[82:83], v28 offset:9216
    buffer_store_dwordx4 v[192:195], v10, s[44:47], s58 offen offset:0 sc1
    buffer_store_dwordx4 v[196:199], v10, s[44:47], s58 offen offset:512 sc1
    s_waitcnt lgkmcnt(6)
    v_mfma_f32_32x32x16_bf16 v[160:175], v[100:103], a[44:47], v[160:175]
    ds_read_b64_tr_b16 v[84:85], v28 offset:12288
    ds_read_b64_tr_b16 v[86:87], v28 offset:13312
    v_cvt_pk_bf16_f32 v200, v144, v145
    v_cvt_pk_bf16_f32 v201, v146, v147
    s_waitcnt lgkmcnt(6)
    v_mfma_f32_32x32x16_bf16 v[160:175], v[72:75], a[64:67], v[160:175]
    ds_read_b64_tr_b16 v[88:89], v28 offset:32768
    ds_read_b64_tr_b16 v[90:91], v28 offset:33792
    v_cvt_pk_bf16_f32 v202, v148, v149
    v_cvt_pk_bf16_f32 v203, v150, v151
    s_waitcnt lgkmcnt(6)
    v_mfma_f32_32x32x16_bf16 v[160:175], v[76:79], a[68:71], v[160:175]
    ds_read_b64_tr_b16 v[92:93], v28 offset:36864
    ds_read_b64_tr_b16 v[94:95], v28 offset:37888
    v_cvt_pk_bf16_f32 v204, v152, v153
    v_cvt_pk_bf16_f32 v205, v154, v155
    s_waitcnt lgkmcnt(6)
    v_mfma_f32_32x32x16_bf16 v[160:175], v[80:83], a[72:75], v[160:175]
    ds_read_b64_tr_b16 v[96:97], v28 offset:40960
    ds_read_b64_tr_b16 v[98:99], v28 offset:41984
    v_cvt_pk_bf16_f32 v206, v156, v157
    v_cvt_pk_bf16_f32 v207, v158, v159
    s_waitcnt lgkmcnt(6)
    v_mfma_f32_32x32x16_bf16 v[160:175], v[84:87], a[76:79], v[160:175]
    ds_read_b64_tr_b16 v[100:101], v28 offset:45056
    ds_read_b64_tr_b16 v[102:103], v28 offset:46080
    buffer_store_dwordx4 v[200:203], v10, s[44:47], s58 offen offset:1024 sc1
    buffer_store_dwordx4 v[204:207], v10, s[44:47], s58 offen offset:1536 sc1
    s_waitcnt lgkmcnt(6)
    v_mfma_f32_32x32x16_bf16 v[160:175], v[88:91], a[96:99], v[160:175]
    ds_read_b64_tr_b16 v[72:73], v24 offset:16384
    ds_read_b64_tr_b16 v[74:75], v24 offset:17408
    s_waitcnt lgkmcnt(6)
    v_mfma_f32_32x32x16_bf16 v[160:175], v[92:95], a[100:103], v[160:175]
    ds_read_b64_tr_b16 v[76:77], v24 offset:20480
    ds_read_b64_tr_b16 v[78:79], v24 offset:21504
    s_waitcnt lgkmcnt(6)
    v_mfma_f32_32x32x16_bf16 v[160:175], v[96:99], a[104:107], v[160:175]
    ds_read_b64_tr_b16 v[80:81], v24 offset:24576
    ds_read_b64_tr_b16 v[82:83], v24 offset:25600
    s_waitcnt lgkmcnt(6)
    v_mfma_f32_32x32x16_bf16 v[160:175], v[100:103], a[108:111], v[160:175]
    ds_read_b64_tr_b16 v[84:85], v24 offset:28672
    ds_read_b64_tr_b16 v[86:87], v24 offset:29696
    s_waitcnt lgkmcnt(6)
    v_mfma_f32_32x32x16_bf16 v[160:175], v[72:75], a[16:19], v[160:175]
    ds_read_b64_tr_b16 v[88:89], v24 offset:49152
    ds_read_b64_tr_b16 v[90:91], v24 offset:50176
    s_waitcnt lgkmcnt(6)
    v_mfma_f32_32x32x16_bf16 v[160:175], v[76:79], a[20:23], v[160:175]
    ds_read_b64_tr_b16 v[92:93], v24 offset:53248
    ds_read_b64_tr_b16 v[94:95], v24 offset:54272
    s_waitcnt lgkmcnt(6)
    v_mfma_f32_32x32x16_bf16 v[160:175], v[80:83], a[24:27], v[160:175]
    ds_read_b64_tr_b16 v[96:97], v24 offset:57344
    ds_read_b64_tr_b16 v[98:99], v24 offset:58368
    s_waitcnt lgkmcnt(6)
    v_mfma_f32_32x32x16_bf16 v[160:175], v[84:87], a[28:31], v[160:175]
    ds_read_b64_tr_b16 v[100:101], v24 offset:61440
    ds_read_b64_tr_b16 v[102:103], v24 offset:62464
    s_waitcnt lgkmcnt(6)
    v_mfma_f32_32x32x16_bf16 v[160:175], v[88:91], a[48:51], v[160:175]
    ds_read_b64_tr_b16 v[72:73], v28 offset:16384
    ds_read_b64_tr_b16 v[74:75], v28 offset:17408
    s_waitcnt lgkmcnt(6)
    v_mfma_f32_32x32x16_bf16 v[160:175], v[92:95], a[52:55], v[160:175]
    ds_read_b64_tr_b16 v[76:77], v28 offset:20480
    ds_read_b64_tr_b16 v[78:79], v28 offset:21504
    s_waitcnt lgkmcnt(6)
    v_mfma_f32_32x32x16_bf16 v[160:175], v[96:99], a[56:59], v[160:175]
    ds_read_b64_tr_b16 v[80:81], v28 offset:24576
    ds_read_b64_tr_b16 v[82:83], v28 offset:25600
    s_waitcnt lgkmcnt(6)
    v_mfma_f32_32x32x16_bf16 v[160:175], v[100:103], a[60:63], v[160:175]
    ds_read_b64_tr_b16 v[84:85], v28 offset:28672
    ds_read_b64_tr_b16 v[86:87], v28 offset:29696
    s_waitcnt lgkmcnt(6)
    v_mfma_f32_32x32x16_bf16 v[160:175], v[72:75], a[80:83], v[160:175]
    ds_read_b64_tr_b16 v[88:89], v28 offset:49152
    ds_read_b64_tr_b16 v[90:91], v28 offset:50176
    s_waitcnt lgkmcnt(6)
    v_mfma_f32_32x32x16_bf16 v[160:175], v[76:79], a[84:87], v[160:175]
    ds_read_b64_tr_b16 v[92:93], v28 offset:53248
    ds_read_b64_tr_b16 v[94:95], v28 offset:54272
    s_waitcnt lgkmcnt(6)
    v_mfma_f32_32x32x16_bf16 v[160:175], v[80:83], a[88:91], v[160:175]
    ds_read_b64_tr_b16 v[96:97], v28 offset:57344
    ds_read_b64_tr_b16 v[98:99], v28 offset:58368
    s_waitcnt lgkmcnt(6)
    v_mfma_f32_32x32x16_bf16 v[160:175], v[84:87], a[92:95], v[160:175]
    ds_read_b64_tr_b16 v[100:101], v28 offset:61440
    ds_read_b64_tr_b16 v[102:103], v28 offset:62464
    s_waitcnt lgkmcnt(6)
    v_mfma_f32_32x32x16_bf16 v[160:175], v[88:91], a[112:115], v[160:175]
    ds_read_b64_tr_b16 v[72:73], v25 offset:0
    ds_read_b64_tr_b16 v[74:75], v25 offset:1024
    s_waitcnt lgkmcnt(6)
    v_mfma_f32_32x32x16_bf16 v[160:175], v[92:95], a[116:119], v[160:175]
    ds_read_b64_tr_b16 v[76:77], v25 offset:4096
    ds_read_b64_tr_b16 v[78:79], v25 offset:5120
    s_waitcnt lgkmcnt(6)
    v_mfma_f32_32x32x16_bf16 v[160:175], v[96:99], a[120:123], v[160:175]
    ds_read_b64_tr_b16 v[80:81], v25 offset:8192
    ds_read_b64_tr_b16 v[82:83], v25 offset:9216
    s_waitcnt lgkmcnt(6)
    v_mfma_f32_32x32x16_bf16 v[160:175], v[100:103], a[124:127], v[160:175]
    ds_read_b64_tr_b16 v[84:85], v25 offset:12288
    ds_read_b64_tr_b16 v[86:87], v25 offset:13312
    s_waitcnt lgkmcnt(6)
    v_mfma_f32_32x32x16_bf16 v[176:191], v[72:75], a[0:3], 0
    ds_read_b64_tr_b16 v[88:89], v25 offset:32768
    ds_read_b64_tr_b16 v[90:91], v25 offset:33792
    s_waitcnt lgkmcnt(6)
    v_mfma_f32_32x32x16_bf16 v[176:191], v[76:79], a[4:7], v[176:191]
    ds_read_b64_tr_b16 v[92:93], v25 offset:36864
    ds_read_b64_tr_b16 v[94:95], v25 offset:37888
    s_waitcnt lgkmcnt(6)
    v_mfma_f32_32x32x16_bf16 v[176:191], v[80:83], a[8:11], v[176:191]
    ds_read_b64_tr_b16 v[96:97], v25 offset:40960
    ds_read_b64_tr_b16 v[98:99], v25 offset:41984
    s_waitcnt lgkmcnt(6)
    v_mfma_f32_32x32x16_bf16 v[176:191], v[84:87], a[12:15], v[176:191]
    ds_read_b64_tr_b16 v[100:101], v25 offset:45056
    ds_read_b64_tr_b16 v[102:103], v25 offset:46080
    v_cvt_pk_bf16_f32 v208, v160, v161
    v_cvt_pk_bf16_f32 v209, v162, v163
    s_waitcnt lgkmcnt(6)
    v_mfma_f32_32x32x16_bf16 v[176:191], v[88:91], a[32:35], v[176:191]
    ds_read_b64_tr_b16 v[72:73], v29 offset:0
    ds_read_b64_tr_b16 v[74:75], v29 offset:1024
    v_cvt_pk_bf16_f32 v210, v164, v165
    v_cvt_pk_bf16_f32 v211, v166, v167
    s_waitcnt lgkmcnt(6)
    v_mfma_f32_32x32x16_bf16 v[176:191], v[92:95], a[36:39], v[176:191]
    ds_read_b64_tr_b16 v[76:77], v29 offset:4096
    ds_read_b64_tr_b16 v[78:79], v29 offset:5120
    v_cvt_pk_bf16_f32 v212, v168, v169
    v_cvt_pk_bf16_f32 v213, v170, v171
    s_waitcnt lgkmcnt(6)
    v_mfma_f32_32x32x16_bf16 v[176:191], v[96:99], a[40:43], v[176:191]
    ds_read_b64_tr_b16 v[80:81], v29 offset:8192
    ds_read_b64_tr_b16 v[82:83], v29 offset:9216
    v_cvt_pk_bf16_f32 v214, v172, v173
    v_cvt_pk_bf16_f32 v215, v174, v175
    s_waitcnt lgkmcnt(6)
    v_mfma_f32_32x32x16_bf16 v[176:191], v[100:103], a[44:47], v[176:191]
    ds_read_b64_tr_b16 v[84:85], v29 offset:12288
    ds_read_b64_tr_b16 v[86:87], v29 offset:13312
    buffer_store_dwordx4 v[208:211], v10, s[44:47], s58 offen offset:2048 sc1
    buffer_store_dwordx4 v[212:215], v10, s[44:47], s58 offen offset:2560 sc1
    s_waitcnt lgkmcnt(6)
    v_mfma_f32_32x32x16_bf16 v[176:191], v[72:75], a[64:67], v[176:191]
    ds_read_b64_tr_b16 v[88:89], v29 offset:32768
    ds_read_b64_tr_b16 v[90:91], v29 offset:33792
    s_waitcnt lgkmcnt(6)
    v_mfma_f32_32x32x16_bf16 v[176:191], v[76:79], a[68:71], v[176:191]
    ds_read_b64_tr_b16 v[92:93], v29 offset:36864
    ds_read_b64_tr_b16 v[94:95], v29 offset:37888
    s_waitcnt lgkmcnt(6)
    v_mfma_f32_32x32x16_bf16 v[176:191], v[80:83], a[72:75], v[176:191]
    ds_read_b64_tr_b16 v[96:97], v29 offset:40960
    ds_read_b64_tr_b16 v[98:99], v29 offset:41984
    s_waitcnt lgkmcnt(6)
    v_mfma_f32_32x32x16_bf16 v[176:191], v[84:87], a[76:79], v[176:191]
    ds_read_b64_tr_b16 v[100:101], v29 offset:45056
    ds_read_b64_tr_b16 v[102:103], v29 offset:46080
    s_waitcnt lgkmcnt(6)
    v_mfma_f32_32x32x16_bf16 v[176:191], v[88:91], a[96:99], v[176:191]
    ds_read_b64_tr_b16 v[72:73], v25 offset:16384
    ds_read_b64_tr_b16 v[74:75], v25 offset:17408
    s_waitcnt lgkmcnt(6)
    v_mfma_f32_32x32x16_bf16 v[176:191], v[92:95], a[100:103], v[176:191]
    ds_read_b64_tr_b16 v[76:77], v25 offset:20480
    ds_read_b64_tr_b16 v[78:79], v25 offset:21504
    s_waitcnt lgkmcnt(6)
    v_mfma_f32_32x32x16_bf16 v[176:191], v[96:99], a[104:107], v[176:191]
    ds_read_b64_tr_b16 v[80:81], v25 offset:24576
    ds_read_b64_tr_b16 v[82:83], v25 offset:25600
    s_waitcnt lgkmcnt(6)
    v_mfma_f32_32x32x16_bf16 v[176:191], v[100:103], a[108:111], v[176:191]
    ds_read_b64_tr_b16 v[84:85], v25 offset:28672
    ds_read_b64_tr_b16 v[86:87], v25 offset:29696
    s_waitcnt lgkmcnt(6)
    v_mfma_f32_32x32x16_bf16 v[176:191], v[72:75], a[16:19], v[176:191]
    ds_read_b64_tr_b16 v[88:89], v25 offset:49152
    ds_read_b64_tr_b16 v[90:91], v25 offset:50176
    s_waitcnt lgkmcnt(6)
    v_mfma_f32_32x32x16_bf16 v[176:191], v[76:79], a[20:23], v[176:191]
    ds_read_b64_tr_b16 v[92:93], v25 offset:53248
    ds_read_b64_tr_b16 v[94:95], v25 offset:54272
    s_waitcnt lgkmcnt(6)
    v_mfma_f32_32x32x16_bf16 v[176:191], v[80:83], a[24:27], v[176:191]
    ds_read_b64_tr_b16 v[96:97], v25 offset:57344
    ds_read_b64_tr_b16 v[98:99], v25 offset:58368
    s_waitcnt lgkmcnt(6)
    v_mfma_f32_32x32x16_bf16 v[176:191], v[84:87], a[28:31], v[176:191]
    ds_read_b64_tr_b16 v[100:101], v25 offset:61440
    ds_read_b64_tr_b16 v[102:103], v25 offset:62464
    s_waitcnt lgkmcnt(6)
    v_mfma_f32_32x32x16_bf16 v[176:191], v[88:91], a[48:51], v[176:191]
    ds_read_b64_tr_b16 v[72:73], v29 offset:16384
    ds_read_b64_tr_b16 v[74:75], v29 offset:17408
    s_waitcnt lgkmcnt(6)
    v_mfma_f32_32x32x16_bf16 v[176:191], v[92:95], a[52:55], v[176:191]
    ds_read_b64_tr_b16 v[76:77], v29 offset:20480
    ds_read_b64_tr_b16 v[78:79], v29 offset:21504
    s_waitcnt lgkmcnt(6)
    v_mfma_f32_32x32x16_bf16 v[176:191], v[96:99], a[56:59], v[176:191]
    ds_read_b64_tr_b16 v[80:81], v29 offset:24576
    ds_read_b64_tr_b16 v[82:83], v29 offset:25600
    s_waitcnt lgkmcnt(6)
    v_mfma_f32_32x32x16_bf16 v[176:191], v[100:103], a[60:63], v[176:191]
    ds_read_b64_tr_b16 v[84:85], v29 offset:28672
    ds_read_b64_tr_b16 v[86:87], v29 offset:29696
    s_waitcnt lgkmcnt(6)
    v_mfma_f32_32x32x16_bf16 v[176:191], v[72:75], a[80:83], v[176:191]
    ds_read_b64_tr_b16 v[88:89], v29 offset:49152
    ds_read_b64_tr_b16 v[90:91], v29 offset:50176
    s_waitcnt lgkmcnt(6)
    v_mfma_f32_32x32x16_bf16 v[176:191], v[76:79], a[84:87], v[176:191]
    ds_read_b64_tr_b16 v[92:93], v29 offset:53248
    ds_read_b64_tr_b16 v[94:95], v29 offset:54272
    s_waitcnt lgkmcnt(6)
    v_mfma_f32_32x32x16_bf16 v[176:191], v[80:83], a[88:91], v[176:191]
    ds_read_b64_tr_b16 v[96:97], v29 offset:57344
    ds_read_b64_tr_b16 v[98:99], v29 offset:58368
    s_waitcnt lgkmcnt(6)
    v_mfma_f32_32x32x16_bf16 v[176:191], v[84:87], a[92:95], v[176:191]
    ds_read_b64_tr_b16 v[100:101], v29 offset:61440
    ds_read_b64_tr_b16 v[102:103], v29 offset:62464
    s_waitcnt lgkmcnt(6)
    v_mfma_f32_32x32x16_bf16 v[176:191], v[88:91], a[112:115], v[176:191]
    s_waitcnt lgkmcnt(4)
    v_mfma_f32_32x32x16_bf16 v[176:191], v[92:95], a[116:119], v[176:191]
    s_waitcnt lgkmcnt(2)
    v_mfma_f32_32x32x16_bf16 v[176:191], v[96:99], a[120:123], v[176:191]
    s_waitcnt lgkmcnt(0)
    v_mfma_f32_32x32x16_bf16 v[176:191], v[100:103], a[124:127], v[176:191]
    s_nop 11
    v_cvt_pk_bf16_f32 v216, v176, v177
    v_cvt_pk_bf16_f32 v217, v178, v179
    v_cvt_pk_bf16_f32 v218, v180, v181
    v_cvt_pk_bf16_f32 v219, v182, v183
    v_cvt_pk_bf16_f32 v220, v184, v185
    v_cvt_pk_bf16_f32 v221, v186, v187
    v_cvt_pk_bf16_f32 v222, v188, v189
    v_cvt_pk_bf16_f32 v223, v190, v191
    buffer_store_dwordx4 v[216:219], v10, s[44:47], s58 offen offset:3072 sc1
    buffer_store_dwordx4 v[220:223], v10, s[44:47], s58 offen offset:3584 sc1
    s_waitcnt vmcnt(0)
    v_mov_b32 v31, 1
    v_lshlrev_b32 v103, 2, v1
    s_mov_b64 exec, 1
    buffer_store_dword v31, v103, s[44:47], s93 offen sc1
    s_mov_b64 exec, -1
    s_cmp_lg_u32 s3, 0
    s_cbranch_scc1 L_g2red_x
    s_mov_b32 s68, 262144
L_g2red:
    v_mov_b32 v31, 1
    s_mov_b64 exec, 255
    v_mov_b32 v31, 0
    buffer_atomic_or v31, v15, s[44:47], s64 offen sc0 sc1
    s_mov_b64 exec, -1
    s_waitcnt vmcnt(0)
    v_cmp_ne_u32 vcc, 1, v31
    s_cbranch_vccz L_g2red_x
    s_sub_u32 s68, s68, 1
    s_cbranch_scc0 L_g2red
L_g2red_x:
    s_barrier
    buffer_load_dwordx4 v[72:75], v13, s[44:47], s53 offen sc1
    s_add_u32 s53, s53, 4096
    buffer_load_dwordx4 v[76:79], v13, s[44:47], s53 offen sc1
    s_add_u32 s53, s53, 4096
    buffer_load_dwordx4 v[80:83], v13, s[44:47], s53 offen sc1
    s_add_u32 s53, s53, 4096
    buffer_load_dwordx4 v[84:87], v13, s[44:47], s53 offen sc1
    buffer_load_dwordx4 v[88:91], v13, s[44:47], s54 offen sc1
    s_add_u32 s54, s54, 4096
    buffer_load_dwordx4 v[92:95], v13, s[44:47], s54 offen sc1
    s_add_u32 s54, s54, 4096
    buffer_load_dwordx4 v[96:99], v13, s[44:47], s54 offen sc1
    s_add_u32 s54, s54, 4096
    buffer_load_dwordx4 v[100:103], v13, s[44:47], s54 offen sc1
    s_waitcnt vmcnt(7)
    v_lshlrev_b32 v128, 16, v72
    v_and_b32 v129, 0xffff0000, v72
    v_lshlrev_b32 v130, 16, v73
    v_and_b32 v131, 0xffff0000, v73
    v_lshlrev_b32 v132, 16, v74
    v_and_b32 v133, 0xffff0000, v74
    v_lshlrev_b32 v134, 16, v75
    v_and_b32 v135, 0xffff0000, v75
    s_waitcnt vmcnt(6)
    v_lshlrev_b32 v136, 16, v76
    v_and_b32 v137, 0xffff0000, v76
    v_lshlrev_b32 v138, 16, v77
    v_and_b32 v139, 0xffff0000, v77
    v_lshlrev_b32 v140, 16, v78
    v_and_b32 v141, 0xffff0000, v78
    v_lshlrev_b32 v142, 16, v79
    v_and_b32 v143, 0xffff0000, v79
    v_pk_add_f32 v[128:129], v[128:129], v[136:137]
    v_pk_add_f32 v[130:131], v[130:131], v[138:139]
    v_pk_add_f32 v[132:133], v[132:133], v[140:141]
    v_pk_add_f32 v[134:135], v[134:135], v[142:143]
    s_waitcnt vmcnt(5)
    v_lshlrev_b32 v136, 16, v80
    v_and_b32 v137, 0xffff0000, v80
    v_lshlrev_b32 v138, 16, v81
    v_and_b32 v139, 0xffff0000, v81
    v_lshlrev_b32 v140, 16, v82
    v_and_b32 v141, 0xffff0000, v82
    v_lshlrev_b32 v142, 16, v83
    v_and_b32 v143, 0xffff0000, v83
    v_pk_add_f32 v[128:129], v[128:129], v[136:137]
    v_pk_add_f32 v[130:131], v[130:131], v[138:139]
    v_pk_add_f32 v[132:133], v[132:133], v[140:141]
    v_pk_add_f32 v[134:135], v[134:135], v[142:143]
    s_waitcnt vmcnt(4)
    v_lshlrev_b32 v136, 16, v84
    v_and_b32 v137, 0xffff0000, v84
    v_lshlrev_b32 v138, 16, v85
    v_and_b32 v139, 0xffff0000, v85
    v_lshlrev_b32 v140, 16, v86
    v_and_b32 v141, 0xffff0000, v86
    v_lshlrev_b32 v142, 16, v87
    v_and_b32 v143, 0xffff0000, v87
    v_pk_add_f32 v[128:129], v[128:129], v[136:137]
    v_pk_add_f32 v[130:131], v[130:131], v[138:139]
    v_pk_add_f32 v[132:133], v[132:133], v[140:141]
    v_pk_add_f32 v[134:135], v[134:135], v[142:143]
    s_waitcnt vmcnt(3)
    v_lshlrev_b32 v136, 16, v88
    v_and_b32 v137, 0xffff0000, v88
    v_lshlrev_b32 v138, 16, v89
    v_and_b32 v139, 0xffff0000, v89
    v_lshlrev_b32 v140, 16, v90
    v_and_b32 v141, 0xffff0000, v90
    v_lshlrev_b32 v142, 16, v91
    v_and_b32 v143, 0xffff0000, v91
    v_pk_add_f32 v[128:129], v[128:129], v[136:137]
    v_pk_add_f32 v[130:131], v[130:131], v[138:139]
    v_pk_add_f32 v[132:133], v[132:133], v[140:141]
    v_pk_add_f32 v[134:135], v[134:135], v[142:143]
    s_waitcnt vmcnt(2)
    v_lshlrev_b32 v136, 16, v92
    v_and_b32 v137, 0xffff0000, v92
    v_lshlrev_b32 v138, 16, v93
    v_and_b32 v139, 0xffff0000, v93
    v_lshlrev_b32 v140, 16, v94
    v_and_b32 v141, 0xffff0000, v94
    v_lshlrev_b32 v142, 16, v95
    v_and_b32 v143, 0xffff0000, v95
    v_pk_add_f32 v[128:129], v[128:129], v[136:137]
    v_pk_add_f32 v[130:131], v[130:131], v[138:139]
    v_pk_add_f32 v[132:133], v[132:133], v[140:141]
    v_pk_add_f32 v[134:135], v[134:135], v[142:143]
    s_waitcnt vmcnt(1)
    v_lshlrev_b32 v136, 16, v96
    v_and_b32 v137, 0xffff0000, v96
    v_lshlrev_b32 v138, 16, v97
    v_and_b32 v139, 0xffff0000, v97
    v_lshlrev_b32 v140, 16, v98
    v_and_b32 v141, 0xffff0000, v98
    v_lshlrev_b32 v142, 16, v99
    v_and_b32 v143, 0xffff0000, v99
    v_pk_add_f32 v[128:129], v[128:129], v[136:137]
    v_pk_add_f32 v[130:131], v[130:131], v[138:139]
    v_pk_add_f32 v[132:133], v[132:133], v[140:141]
    v_pk_add_f32 v[134:135], v[134:135], v[142:143]
    s_waitcnt vmcnt(0)
    v_lshlrev_b32 v136, 16, v100
    v_and_b32 v137, 0xffff0000, v100
    v_lshlrev_b32 v138, 16, v101
    v_and_b32 v139, 0xffff0000, v101
    v_lshlrev_b32 v140, 16, v102
    v_and_b32 v141, 0xffff0000, v102
    v_lshlrev_b32 v142, 16, v103
    v_and_b32 v143, 0xffff0000, v103
    v_pk_add_f32 v[128:129], v[128:129], v[136:137]
    v_pk_add_f32 v[130:131], v[130:131], v[138:139]
    v_pk_add_f32 v[132:133], v[132:133], v[140:141]
    v_pk_add_f32 v[134:135], v[134:135], v[142:143]
    v_cvt_pk_bf16_f32 v144, v128, v129
    v_cvt_pk_bf16_f32 v145, v130, v131
    v_cvt_pk_bf16_f32 v146, v132, v133
    v_cvt_pk_bf16_f32 v147, v134, v135
    buffer_store_dwordx4 v[144:147], v14, s[8:11], s66 offen
    s_endpgm
L_g2early:
    s_add_u32 s7, s52, 0
    s_and_b32 s7, s7, 3
    s_lshl_b32 s7, s7, 13
    s_add_u32 s7, s7, s96
    s_add_u32 s56, s59, s7
    s_xor_b32 s57, s59, 4096
    s_add_u32 s57, s57, s7
    buffer_load_dwordx4 a[0:3], v30, s[44:47], s56 offen offset:0 sc1
    buffer_load_dwordx4 a[4:7], v30, s[44:47], s56 offen offset:1024 sc1
    buffer_load_dwordx4 a[8:11], v30, s[44:47], s56 offen offset:2048 sc1
    buffer_load_dwordx4 a[12:15], v30, s[44:47], s56 offen offset:3072 sc1
    s_add_u32 s7, s52, 1
    s_and_b32 s7, s7, 3
    s_lshl_b32 s7, s7, 13
    s_add_u32 s7, s7, s96
    s_add_u32 s56, s59, s7
    s_xor_b32 s57, s59, 4096
    s_add_u32 s57, s57, s7
    buffer_load_dwordx4 a[32:35], v30, s[44:47], s56 offen offset:0 sc1
    buffer_load_dwordx4 a[36:39], v30, s[44:47], s56 offen offset:1024 sc1
    buffer_load_dwordx4 a[40:43], v30, s[44:47], s56 offen offset:2048 sc1
    buffer_load_dwordx4 a[44:47], v30, s[44:47], s56 offen offset:3072 sc1
    s_waitcnt vmcnt(8)
    s_barrier
    s_cmp_lg_u32 s3, 0
    s_cbranch_scc1 L_g2pub2
    v_mov_b32 v31, 1
    v_lshlrev_b32 v103, 2, v1
    s_mov_b64 exec, 3
    buffer_store_dword v31, v103, s[44:47], s100 offen sc1
    s_mov_b64 exec, -1
L_g2pub2:
L_g2ready:
    ds_read_b64_tr_b16 v[72:73], v22 offset:0
    ds_read_b64_tr_b16 v[74:75], v22 offset:1024
    ds_read_b64_tr_b16 v[76:77], v23 offset:0
    ds_read_b64_tr_b16 v[78:79], v23 offset:1024
    ds_read_b64_tr_b16 v[80:81], v22 offset:4096
    ds_read_b64_tr_b16 v[82:83], v22 offset:5120
    ds_read_b64_tr_b16 v[84:85], v23 offset:4096
    ds_read_b64_tr_b16 v[86:87], v23 offset:5120
    s_waitcnt lgkmcnt(6)
    s_waitcnt vmcnt(7)
    s_add_u32 s7, s52, 2
    s_and_b32 s7, s7, 3
    s_lshl_b32 s7, s7, 13
    s_add_u32 s7, s7, s96
    s_add_u32 s56, s59, s7
    s_xor_b32 s57, s59, 4096
    s_add_u32 s57, s57, s7
    buffer_load_dwordx4 a[64:67], v30, s[44:47], s56 offen offset:0 sc1
    s_add_u32 m0, s4, 16384
    s_nop 0
    buffer_load_dwordx4 v6, s[12:15], s60 offen lds
    buffer_load_dwordx4 v7, s[12:15], s60 offen offset:1024 lds
    v_mfma_f32_32x32x16_bf16 v[128:143], v[72:75], a[0:3], 0
    ds_read_b64_tr_b16 v[88:89], v22 offset:8192
    ds_read_b64_tr_b16 v[90:91], v22 offset:9216
    s_waitcnt lgkmcnt(6)
    v_mfma_f32_32x32x16_bf16 v[144:159], v[76:79], a[0:3], 0
    ds_read_b64_tr_b16 v[92:93], v23 offset:8192
    ds_read_b64_tr_b16 v[94:95], v23 offset:9216
    s_waitcnt lgkmcnt(6)
    s_waitcnt vmcnt(9)
    buffer_load_dwordx4 a[68:71], v30, s[44:47], s56 offen offset:1024 sc1
    buffer_load_dwordx4 v8, s[12:15], s60 offen offset:2048 lds
    buffer_load_dwordx4 v9, s[12:15], s60 offen offset:3072 lds
    v_mfma_f32_32x32x16_bf16 v[128:143], v[80:83], a[4:7], v[128:143]
    ds_read_b64_tr_b16 v[96:97], v22 offset:12288
    ds_read_b64_tr_b16 v[98:99], v22 offset:13312
    s_waitcnt lgkmcnt(6)
    v_mfma_f32_32x32x16_bf16 v[144:159], v[84:87], a[4:7], v[144:159]
    ds_read_b64_tr_b16 v[100:101], v23 offset:12288
    ds_read_b64_tr_b16 v[102:103], v23 offset:13312
    s_waitcnt lgkmcnt(6)
    s_waitcnt vmcnt(11)
    buffer_load_dwordx4 a[72:75], v30, s[44:47], s56 offen offset:2048 sc1
    s_add_u32 s61, s60, 32768
    s_add_u32 m0, s4, 20480
    s_nop 0
    buffer_load_dwordx4 v6, s[12:15], s61 offen lds
    buffer_load_dwordx4 v7, s[12:15], s61 offen offset:1024 lds
    v_mfma_f32_32x32x16_bf16 v[128:143], v[88:91], a[8:11], v[128:143]
    ds_read_b64_tr_b16 v[72:73], v22 offset:32768
    ds_read_b64_tr_b16 v[74:75], v22 offset:33792
    s_waitcnt lgkmcnt(6)
    v_mfma_f32_32x32x16_bf16 v[144:159], v[92:95], a[8:11], v[144:159]
    ds_read_b64_tr_b16 v[76:77], v23 offset:32768
    ds_read_b64_tr_b16 v[78:79], v23 offset:33792
    s_waitcnt lgkmcnt(6)
    s_waitcnt vmcnt(13)
    buffer_load_dwordx4 a[76:79], v30, s[44:47], s56 offen offset:3072 sc1
    buffer_load_dwordx4 v8, s[12:15], s61 offen offset:2048 lds
    buffer_load_dwordx4 v9, s[12:15], s61 offen offset:3072 lds
    s_xor_b32 s7, s62, 196608
    s_add_u32 s60, s63, s7
    v_mfma_f32_32x32x16_bf16 v[128:143], v[96:99], a[12:15], v[128:143]
    ds_read_b64_tr_b16 v[80:81], v22 offset:36864
    ds_read_b64_tr_b16 v[82:83], v22 offset:37888
    s_waitcnt lgkmcnt(6)
    v_mfma_f32_32x32x16_bf16 v[144:159], v[100:103], a[12:15], v[144:159]
    ds_read_b64_tr_b16 v[84:85], v23 offset:36864
    ds_read_b64_tr_b16 v[86:87], v23 offset:37888
    s_waitcnt lgkmcnt(6)
    s_waitcnt vmcnt(15)
    s_add_u32 s7, s52, 3
    s_and_b32 s7, s7, 3
    s_lshl_b32 s7, s7, 13
    s_add_u32 s7, s7, s96
    s_add_u32 s56, s59, s7
    s_xor_b32 s57, s59, 4096
    s_add_u32 s57, s57, s7
    buffer_load_dwordx4 a[96:99], v30, s[44:47], s56 offen offset:0 sc1
    s_add_u32 m0, s4, 24576
    s_nop 0
    buffer_load_dwordx4 v6, s[12:15], s60 offen lds
    buffer_load_dwordx4 v7, s[12:15], s60 offen offset:1024 lds
    v_mfma_f32_32x32x16_bf16 v[128:143], v[72:75], a[32:35], v[128:143]
    ds_read_b64_tr_b16 v[88:89], v22 offset:40960
    ds_read_b64_tr_b16 v[90:91], v22 offset:41984
    s_waitcnt lgkmcnt(6)
    v_mfma_f32_32x32x16_bf16 v[144:159], v[76:79], a[32:35], v[144:159]
    ds_read_b64_tr_b16 v[92:93], v23 offset:40960
    ds_read_b64_tr_b16 v[94:95], v23 offset:41984
    s_waitcnt lgkmcnt(6)
    s_waitcnt vmcnt(17)
    buffer_load_dwordx4 a[100:103], v30, s[44:47], s56 offen offset:1024 sc1
    buffer_load_dwordx4 v8, s[12:15], s60 offen offset:2048 lds
    buffer_load_dwordx4 v9, s[12:15], s60 offen offset:3072 lds
    v_mfma_f32_32x32x16_bf16 v[128:143], v[80:83], a[36:39], v[128:143]
    ds_read_b64_tr_b16 v[96:97], v22 offset:45056
    ds_read_b64_tr_b16 v[98:99], v22 offset:46080
    s_waitcnt lgkmcnt(6)
    v_mfma_f32_32x32x16_bf16 v[144:159], v[84:87], a[36:39], v[144:159]
    ds_read_b64_tr_b16 v[100:101], v23 offset:45056
    ds_read_b64_tr_b16 v[102:103], v23 offset:46080
    s_waitcnt lgkmcnt(6)
    s_waitcnt vmcnt(19)
    buffer_load_dwordx4 a[104:107], v30, s[44:47], s56 offen offset:2048 sc1
    s_add_u32 s61, s60, 32768
    s_add_u32 m0, s4, 28672
    s_nop 0
    buffer_load_dwordx4 v6, s[12:15], s61 offen lds
    v_mfma_f32_32x32x16_bf16 v[128:143], v[88:91], a[40:43], v[128:143]
    ds_read_b64_tr_b16 v[72:73], v26 offset:0
    ds_read_b64_tr_b16 v[74:75], v26 offset:1024
    s_waitcnt lgkmcnt(6)
    v_mfma_f32_32x32x16_bf16 v[144:159], v[92:95], a[40:43], v[144:159]
    ds_read_b64_tr_b16 v[76:77], v27 offset:0
    ds_read_b64_tr_b16 v[78:79], v27 offset:1024
    s_waitcnt lgkmcnt(6)
    s_waitcnt vmcnt(20)
    buffer_load_dwordx4 a[108:111], v30, s[44:47], s56 offen offset:3072 sc1
    buffer_load_dwordx4 v7, s[12:15], s61 offen offset:1024 lds
    v_mfma_f32_32x32x16_bf16 v[128:143], v[96:99], a[44:47], v[128:143]
    ds_read_b64_tr_b16 v[80:81], v26 offset:4096
    ds_read_b64_tr_b16 v[82:83], v26 offset:5120
    s_waitcnt lgkmcnt(6)
    v_mfma_f32_32x32x16_bf16 v[144:159], v[100:103], a[44:47], v[144:159]
    ds_read_b64_tr_b16 v[84:85], v27 offset:4096
    ds_read_b64_tr_b16 v[86:87], v27 offset:5120
    s_waitcnt lgkmcnt(6)
    s_waitcnt vmcnt(21)
    s_add_u32 s7, s52, 0
    s_and_b32 s7, s7, 3
    s_lshl_b32 s7, s7, 13
    s_add_u32 s7, s7, s96
    s_add_u32 s56, s59, s7
    s_xor_b32 s57, s59, 4096
    s_add_u32 s57, s57, s7
    buffer_load_dwordx4 a[16:19], v30, s[44:47], s57 offen offset:0 sc1
    buffer_load_dwordx4 v8, s[12:15], s61 offen offset:2048 lds
    v_mfma_f32_32x32x16_bf16 v[128:143], v[72:75], a[64:67], v[128:143]
    ds_read_b64_tr_b16 v[88:89], v26 offset:8192
    ds_read_b64_tr_b16 v[90:91], v26 offset:9216
    s_waitcnt lgkmcnt(6)
    v_mfma_f32_32x32x16_bf16 v[144:159], v[76:79], a[64:67], v[144:159]
    ds_read_b64_tr_b16 v[92:93], v27 offset:8192
    ds_read_b64_tr_b16 v[94:95], v27 offset:9216
    s_waitcnt lgkmcnt(6)
    s_waitcnt vmcnt(20)
    buffer_load_dwordx4 a[20:23], v30, s[44:47], s57 offen offset:1024 sc1
    buffer_load_dwordx4 v9, s[12:15], s61 offen offset:3072 lds
    v_mfma_f32_32x32x16_bf16 v[128:143], v[80:83], a[68:71], v[128:143]
    ds_read_b64_tr_b16 v[96:97], v26 offset:12288
    ds_read_b64_tr_b16 v[98:99], v26 offset:13312
    s_waitcnt lgkmcnt(6)
    v_mfma_f32_32x32x16_bf16 v[144:159], v[84:87], a[68:71], v[144:159]
    ds_read_b64_tr_b16 v[100:101], v27 offset:12288
    ds_read_b64_tr_b16 v[102:103], v27 offset:13312
    s_waitcnt lgkmcnt(6)
    s_waitcnt vmcnt(19)
    buffer_load_dwordx4 a[24:27], v30, s[44:47], s57 offen offset:2048 sc1
    v_mfma_f32_32x32x16_bf16 v[128:143], v[88:91], a[72:75], v[128:143]
    ds_read_b64_tr_b16 v[72:73], v26 offset:32768
    ds_read_b64_tr_b16 v[74:75], v26 offset:33792
    s_waitcnt lgkmcnt(6)
    v_mfma_f32_32x32x16_bf16 v[144:159], v[92:95], a[72:75], v[144:159]
    ds_read_b64_tr_b16 v[76:77], v27 offset:32768
    ds_read_b64_tr_b16 v[78:79], v27 offset:33792
    s_waitcnt lgkmcnt(6)
    s_waitcnt vmcnt(17)
    buffer_load_dwordx4 a[28:31], v30, s[44:47], s57 offen offset:3072 sc1
    v_mfma_f32_32x32x16_bf16 v[128:143], v[96:99], a[76:79], v[128:143]
    ds_read_b64_tr_b16 v[80:81], v26 offset:36864
    ds_read_b64_tr_b16 v[82:83], v26 offset:37888
    s_waitcnt lgkmcnt(6)
    v_mfma_f32_32x32x16_bf16 v[144:159], v[100:103], a[76:79], v[144:159]
    ds_read_b64_tr_b16 v[84:85], v27 offset:36864
    ds_read_b64_tr_b16 v[86:87], v27 offset:37888
    s_waitcnt lgkmcnt(6)
    s_waitcnt vmcnt(15)
    s_add_u32 s7, s52, 1
    s_and_b32 s7, s7, 3
    s_lshl_b32 s7, s7, 13
    s_add_u32 s7, s7, s96
    s_add_u32 s56, s59, s7
    s_xor_b32 s57, s59, 4096
    s_add_u32 s57, s57, s7
    buffer_load_dwordx4 a[48:51], v30, s[44:47], s57 offen offset:0 sc1
    v_mfma_f32_32x32x16_bf16 v[128:143], v[72:75], a[96:99], v[128:143]
    ds_read_b64_tr_b16 v[88:89], v26 offset:40960
    ds_read_b64_tr_b16 v[90:91], v26 offset:41984
    s_waitcnt lgkmcnt(6)
    v_mfma_f32_32x32x16_bf16 v[144:159], v[76:79], a[96:99], v[144:159]
    ds_read_b64_tr_b16 v[92:93], v27 offset:40960
    ds_read_b64_tr_b16 v[94:95], v27 offset:41984
    s_waitcnt lgkmcnt(6)
    s_waitcnt vmcnt(13)
    buffer_load_dwordx4 a[52:55], v30, s[44:47], s57 offen offset:1024 sc1
    v_mfma_f32_32x32x16_bf16 v[128:143], v[80:83], a[100:103], v[128:143]
    ds_read_b64_tr_b16 v[96:97], v26 offset:45056
    ds_read_b64_tr_b16 v[98:99], v26 offset:46080
    s_waitcnt lgkmcnt(6)
    v_mfma_f32_32x32x16_bf16 v[144:159], v[84:87], a[100:103], v[144:159]
    ds_read_b64_tr_b16 v[100:101], v27 offset:45056
    ds_read_b64_tr_b16 v[102:103], v27 offset:46080
    s_waitcnt vmcnt(4)
    s_branch L_g2go
L_g2second:
    s_add_u32 s7, s52, 0
    s_and_b32 s7, s7, 3
    s_lshl_b32 s7, s7, 13
    s_add_u32 s7, s7, s96
    s_add_u32 s56, s59, s7
    s_xor_b32 s57, s59, 4096
    s_add_u32 s57, s57, s7
    buffer_load_dwordx4 a[0:3], v30, s[44:47], s56 offen offset:0 sc1
    buffer_load_dwordx4 a[4:7], v30, s[44:47], s56 offen offset:1024 sc1
    buffer_load_dwordx4 a[8:11], v30, s[44:47], s56 offen offset:2048 sc1
    buffer_load_dwordx4 a[12:15], v30, s[44:47], s56 offen offset:3072 sc1
    s_add_u32 s7, s52, 1
    s_and_b32 s7, s7, 3
    s_lshl_b32 s7, s7, 13
    s_add_u32 s7, s7, s96
    s_add_u32 s56, s59, s7
    s_xor_b32 s57, s59, 4096
    s_add_u32 s57, s57, s7
    buffer_load_dwordx4 a[32:35], v30, s[44:47], s56 offen offset:0 sc1
    buffer_load_dwordx4 a[36:39], v30, s[44:47], s56 offen offset:1024 sc1
    buffer_load_dwordx4 a[40:43], v30, s[44:47], s56 offen offset:2048 sc1
    buffer_load_dwordx4 a[44:47], v30, s[44:47], s56 offen offset:3072 sc1
    s_branch L_g2ready
L_red:
L_end:
    s_endpgm
.section .rodata,"a"
.p2align 6
.amdhsa_kernel concat_heads__gqa_block_cached__mha_block_cached__near_ridge_kernel
  .amdhsa_next_free_vgpr 512
  .amdhsa_next_free_sgpr 102
  .amdhsa_accum_offset 256
  .amdhsa_group_segment_fixed_size 0
  .amdhsa_kernarg_size 104
  .amdhsa_user_sgpr_count 2
  .amdhsa_user_sgpr_kernarg_segment_ptr 1
  .amdhsa_system_sgpr_workgroup_id_x 1
.end_amdhsa_kernel
```
